```python
import torch

def _softmax(x, axis=-1):
    return torch.softmax(x, dim=axis)

def _gelu(x):
    return torch.nn.functional.gelu(x, approximate='tanh')

def _silu(x):
    return torch.nn.functional.silu(x)

def _sigmoid(x):
    return torch.sigmoid(x)

def _layernorm(x, axis=-1, eps=1e-05):
    m = x.mean(dim=axis, keepdim=True)
    v = x.var(dim=axis, keepdim=True, unbiased=False)
    return (x - m) / torch.sqrt(v + eps)

def _scatter_add(tgt, idx, src, axis=0):
    return tgt.clone().index_add_(axis, idx, src)

def _segment_sum(src, seg, n):
    out = torch.zeros((n,) + src.shape[1:], dtype=src.dtype)
    return out.index_add_(0, seg, src)

def _pad(x, pw):
    flat = tuple((v for pair in reversed(pw) for v in pair))
    return torch.nn.functional.pad(x, flat)
kernel_name = 'sequential_preLN__spectral_fnet__mixer_gmlp__prompt'

def setup_inputs():

    _w = lambda a: (lambda t: t.to(torch.bfloat16) if t.is_floating_point() else t)(torch.as_tensor(a))

    def _A_setup():
        B, S, D = (1, 2048, 512)
        ns = torch.arange(S)[:, None] * torch.arange(S)[None, :]
        nd = torch.arange(D)[:, None] * torch.arange(D)[None, :]
        Ws_re = torch.cos(-2.0 * torch.pi * ns / S).to(float)
        Ws_im = torch.sin(-2.0 * torch.pi * ns / S).to(float)
        Wd_re = torch.cos(-2.0 * torch.pi * nd / D).to(float)
        Wd_im = torch.sin(-2.0 * torch.pi * nd / D).to(float)
        return {'x': _w((lambda *s: torch.randn(*s, dtype=torch.bfloat16) * 0.05)(B, S, D)), 'dft_seq_re': _w(Ws_re), 'dft_seq_im': _w(Ws_im), 'dft_hid_re': _w(Wd_re), 'dft_hid_im': _w(Wd_im)}
    _A_in = _A_setup()

    def _B_setup():
        B, S, D, F = (1, 2048, 512, 1376)
        Fh = F // 2
        return {'x': _w((lambda *s: torch.randn(*s, dtype=torch.bfloat16) * 0.05)(B, S, D)), 'w_in': _w((lambda *s: torch.randn(*s, dtype=torch.bfloat16) * 1.6)(D, 2 * Fh)), 'w_sp': _w(0.01 * (lambda *s: torch.randn(*s, dtype=torch.bfloat16) * 1.6)(S, S)), 'b_sp': _w(1.0 + 0.01 * (lambda *s: torch.randn(*s, dtype=torch.bfloat16) * 0.8)(S)), 'w_out': _w((lambda *s: torch.randn(*s, dtype=torch.bfloat16) * 0.8)(Fh, D))}
    _B_in = _B_setup()
    return {'A_x': _A_in['x'], 'A_dft_seq_re': _A_in['dft_seq_re'], 'A_dft_seq_im': _A_in['dft_seq_im'], 'A_dft_hid_re': _A_in['dft_hid_re'], 'A_dft_hid_im': _A_in['dft_hid_im'], 'B_x': _B_in['x'], 'B_w_in': _B_in['w_in'], 'B_w_sp': _B_in['w_sp'], 'B_b_sp': _B_in['b_sp'], 'B_w_out': _B_in['w_out']}

def reference(A_x, A_dft_seq_re, A_dft_seq_im, A_dft_hid_re, A_dft_hid_im, B_x, B_w_in, B_w_sp, B_b_sp, B_w_out):

    def _A_ref(x, dft_seq_re, dft_seq_im, dft_hid_re, dft_hid_im):
        a = torch.einsum('bsd,ed->bse', x, dft_hid_re)
        b = torch.einsum('bsd,ed->bse', x, dft_hid_im)
        y = torch.einsum('ts,bse->bte', dft_seq_re, a) - torch.einsum('ts,bse->bte', dft_seq_im, b)
        return y

    def _B_ref(x, w_in, w_sp, b_sp, w_out):
        B, S, D = x.shape
        F = w_in.shape[-1]
        Fh = F // 2
        z = _gelu(torch.einsum('bsd,df->bsf', x, w_in))
        z1 = z[..., :Fh].clone()
        z2 = _layernorm(z[..., Fh:], axis=-1)
        g = torch.einsum('ts,bsf->btf', w_sp, z2) + b_sp[None, :, None]
        return torch.einsum('bsf,fd->bsd', z1 * g, w_out)
    x = A_x
    h = x + _A_ref(_layernorm(x, axis=-1), A_dft_seq_re, A_dft_seq_im, A_dft_hid_re, A_dft_hid_im)
    h2 = h + _B_ref(_layernorm(h, axis=-1), B_w_in, B_w_sp, B_b_sp, B_w_out)
    return h2
```

```asm
; @launch grid=(256,1,1) block=(512,1,1) lds=163840
.amdgcn_target "amdgcn-amd-amdhsa--gfx950"
.text
.globl sequential_preLN__spectral_fnet__mixer_gmlp__prompt_kernel
.p2align 8
.type sequential_preLN__spectral_fnet__mixer_gmlp__prompt_kernel,@function
sequential_preLN__spectral_fnet__mixer_gmlp__prompt_kernel:
    s_getpc_b64 s[42:43]
    s_load_dwordx2 s[4:5], s[0:1], 0
    s_load_dwordx2 s[8:9], s[0:1], 48
    s_cmp_ge_u32 s2, 256
    s_cbranch_scc1 L_end
    s_lshl_b32 s40, s2, 8
    s_and_b32 s40, s40, 63488
    s_min_u32 s40, s40, 38912
    s_sub_u32 s42, s42, 4
    v_lshl_add_u32 v7, v0, 2, s40
    global_load_dword v255, v7, s[42:43]
    v_readfirstlane_b32 s41, v0
    v_and_b32 v1, 15, v0
    v_bfe_u32 v2, v0, 4, 2
    v_and_b32 v0, 63, v0
    s_and_b32 s40, s2, 7
    s_cselect_b32 s44, s40, 8
    s_sub_u32 s44, 0, s44
    s_bitcmp1_b32 s2, 6
    s_cselect_b32 s40, s44, s40
    s_lshr_b32 s44, s2, 3
    s_and_b32 s36, s44, 7
    s_and_b32 s44, s44, 16
    s_add_u32 s40, s40, s44
    s_and_b32 s35, s40, 31
    s_bfe_u32 s32, s41, 0x20006
    s_lshl_b32 s59, s32, 14
    s_bitcmp1_b32 s41, 8
    s_cbranch_scc1 L_teamY
    v_xor_b32 v9, v2, v1
    v_lshlrev_b32 v9, 4, v9
    v_lshl_add_u32 v112, v2, 15, v9
    v_xor_b32 v8, 64, v112
    v_add_u32 v113, 130048, v8
    v_xor_b32 v8, 128, v112
    v_add_u32 v114, 260096, v8
    v_xor_b32 v8, 192, v112
    v_add_u32 v115, 390144, v8
    s_lshl_b32 s49, s59, 5
    s_lshl_b32 s45, s35, 10
    s_add_u32 s49, s49, s45
    s_and_b32 s51, s36, 3
    s_lshl_b32 s51, s51, 8
    s_mov_b32 s6, 2097152
    s_mov_b32 s7, 0x20000
    s_mov_b32 m0, s59
    s_add_u32 s48, s51, s49
    s_waitcnt lgkmcnt(0)
    buffer_load_dwordx4 v112, s[4:7], s48 offen offset:0 lds
    buffer_load_dwordx4 v113, s[4:7], s48 offen offset:1024 lds
    buffer_load_dwordx4 v114, s[4:7], s48 offen offset:2048 lds
    buffer_load_dwordx4 v115, s[4:7], s48 offen offset:3072 lds
    s_mul_i32 s42, s36, 12
    s_lshl2_add_u32 s42, s32, s42
    s_sub_u32 s42, s42, 10
    v_and_b32 v3, 3, v0
    v_add_u32 v3, s42, v3
    s_cmp_eq_u32 s32, 3
    s_cselect_b32 s42, 0, 86
    v_cmp_gt_u32 vcc, s42, v3
    v_lshlrev_b32 v3, 4, v3
    v_mov_b32 v5, 2147418112
    s_lshl_b32 s40, s35, 5
    s_and_b32 s40, s40, 511
    v_cndmask_b32 v3, v5, v3, vcc
    v_lshrrev_b32 v8, 2, v0
    v_add_u32 v8, s40, v8
    s_movk_i32 s43, 2752
    v_sub_u32 v4, 768, v8
    v_cmp_lt_u32 vcc, 0x100, v8
    s_bitcmp1_b32 s35, 3
    s_cselect_b32 s40, -1, 0
    v_cndmask_b32 v4, v8, v4, vcc
    v_xor_b32 v8, s40, v8
    s_cselect_b32 s40, 753, 16
    v_add_u32 v8, s40, v8
    v_mad_u32_u24 v4, v4, s43, v3
    v_mad_u32_u24 v5, v8, s43, v3
    s_lshr_b32 s42, s35, 4
    s_mulk_i32 s42, 1376
    s_mul_i32 s57, s32, 24576
    s_add_u32 s57, s57, 65536
    s_mov_b32 s10, 1409024
    s_mov_b32 s11, 0x20000
    s_add_u32 m0, s57, 16384
    s_nop 0
    buffer_load_dwordx4 v4, s[8:11], s42 offen lds
    s_add_u32 m0, s57, 17408
    s_nop 0
    buffer_load_dwordx4 v5, s[8:11], s42 offen lds
    s_load_dwordx2 s[28:29], s[0:1], 96
    s_load_dwordx2 s[12:13], s[0:1], 56
    s_load_dwordx2 s[16:17], s[0:1], 64
    s_load_dwordx2 s[20:21], s[0:1], 72
    s_load_dwordx2 s[24:25], s[0:1], 80
    s_mov_b32 s30, 268435456
    s_mov_b32 s31, 0x20000
    s_mov_b32 s14, 8388608
    s_mov_b32 s15, 0x20000
    s_mov_b32 s18, 4096
    s_mov_b32 s19, 0x20000
    s_mov_b32 s22, 704512
    s_mov_b32 s23, 0x20000
    s_mov_b32 s26, 2097152
    s_mov_b32 s27, 0x20000
    s_mov_b32 s58, 0
    s_and_b32 s63, s32, 1
    s_mov_b32 s33, s35
    s_mov_b32 s34, s36
    v_lshlrev_b32 v7, 8, v1
    v_add3_u32 v12, v9, v7, s59
    v_xor_b32 v13, 64, v12
    v_xor_b32 v14, 128, v12
    v_xor_b32 v15, 192, v12
    s_lshl_b32 s41, s36, 7
    s_add_u32 s99, s49, s41
    v_lshrrev_b32 v3, 1, v2
    v_and_b32 v31, 1, v2
    v_lshl_or_b32 v3, v31, 1, v3
    v_lshlrev_b32 v31, 4, v3
    v_lshl_add_u32 v30, v1, 15, v31
    v_lshlrev_b32 v29, 4, v0
    s_mov_b32 s37, s35
    s_sub_u32 s38, 64, s35
    s_cmp_eq_u32 s35, 0
    s_cselect_b32 s38, 32, s38
    s_mul_i32 s56, s36, 196608
    s_add_u32 s56, s56, 8912896
    s_cmp_lt_u32 s32, 2
    s_cselect_b32 s62, s37, s38
    s_lshl_b32 s100, s36, 5
    s_add_u32 s100, s100, s35
    s_mul_i32 s40, s36, 393216
    s_add_u32 s98, s40, 2097152
    s_cmp_eq_u32 s32, 0
    s_cselect_b32 s60, 0xffff, 0
    s_mov_b32 s61, 0
    s_lshr_b32 s40, s2, 6
    s_mul_i32 s40, s40, 0
    s_mul_i32 s96, s2, 0
    s_add_u32 s96, s96, s40
    s_lshl_b32 s40, s35, 2
    s_add_u32 s40, s40, s32
    s_lshl_b32 s101, s40, 10
    s_add_u32 s101, s101, 8388608
    s_mul_i32 s53, s40, 24576
    s_add_u32 s53, s53, 5242880
    s_mul_i32 s40, s36, 3072
    s_add_u32 s3, s53, s40
    s_waitcnt lgkmcnt(0)
    s_add_u32 s42, s28, 8650752
    s_addc_u32 s43, s29, 0
    s_load_dword s39, s[42:43], 0
    v_lshlrev_b32 v16, 3, v0
    v_add_u32 v17, s59, v16
    v_lshlrev_b32 v20, 30, v1
    v_and_b32 v20, 0x80000000, v20
    v_or_b32 v20, 1.0, v20
    v_mov_b32 v24, 0x3f803f80
    v_mov_b32 v25, 0x3f803f80
    v_mov_b32 v26, 0x3f803f80
    v_mov_b32 v27, 0x3f803f80
    v_add_u32 v22, 65536, v29
    v_add_u32 v23, 114688, v29
    s_barrier
    ds_read_b128 v[128:131], v22 offset:0
    ds_read_b128 v[160:163], v22 offset:24576
    ds_read_b128 v[192:195], v23 offset:0
    ds_read_b128 v[224:227], v23 offset:24576
    ds_read_b128 v[132:135], v22 offset:1024
    ds_read_b128 v[164:167], v22 offset:25600
    ds_read_b128 v[196:199], v23 offset:1024
    ds_read_b128 v[228:231], v23 offset:25600
    ds_read_b128 v[136:139], v22 offset:2048
    ds_read_b128 v[168:171], v22 offset:26624
    ds_read_b128 v[200:203], v23 offset:2048
    ds_read_b128 v[232:235], v23 offset:26624
    ds_read_b128 v[140:143], v22 offset:3072
    ds_read_b128 v[172:175], v22 offset:27648
    ds_read_b128 v[204:207], v23 offset:3072
    ds_read_b128 v[236:239], v23 offset:27648
    ds_read_b128 v[144:147], v22 offset:4096
    ds_read_b128 v[176:179], v22 offset:28672
    ds_read_b128 v[208:211], v23 offset:4096
    ds_read_b128 v[240:243], v23 offset:28672
    ds_read_b128 v[148:151], v22 offset:5120
    ds_read_b128 v[180:183], v22 offset:29696
    ds_read_b128 v[212:215], v23 offset:5120
    ds_read_b128 v[244:247], v23 offset:29696
    ds_read_b128 v[152:155], v22 offset:6144
    ds_read_b128 v[184:187], v22 offset:30720
    ds_read_b128 v[216:219], v23 offset:6144
    ds_read_b128 v[248:251], v23 offset:30720
    ds_read_b128 v[156:159], v22 offset:7168
    ds_read_b128 v[188:191], v22 offset:31744
    ds_read_b128 v[220:223], v23 offset:7168
    s_waitcnt vmcnt(6)
    ds_read_b128 v[252:255], v23 offset:31744
    s_add_u32 m0, s59, 4096
    s_add_u32 s48, s51, 256
    s_and_b32 s48, s48, 1023
    s_add_u32 s48, s48, s49
    buffer_load_dwordx4 v112, s[4:7], s48 offen offset:0 lds
    buffer_load_dwordx4 v113, s[4:7], s48 offen offset:1024 lds
    buffer_load_dwordx4 v114, s[4:7], s48 offen offset:2048 lds
    buffer_load_dwordx4 v115, s[4:7], s48 offen offset:3072 lds
    s_waitcnt lgkmcnt(0)
    s_mul_i32 s39, s39, 0x9e3779b1
    s_add_u32 s39, s39, 0x7f4a7c15
    s_and_b32 s88, s39, 0x00030003
    s_lshr_b32 s89, s39, 2
    s_and_b32 s89, s89, 196610
    s_lshr_b32 s90, s39, 4
    s_and_b32 s90, s90, 196610
    s_lshr_b32 s91, s39, 6
    s_and_b32 s91, s91, 196611
    s_and_b32 s40, s39, 1
    s_xor_b32 s40, s40, 1
    s_or_b32 s89, s89, s40
    s_or_b32 s90, s90, s40
    v_mov_b32 v28, 0xfffcfffc
    s_waitcnt vmcnt(6)
    ds_read_b128 v[32:35], v12 offset:0
    s_add_u32 m0, s59, 8192
    ds_read_b128 v[36:39], v13 offset:0
    s_add_u32 s48, s51, 512
    ds_read_b128 v[40:43], v14 offset:0
    s_and_b32 s48, s48, 1023
    ds_read_b128 v[44:47], v15 offset:0
    s_add_u32 s48, s48, s49
    s_waitcnt lgkmcnt(0)
    v_mfma_f32_16x16x32_bf16 v[120:123], v[32:35], v[32:35], 0
    buffer_load_dwordx4 v112, s[4:7], s48 offen offset:0 lds
    v_mfma_f32_16x16x32_bf16 v[124:127], v[24:27], v[32:35], 0
    v_mfma_f32_16x16x32_bf16 v[120:123], v[36:39], v[36:39], v[120:123]
    v_mfma_f32_16x16x32_bf16 v[124:127], v[24:27], v[36:39], v[124:127]
    buffer_load_dwordx4 v113, s[4:7], s48 offen offset:1024 lds
    v_mfma_f32_16x16x32_bf16 v[120:123], v[40:43], v[40:43], v[120:123]
    v_mfma_f32_16x16x32_bf16 v[124:127], v[24:27], v[40:43], v[124:127]
    v_mfma_f32_16x16x32_bf16 v[120:123], v[44:47], v[44:47], v[120:123]
    buffer_load_dwordx4 v114, s[4:7], s48 offen offset:2048 lds
    v_mfma_f32_16x16x32_bf16 v[124:127], v[24:27], v[44:47], v[124:127]
    v_mfma_f32_16x16x32_bf16 v[64:67], v[32:35], v[128:131], 0
    v_mfma_f32_16x16x32_bf16 v[64:67], v[36:39], v[132:135], v[64:67]
    buffer_load_dwordx4 v115, s[4:7], s48 offen offset:3072 lds
    s_waitcnt vmcnt(4)
    v_mfma_f32_16x16x32_bf16 v[64:67], v[40:43], v[136:139], v[64:67]
    ds_read_b128 v[48:51], v12 offset:4096
    s_add_u32 m0, s59, 12288
    v_mfma_f32_16x16x32_bf16 v[64:67], v[44:47], v[140:143], v[64:67]
    ds_read_b128 v[52:55], v13 offset:4096
    s_add_u32 s48, s51, 768
    v_mfma_f32_16x16x32_bf16 v[68:71], v[32:35], v[160:163], 0
    ds_read_b128 v[56:59], v14 offset:4096
    s_and_b32 s48, s48, 1023
    v_mfma_f32_16x16x32_bf16 v[68:71], v[36:39], v[164:167], v[68:71]
    ds_read_b128 v[60:63], v15 offset:4096
    s_add_u32 s48, s48, s49
    v_mfma_f32_16x16x32_bf16 v[68:71], v[40:43], v[168:171], v[68:71]
    buffer_load_dwordx4 v112, s[4:7], s48 offen offset:0 lds
    v_mfma_f32_16x16x32_bf16 v[68:71], v[44:47], v[172:175], v[68:71]
    v_mfma_f32_16x16x32_bf16 v[72:75], v[32:35], v[192:195], 0
    buffer_load_dwordx4 v113, s[4:7], s48 offen offset:1024 lds
    buffer_load_dwordx4 v114, s[4:7], s48 offen offset:2048 lds
    buffer_load_dwordx4 v115, s[4:7], s48 offen offset:3072 lds
    s_barrier
    v_mfma_f32_16x16x32_bf16 v[72:75], v[36:39], v[196:199], v[72:75]
    s_lshl_b32 s40, s32, 4
    v_add_u32 v18, s40, v1
    v_mfma_f32_16x16x32_bf16 v[72:75], v[40:43], v[200:203], v[72:75]
    v_cvt_f32_u32 v18, v18
    v_mul_f32 v18, 0x3a000000, v18
    v_mfma_f32_16x16x32_bf16 v[72:75], v[44:47], v[204:207], v[72:75]
    v_lshlrev_b32 v19, 7, v2
    v_add_u32 v19, s33, v19
    v_mfma_f32_16x16x32_bf16 v[76:79], v[32:35], v[224:227], 0
    v_cvt_f32_u32 v19, v19
    v_mul_f32 v19, v19, v18
    v_mfma_f32_16x16x32_bf16 v[76:79], v[36:39], v[228:231], v[76:79]
    v_and_b32 v3, 1, v1
    v_sub_u32 v3, 0, v3
    v_mfma_f32_16x16x32_bf16 v[76:79], v[40:43], v[232:235], v[76:79]
    v_and_b32 v3, 0x80008000, v3
    v_fmamk_f32 v4, v18, 0x00000000, v19
    v_mfma_f32_16x16x32_bf16 v[76:79], v[44:47], v[236:239], v[76:79]
    v_fmamk_f32 v5, v18, 0x42000000, v19
    v_fmamk_f32 v6, v18, 0x42800000, v19
    s_waitcnt lgkmcnt(0)
    v_mfma_f32_16x16x32_bf16 v[120:123], v[48:51], v[48:51], v[120:123]
    v_fmamk_f32 v7, v18, 0x42c00000, v19
    v_cos_f32 v8, v4
    v_mfma_f32_16x16x32_bf16 v[124:127], v[24:27], v[48:51], v[124:127]
    v_cos_f32 v9, v5
    v_mfma_f32_16x16x32_bf16 v[120:123], v[52:55], v[52:55], v[120:123]
    v_cos_f32 v10, v6
    v_mfma_f32_16x16x32_bf16 v[124:127], v[24:27], v[52:55], v[124:127]
    v_cos_f32 v11, v7
    v_mfma_f32_16x16x32_bf16 v[120:123], v[56:59], v[56:59], v[120:123]
    v_sin_f32 v4, v4
    v_mfma_f32_16x16x32_bf16 v[124:127], v[24:27], v[56:59], v[124:127]
    v_sin_f32 v5, v5
    v_mfma_f32_16x16x32_bf16 v[120:123], v[60:63], v[60:63], v[120:123]
    v_sin_f32 v6, v6
    v_mfma_f32_16x16x32_bf16 v[124:127], v[24:27], v[60:63], v[124:127]
    v_sin_f32 v7, v7
    v_mfma_f32_16x16x32_bf16 v[64:67], v[48:51], v[144:147], v[64:67]
    v_cvt_pk_f16_f32 v96, v8, v9
    v_cvt_pk_f16_f32 v97, v10, v11
    v_mfma_f32_16x16x32_bf16 v[64:67], v[52:55], v[148:151], v[64:67]
    s_waitcnt vmcnt(4)
    v_cvt_pk_f16_f32 v104, v4, v5
    v_cvt_pk_f16_f32 v105, v6, v7
    v_mfma_f32_16x16x32_bf16 v[64:67], v[56:59], v[152:155], v[64:67]
    ds_read_b128 v[32:35], v12 offset:8192
    v_fmamk_f32 v4, v18, 0x44000000, v19
    v_mfma_f32_16x16x32_bf16 v[64:67], v[60:63], v[156:159], v[64:67]
    ds_read_b128 v[36:39], v13 offset:8192
    v_fmamk_f32 v5, v18, 0x44080000, v19
    v_mfma_f32_16x16x32_bf16 v[68:71], v[48:51], v[176:179], v[68:71]
    ds_read_b128 v[40:43], v14 offset:8192
    v_fmamk_f32 v6, v18, 0x44100000, v19
    v_mfma_f32_16x16x32_bf16 v[68:71], v[52:55], v[180:183], v[68:71]
    ds_read_b128 v[44:47], v15 offset:8192
    v_fmamk_f32 v7, v18, 0x44180000, v19
    v_mfma_f32_16x16x32_bf16 v[68:71], v[56:59], v[184:187], v[68:71]
    v_cos_f32 v8, v4
    v_mfma_f32_16x16x32_bf16 v[68:71], v[60:63], v[188:191], v[68:71]
    v_cos_f32 v9, v5
    v_mfma_f32_16x16x32_bf16 v[72:75], v[48:51], v[208:211], v[72:75]
    v_cos_f32 v10, v6
    v_mfma_f32_16x16x32_bf16 v[72:75], v[52:55], v[212:215], v[72:75]
    v_cos_f32 v11, v7
    v_mfma_f32_16x16x32_bf16 v[72:75], v[56:59], v[216:219], v[72:75]
    v_sin_f32 v4, v4
    v_mfma_f32_16x16x32_bf16 v[72:75], v[60:63], v[220:223], v[72:75]
    v_sin_f32 v5, v5
    v_mfma_f32_16x16x32_bf16 v[76:79], v[48:51], v[240:243], v[76:79]
    v_sin_f32 v6, v6
    v_mfma_f32_16x16x32_bf16 v[76:79], v[52:55], v[244:247], v[76:79]
    v_sin_f32 v7, v7
    v_mfma_f32_16x16x32_bf16 v[76:79], v[56:59], v[248:251], v[76:79]
    v_cvt_pk_f16_f32 v98, v8, v9
    v_cvt_pk_f16_f32 v99, v10, v11
    v_mfma_f32_16x16x32_bf16 v[76:79], v[60:63], v[252:255], v[76:79]
    v_cvt_pk_f16_f32 v106, v4, v5
    v_cvt_pk_f16_f32 v107, v6, v7
    s_waitcnt lgkmcnt(0)
    v_mfma_f32_16x16x32_bf16 v[120:123], v[32:35], v[32:35], v[120:123]
    v_xor_b32 v100, v3, v96
    v_xor_b32 v108, v3, v104
    v_mfma_f32_16x16x32_bf16 v[124:127], v[24:27], v[32:35], v[124:127]
    v_xor_b32 v101, v3, v97
    v_xor_b32 v109, v3, v105
    v_mfma_f32_16x16x32_bf16 v[120:123], v[36:39], v[36:39], v[120:123]
    v_xor_b32 v102, v3, v98
    v_xor_b32 v110, v3, v106
    v_mfma_f32_16x16x32_bf16 v[124:127], v[24:27], v[36:39], v[124:127]
    v_xor_b32 v103, v3, v99
    v_xor_b32 v111, v3, v107
    v_mfma_f32_16x16x32_bf16 v[120:123], v[40:43], v[40:43], v[120:123]
    s_cmp_eq_u32 s36, 0
    s_cselect_b32 s40, 10, 0
    v_mfma_f32_16x16x32_bf16 v[124:127], v[24:27], v[40:43], v[124:127]
    s_mov_b32 s41, 2752
    v_mov_b32 v7, 2147418112
    v_mfma_f32_16x16x32_bf16 v[120:123], v[44:47], v[44:47], v[120:123]
    s_cmp_ge_u32 s32, 2
    s_cselect_b32 s42, 15, 0
    s_cselect_b32 s46, 2048, 0
    v_mfma_f32_16x16x32_bf16 v[124:127], v[24:27], v[44:47], v[124:127]
    v_add_u32 v8, 0, v0
    v_mul_u32_u24 v9, 171, v8
    v_mfma_f32_16x16x32_bf16 v[80:83], v[32:35], v[128:131], 0
    v_lshrrev_b32 v9, 11, v9
    v_mul_u32_u24 v4, 12, v9
    v_mfma_f32_16x16x32_bf16 v[80:83], v[36:39], v[132:135], v[80:83]
    s_waitcnt vmcnt(0)
    v_sub_u32 v4, v8, v4
    v_lshrrev_b32 v5, 2, v9
    v_mfma_f32_16x16x32_bf16 v[80:83], v[40:43], v[136:139], v[80:83]
    ds_read_b128 v[48:51], v12 offset:12288
    v_and_b32 v5, 2, v5
    v_mfma_f32_16x16x32_bf16 v[80:83], v[44:47], v[140:143], v[80:83]
    ds_read_b128 v[52:55], v13 offset:12288
    v_xor_b32 v4, v4, v5
    v_mfma_f32_16x16x32_bf16 v[84:87], v[32:35], v[160:163], 0
    ds_read_b128 v[56:59], v14 offset:12288
    v_cmp_le_u32 vcc, s40, v4
    v_mfma_f32_16x16x32_bf16 v[84:87], v[36:39], v[164:167], v[84:87]
    ds_read_b128 v[60:63], v15 offset:12288
    v_lshl_add_u32 v4, v4, 4, s46
    v_mfma_f32_16x16x32_bf16 v[84:87], v[40:43], v[168:171], v[84:87]
    v_subrev_u32 v4, 0, v4
    v_cndmask_b32 v4, v7, v4, vcc
    v_mfma_f32_16x16x32_bf16 v[84:87], v[44:47], v[172:175], v[84:87]
    v_xor_b32 v9, s42, v9
    v_mad_u32_u24 v116, v9, s41, v4
    v_mfma_f32_16x16x32_bf16 v[88:91], v[32:35], v[192:195], 0
    v_add_u32 v8, 64, v0
    v_mul_u32_u24 v9, 171, v8
    v_mfma_f32_16x16x32_bf16 v[88:91], v[36:39], v[196:199], v[88:91]
    v_lshrrev_b32 v9, 11, v9
    v_mul_u32_u24 v4, 12, v9
    v_mfma_f32_16x16x32_bf16 v[88:91], v[40:43], v[200:203], v[88:91]
    v_sub_u32 v4, v8, v4
    v_lshrrev_b32 v5, 2, v9
    v_mfma_f32_16x16x32_bf16 v[88:91], v[44:47], v[204:207], v[88:91]
    v_and_b32 v5, 2, v5
    v_xor_b32 v4, v4, v5
    v_mfma_f32_16x16x32_bf16 v[92:95], v[32:35], v[224:227], 0
    v_cmp_le_u32 vcc, s40, v4
    v_lshl_add_u32 v4, v4, 4, s46
    v_mfma_f32_16x16x32_bf16 v[92:95], v[36:39], v[228:231], v[92:95]
    v_subrev_u32 v4, 1024, v4
    v_cndmask_b32 v4, v7, v4, vcc
    v_mfma_f32_16x16x32_bf16 v[92:95], v[40:43], v[232:235], v[92:95]
    v_xor_b32 v9, s42, v9
    v_mad_u32_u24 v117, v9, s41, v4
    v_mfma_f32_16x16x32_bf16 v[92:95], v[44:47], v[236:239], v[92:95]
    v_add_u32 v8, 128, v0
    v_mul_u32_u24 v9, 171, v8
    s_waitcnt lgkmcnt(0)
    v_mfma_f32_16x16x32_bf16 v[120:123], v[48:51], v[48:51], v[120:123]
    v_lshrrev_b32 v9, 11, v9
    v_mul_u32_u24 v4, 12, v9
    v_mfma_f32_16x16x32_bf16 v[124:127], v[24:27], v[48:51], v[124:127]
    v_sub_u32 v4, v8, v4
    v_lshrrev_b32 v5, 2, v9
    v_mfma_f32_16x16x32_bf16 v[120:123], v[52:55], v[52:55], v[120:123]
    v_and_b32 v5, 2, v5
    v_xor_b32 v4, v4, v5
    v_mfma_f32_16x16x32_bf16 v[124:127], v[24:27], v[52:55], v[124:127]
    v_cmp_le_u32 vcc, s40, v4
    v_lshl_add_u32 v4, v4, 4, s46
    v_mfma_f32_16x16x32_bf16 v[120:123], v[56:59], v[56:59], v[120:123]
    v_subrev_u32 v4, 2048, v4
    v_cndmask_b32 v4, v7, v4, vcc
    v_mfma_f32_16x16x32_bf16 v[124:127], v[24:27], v[56:59], v[124:127]
    v_xor_b32 v9, s42, v9
    v_mad_u32_u24 v118, v9, s41, v4
    v_mfma_f32_16x16x32_bf16 v[120:123], v[60:63], v[60:63], v[120:123]
    s_cmp_eq_u32 s32, 2
    s_cselect_b32 s40, 704512, 0
    v_mfma_f32_16x16x32_bf16 v[124:127], v[24:27], v[60:63], v[124:127]
    v_add_u32 v8, s40, v116
    v_cmp_gt_u32 vcc, 12, v0
    v_mfma_f32_16x16x32_bf16 v[80:83], v[48:51], v[144:147], v[80:83]
    s_nop 0
    v_cndmask_b32 v119, v8, v116, vcc
    v_mfma_f32_16x16x32_bf16 v[80:83], v[52:55], v[148:151], v[80:83]
    v_mfma_f32_16x16x32_bf16 v[80:83], v[56:59], v[152:155], v[80:83]
    s_mov_b32 vcc_lo, 0x22222222
    s_mov_b32 vcc_hi, 0x22222222
    v_mfma_f32_16x16x32_bf16 v[80:83], v[60:63], v[156:159], v[80:83]
    v_cndmask_b32 v8, v120, v121, vcc
    s_mov_b32 vcc_lo, 0x44444444
    v_mfma_f32_16x16x32_bf16 v[84:87], v[48:51], v[176:179], v[84:87]
    s_mov_b32 vcc_hi, 0x44444444
    v_cndmask_b32 v8, v8, v122, vcc
    v_mfma_f32_16x16x32_bf16 v[84:87], v[52:55], v[180:183], v[84:87]
    s_mov_b32 vcc_lo, 0x88888888
    s_mov_b32 vcc_hi, 0x88888888
    v_mfma_f32_16x16x32_bf16 v[84:87], v[56:59], v[184:187], v[84:87]
    v_cndmask_b32 v8, v8, v123, vcc
    v_mul_f32 v9, 0x3b000000, v124
    v_mfma_f32_16x16x32_bf16 v[84:87], v[60:63], v[188:191], v[84:87]
    v_mul_f32 v8, 0x3b000000, v8
    v_fma_f32 v8, -v9, v9, v8
    v_mfma_f32_16x16x32_bf16 v[88:91], v[48:51], v[208:211], v[88:91]
    v_max_f32 v8, 0, v8
    v_add_f32 v8, 0x3727c5ac, v8
    v_mfma_f32_16x16x32_bf16 v[88:91], v[52:55], v[212:215], v[88:91]
    v_rsq_f32 v8, v8
    v_mfma_f32_16x16x32_bf16 v[88:91], v[56:59], v[216:219], v[88:91]
    v_mov_b32 v9, v8
    s_nop 1
    v_mov_b32_dpp v9, v8 row_ror:12 row_mask:0x2 bank_mask:0xf
    v_mfma_f32_16x16x32_bf16 v[88:91], v[60:63], v[220:223], v[88:91]
    s_nop 0
    v_mov_b32_dpp v9, v8 row_ror:8 row_mask:0x4 bank_mask:0xf
    s_nop 1
    v_mov_b32_dpp v9, v8 row_ror:4 row_mask:0x8 bank_mask:0xf
    v_mfma_f32_16x16x32_bf16 v[92:95], v[48:51], v[240:243], v[92:95]
    s_nop 0
    v_mov_b32_dpp v32, v9 row_newbcast:0 row_mask:0xf bank_mask:0xf
    v_mov_b32_dpp v33, v9 row_newbcast:1 row_mask:0xf bank_mask:0xf
    v_mfma_f32_16x16x32_bf16 v[92:95], v[52:55], v[244:247], v[92:95]
    v_mov_b32_dpp v34, v9 row_newbcast:2 row_mask:0xf bank_mask:0xf
    v_mov_b32_dpp v35, v9 row_newbcast:3 row_mask:0xf bank_mask:0xf
    v_mfma_f32_16x16x32_bf16 v[92:95], v[56:59], v[248:251], v[92:95]
    v_fmac_f32 v64, v20, v80
    v_fmac_f32 v65, v20, v81
    v_mfma_f32_16x16x32_bf16 v[92:95], v[60:63], v[252:255], v[92:95]
    v_fmac_f32 v66, v20, v82
    v_fmac_f32 v67, v20, v83
    v_fmac_f32 v68, v20, v84
    v_fmac_f32 v69, v20, v85
    v_fmac_f32 v70, v20, v86
    v_fmac_f32 v71, v20, v87
    v_fmac_f32 v72, v20, v88
    v_fmac_f32 v73, v20, v89
    v_fmac_f32 v74, v20, v90
    v_fmac_f32 v75, v20, v91
    v_mul_f32 v64, v64, v32
    v_mul_f32 v65, v65, v33
    v_mul_f32 v66, v66, v34
    v_mul_f32 v67, v67, v35
    v_cvt_pk_f16_f32 v4, v64, v65
    v_cvt_pk_f16_f32 v5, v66, v67
    ds_write_b64 v17, v[4:5] offset:0
    v_mul_f32 v68, v68, v32
    v_mul_f32 v69, v69, v33
    v_mul_f32 v70, v70, v34
    v_mul_f32 v71, v71, v35
    v_cvt_pk_f16_f32 v6, v68, v69
    v_cvt_pk_f16_f32 v7, v70, v71
    ds_write_b64 v17, v[6:7] offset:512
    v_fmac_f32 v76, v20, v92
    v_fmac_f32 v77, v20, v93
    v_fmac_f32 v78, v20, v94
    v_fmac_f32 v79, v20, v95
    v_mul_f32 v72, v72, v32
    v_mul_f32 v73, v73, v33
    v_mul_f32 v74, v74, v34
    v_mul_f32 v75, v75, v35
    v_cvt_pk_f16_f32 v4, v72, v73
    v_cvt_pk_f16_f32 v5, v74, v75
    ds_write_b64 v17, v[4:5] offset:1024
    v_mul_f32 v76, v76, v32
    v_mul_f32 v77, v77, v33
    v_mul_f32 v78, v78, v34
    v_mul_f32 v79, v79, v35
    v_cvt_pk_f16_f32 v6, v76, v77
    v_cvt_pk_f16_f32 v7, v78, v79
    ds_write_b64 v17, v[6:7] offset:1536
    s_waitcnt lgkmcnt(0)
    s_barrier
    ds_read_b64 v[128:129], v16 offset:0
    ds_read_b64 v[130:131], v16 offset:16384
    ds_read_b64 v[132:133], v16 offset:32768
    ds_read_b64 v[134:135], v16 offset:49152
    ds_read_b64 v[136:137], v16 offset:512
    ds_read_b64 v[138:139], v16 offset:16896
    ds_read_b64 v[140:141], v16 offset:33280
    ds_read_b64 v[142:143], v16 offset:49664
    ds_read_b64 v[144:145], v16 offset:1024
    ds_read_b64 v[146:147], v16 offset:17408
    ds_read_b64 v[148:149], v16 offset:33792
    ds_read_b64 v[150:151], v16 offset:50176
    ds_read_b64 v[152:153], v16 offset:1536
    ds_read_b64 v[154:155], v16 offset:17920
    ds_read_b64 v[156:157], v16 offset:34304
    ds_read_b64 v[158:159], v16 offset:50688
    s_mul_i32 s40, s32, 352256
    s_sub_u32 s41, 2070208, s40
    s_cmp_ge_u32 s32, 2
    s_cselect_b32 s50, s41, s40
    s_cselect_b32 s51, -16, 16
    s_mul_i32 s51, s51, 2752
    s_mul_i32 s40, s36, 192
    s_add_u32 s50, s50, s40
    s_add_u32 s50, s50, 1216
    s_cmp_eq_u32 s32, 2
    s_cselect_b32 s40, 704512, 0
    s_sub_u32 s49, s50, s40
    s_lshr_b32 s40, s2, 6
    s_add_u32 s40, s40, s2
    s_and_b32 s34, s40, 3
    s_mul_i32 s57, s32, 24576
    s_add_u32 s57, s57, 65536
    s_cmp_eq_u32 s32, 3
    s_cselect_b32 s55, -10240, s57
    s_waitcnt lgkmcnt(14)
    v_mfma_f32_16x16x32_f16 v[64:67], v[128:131], v[96:99], 0
    v_mfma_f32_16x16x32_f16 v[80:83], v[128:131], v[104:107], 0
    s_waitcnt lgkmcnt(12)
    v_mfma_f32_16x16x32_f16 v[64:67], v[132:135], v[100:103], v[64:67]
    v_mfma_f32_16x16x32_f16 v[80:83], v[132:135], v[108:111], v[80:83]
    s_waitcnt lgkmcnt(10)
    v_mfma_f32_16x16x32_f16 v[68:71], v[136:139], v[96:99], 0
    v_mfma_f32_16x16x32_f16 v[84:87], v[136:139], v[104:107], 0
    s_waitcnt lgkmcnt(8)
    v_mfma_f32_16x16x32_f16 v[68:71], v[140:143], v[100:103], v[68:71]
    v_mfma_f32_16x16x32_f16 v[84:87], v[140:143], v[108:111], v[84:87]
    s_waitcnt lgkmcnt(6)
    v_mfma_f32_16x16x32_f16 v[72:75], v[144:147], v[96:99], 0
    v_add_f32 v64, v64, v81
    v_sub_f32 v65, v65, v80
    v_mfma_f32_16x16x32_f16 v[88:91], v[144:147], v[104:107], 0
    v_cvt_pk_f16_f32 v32, v64, v65
    v_add_u32 v32, 0x00020002, v32
    s_waitcnt lgkmcnt(4)
    v_mfma_f32_16x16x32_f16 v[72:75], v[148:151], v[100:103], v[72:75]
    v_add_f32 v66, v66, v83
    v_sub_f32 v67, v67, v82
    v_mfma_f32_16x16x32_f16 v[88:91], v[148:151], v[108:111], v[88:91]
    v_cvt_pk_f16_f32 v33, v66, v67
    v_add_u32 v33, 0x00020002, v33
    s_waitcnt lgkmcnt(2)
    v_mfma_f32_16x16x32_f16 v[76:79], v[152:155], v[96:99], 0
    v_add_f32 v68, v68, v85
    v_sub_f32 v69, v69, v84
    v_mfma_f32_16x16x32_f16 v[92:95], v[152:155], v[104:107], 0
    v_cvt_pk_f16_f32 v34, v68, v69
    v_add_u32 v34, 0x00020002, v34
    s_waitcnt lgkmcnt(0)
    v_mfma_f32_16x16x32_f16 v[76:79], v[156:159], v[100:103], v[76:79]
    v_add_f32 v70, v70, v87
    v_sub_f32 v71, v71, v86
    v_mfma_f32_16x16x32_f16 v[92:95], v[156:159], v[108:111], v[92:95]
    v_cvt_pk_f16_f32 v35, v70, v71
    v_add_u32 v35, 0x00020002, v35
    v_permlane16_swap_b32 v32, v34
    s_nop 0
    v_permlane16_swap_b32 v33, v35
    v_and_or_b32 v32, v32, v28, s88
    v_and_or_b32 v33, v33, v28, s89
    v_and_or_b32 v34, v34, v28, s90
    v_and_or_b32 v35, v35, v28, s91
    buffer_store_dwordx4 v[32:35], v30, s[28:31], s99 offen offset:0 sc1
    v_add_f32 v72, v72, v89
    v_sub_f32 v73, v73, v88
    v_cvt_pk_f16_f32 v36, v72, v73
    v_add_u32 v36, 0x00020002, v36
    v_add_f32 v74, v74, v91
    v_sub_f32 v75, v75, v90
    v_cvt_pk_f16_f32 v37, v74, v75
    v_add_u32 v37, 0x00020002, v37
    v_add_f32 v76, v76, v93
    v_sub_f32 v77, v77, v92
    v_cvt_pk_f16_f32 v38, v76, v77
    v_add_u32 v38, 0x00020002, v38
    v_add_f32 v78, v78, v95
    v_sub_f32 v79, v79, v94
    v_cvt_pk_f16_f32 v39, v78, v79
    v_add_u32 v39, 0x00020002, v39
    v_permlane16_swap_b32 v36, v38
    s_nop 0
    v_permlane16_swap_b32 v37, v39
    v_and_or_b32 v36, v36, v28, s88
    v_and_or_b32 v37, v37, v28, s89
    v_and_or_b32 v38, v38, v28, s90
    v_and_or_b32 v39, v39, v28, s91
    buffer_store_dwordx4 v[36:39], v30, s[28:31], s99 offen offset:64 sc1
    s_add_u32 m0, s55, 18432
    s_mul_i32 s48, s51, 6
    s_add_u32 s48, s48, s50
    buffer_load_dwordx4 v116, s[8:11], s48 offen offset:0 lds
    buffer_load_dwordx4 v117, s[8:11], s48 offen offset:1024 lds
    buffer_load_dwordx4 v118, s[8:11], s48 offen offset:2048 lds
    s_add_u32 m0, s55, 21504
    s_mul_i32 s48, s51, 7
    s_add_u32 s48, s48, s50
    buffer_load_dwordx4 v116, s[8:11], s48 offen offset:0 lds
    buffer_load_dwordx4 v117, s[8:11], s48 offen offset:1024 lds
    buffer_load_dwordx4 v118, s[8:11], s48 offen offset:2048 lds
    s_barrier
    v_bfe_u32 v8, v0, 2, 2
    v_lshl_add_u32 v8, v2, 3, v8
    v_lshlrev_b32 v8, 6, v8
    v_and_b32 v9, 3, v0
    v_lshl_add_u32 v8, v9, 3, v8
    v_add_u32 v8, s57, v8
    v_mov_b32 v104, 0x3f803f80
    v_mov_b32 v105, 0x3f803f80
    v_mov_b32 v106, 0x3f803f80
    v_mov_b32 v107, 0x3f803f80
    s_mul_i32 s40, s35, 6144
    s_add_u32 s40, s40, s56
    s_lshl_b32 s41, s32, 11
    s_add_u32 s40, s40, s41
    s_mul_i32 s41, s100, 384
    s_lshl_b32 s42, s32, 7
    s_add_u32 s41, s41, s42
    s_add_u32 s41, s41, 8683520
    v_lshlrev_b32 v9, 4, v0
    v_lshlrev_b32 v7, 2, v0
    ds_read_b64_tr_b16 v[96:97], v8 offset:16384
    ds_read_b64_tr_b16 v[98:99], v8 offset:16640
    ds_read_b64_tr_b16 v[100:101], v8 offset:16416
    ds_read_b64_tr_b16 v[102:103], v8 offset:16672
    s_waitcnt lgkmcnt(2)
    v_mfma_f32_16x16x32_bf16 v[108:111], v[104:107], v[96:99], 0
    s_waitcnt lgkmcnt(0)
    v_mfma_f32_16x16x32_bf16 v[112:115], v[104:107], v[100:103], 0
    s_cmp_lt_u32 s35, 16
    s_cselect_b32 s42, 3, s32
    s_cmp_eq_u32 s32, s42
    s_cselect_b64 exec, 0, -1
    buffer_store_dwordx4 v[96:99], v9, s[28:31], s40 offen offset:0 sc1
    buffer_store_dwordx4 v[100:103], v9, s[28:31], s40 offen offset:1024 sc1
    s_cmp_eq_u32 s32, 3
    s_cselect_b64 exec, 0, -1
    s_mov_b32 vcc_lo, 0xffff0000
    s_mov_b32 vcc_hi, 0
    v_cndmask_b32 v108, v108, v112, vcc
    s_mov_b32 exec_hi, 0
    s_and_b32 s42, s39, 0xff
    v_and_b32 v108, 0xffffff00, v108
    v_or_b32 v108, s42, v108
    buffer_store_dword v108, v7, s[28:31], s41 offen sc1
    s_mov_b64 exec, -1
    v_mul_u32_u24 v65, 1536, v2
    s_add_u32 m0, s57, 0
    v_lshl_add_u32 v65, v1, 4, v65
    s_mul_i32 s48, s51, 0
    v_mov_b32 v66, 2147418112
    s_add_u32 s48, s48, s50
    v_cmp_gt_u32 vcc, 12, v1
    buffer_load_dwordx4 v119, s[8:11], s49 offen lds
    s_nop 0
    v_cndmask_b32 v65, v66, v65, vcc
    s_lshr_b32 s40, s32, 1
    s_lshl_b32 s41, s36, 1
    s_add_u32 s41, s41, s40
    s_mul_i32 s41, s41, 6144
    s_mul_i32 s42, s63, 192
    s_add_u32 s41, s41, s42
    s_add_u32 s52, s41, 8683520
    buffer_load_dwordx4 v117, s[8:11], s48 offen offset:1024 lds
    s_lshl_b32 s40, s40, 9
    s_add_u32 s40, s40, s42
    s_add_u32 s40, s40, 158720
    v_add_u32 v66, s40, v29
    v_lshlrev_b32 v20, 4, v0
    v_add_u32 v21, 114688, v20
    v_add_u32 v20, 65536, v20
    v_mul_u32_u24 v3, 768, v1
    buffer_load_dwordx4 v118, s[8:11], s48 offen offset:2048 lds
    v_add_u32 v12, v3, v12
    s_add_u32 m0, s57, 3072
    v_add_u32 v13, v3, v13
    s_mul_i32 s48, s51, 1
    v_add_u32 v14, v3, v14
    s_add_u32 s48, s48, s50
    v_add_u32 v15, v3, v15
    v_and_b32 v17, 31, v0
    buffer_load_dwordx4 v116, s[8:11], s48 offen offset:0 lds
    v_lshlrev_b32 v17, 2, v17
    v_lshrrev_b32 v9, 5, v0
    v_lshl_add_u32 v17, v9, 9, v17
    s_and_b32 s40, s62, 1
    s_and_b32 s41, s62, 2
    s_lshl_b32 s41, s41, 1
    s_or_b32 s40, s40, s41
    s_lshl_b32 s40, s40, 5
    buffer_load_dwordx4 v117, s[8:11], s48 offen offset:1024 lds
    v_and_b32 v16, 3, v1
    v_lshl_add_u32 v16, v16, 6, v31
    v_lshrrev_b32 v9, 2, v1
    v_mul_u32_u24 v9, 768, v9
    v_xad_u32 v16, v16, s40, v9
    s_mul_i32 s46, s62, 6144
    s_mul_i32 s41, s63, 3072
    s_add_u32 s46, s46, s41
    buffer_load_dwordx4 v118, s[8:11], s48 offen offset:2048 lds
    s_add_u32 s46, s46, s98
    s_add_u32 s48, s34, 2
    s_lshl_b32 s47, s36, 7
    s_and_b32 s48, s48, 3
    s_add_u32 s47, s47, s101
    s_add_u32 s48, s48, 2
    v_bfe_u32 v8, v0, 2, 2
    s_mul_i32 m0, s48, 3072
    v_lshl_add_u32 v8, v2, 3, v8
    s_add_u32 m0, m0, s57
    v_mul_u32_u24 v8, 192, v8
    s_mul_i32 s48, s51, s48
    v_and_b32 v9, 3, v0
    s_add_u32 s48, s48, s50
    v_lshl_add_u32 v8, v9, 3, v8
    buffer_load_dwordx4 v116, s[8:11], s48 offen offset:0 lds
    v_add_u32 v8, 65536, v8
    v_and_b32 v9, 1, v2
    v_lshlrev_b32 v9, 5, v9
    v_add_u32 v248, v8, v9
    v_sub_u32 v249, v8, v9
    v_add_u32 v250, 49152, v248
    v_add_u32 v251, 49152, v249
    v_add_u32 v68, -57344, v248
    buffer_load_dwordx4 v117, s[8:11], s48 offen offset:1024 lds
    v_add_u32 v69, -57344, v249
    v_and_b32 v64, 7, v0
    v_lshlrev_b32 v64, 7, v64
    s_lshl_b32 s45, s35, 10
    s_add_u32 s45, s45, 8519680
    s_and_b32 s44, s39, 0xff
    buffer_load_dwordx4 v118, s[8:11], s48 offen offset:2048 lds
    s_add_u32 s48, s34, 3
    s_and_b32 s48, s48, 3
    s_add_u32 s48, s48, 2
    s_mul_i32 m0, s48, 3072
    s_add_u32 m0, m0, s57
    s_mul_i32 s48, s51, s48
    s_add_u32 s48, s48, s50
    buffer_load_dwordx4 v116, s[8:11], s48 offen offset:0 lds
    buffer_load_dwordx4 v117, s[8:11], s48 offen offset:1024 lds
    buffer_load_dwordx4 v118, s[8:11], s48 offen offset:2048 lds
    s_add_u32 s48, s34, 4
    s_and_b32 s48, s48, 3
    s_add_u32 s48, s48, 2
    s_mul_i32 m0, s48, 3072
    s_add_u32 m0, m0, s57
    s_mul_i32 s48, s51, s48
    s_add_u32 s48, s48, s50
    buffer_load_dwordx4 v116, s[8:11], s48 offen offset:0 lds
    buffer_load_dwordx4 v117, s[8:11], s48 offen offset:1024 lds
    buffer_load_dwordx4 v118, s[8:11], s48 offen offset:2048 lds
    s_add_u32 s48, s34, 5
    s_and_b32 s48, s48, 3
    s_add_u32 s48, s48, 2
    s_mul_i32 m0, s48, 3072
    s_add_u32 m0, m0, s57
    s_mul_i32 s48, s51, s48
    s_add_u32 s48, s48, s50
    buffer_load_dwordx4 v116, s[8:11], s48 offen offset:0 lds
    buffer_load_dwordx4 v117, s[8:11], s48 offen offset:1024 lds
    buffer_load_dwordx4 v118, s[8:11], s48 offen offset:2048 lds
    s_waitcnt vmcnt(21)
    s_barrier
    ds_read_b64_tr_b16 v[200:201], v68 offset:0
    ds_read_b64_tr_b16 v[202:203], v68 offset:768
    ds_read_b64_tr_b16 v[204:205], v69 offset:32
    ds_read_b64_tr_b16 v[206:207], v69 offset:800
    ds_read_b64_tr_b16 v[208:209], v68 offset:64
    ds_read_b64_tr_b16 v[210:211], v68 offset:832
    ds_read_b64_tr_b16 v[212:213], v69 offset:96
    ds_read_b64_tr_b16 v[214:215], v69 offset:864
    ds_read_b64_tr_b16 v[216:217], v68 offset:128
    ds_read_b64_tr_b16 v[218:219], v68 offset:896
    ds_read_b64_tr_b16 v[220:221], v69 offset:160
    ds_read_b64_tr_b16 v[222:223], v69 offset:928
    ds_read_b64_tr_b16 v[176:177], v248 offset:18432
    ds_read_b64_tr_b16 v[178:179], v248 offset:19200
    ds_read_b64_tr_b16 v[180:181], v249 offset:18464
    ds_read_b64_tr_b16 v[182:183], v249 offset:19232
    ds_read_b64_tr_b16 v[184:185], v248 offset:18496
    ds_read_b64_tr_b16 v[186:187], v248 offset:19264
    ds_read_b64_tr_b16 v[188:189], v249 offset:18528
    ds_read_b64_tr_b16 v[190:191], v249 offset:19296
    ds_read_b64_tr_b16 v[192:193], v248 offset:18560
    ds_read_b64_tr_b16 v[194:195], v248 offset:19328
    ds_read_b64_tr_b16 v[196:197], v249 offset:18592
    ds_read_b64_tr_b16 v[198:199], v249 offset:19360
    ds_read_b64_tr_b16 v[224:225], v248 offset:43008
    ds_read_b64_tr_b16 v[226:227], v248 offset:43776
    ds_read_b64_tr_b16 v[228:229], v249 offset:43040
    ds_read_b64_tr_b16 v[230:231], v249 offset:43808
    ds_read_b64_tr_b16 v[232:233], v248 offset:43072
    ds_read_b64_tr_b16 v[234:235], v248 offset:43840
    ds_read_b64_tr_b16 v[236:237], v249 offset:43104
    ds_read_b64_tr_b16 v[238:239], v249 offset:43872
    ds_read_b64_tr_b16 v[240:241], v248 offset:43136
    ds_read_b64_tr_b16 v[242:243], v248 offset:43904
    ds_read_b64_tr_b16 v[244:245], v249 offset:43168
    ds_read_b64_tr_b16 v[246:247], v249 offset:43936
    ds_read_b64_tr_b16 v[128:129], v250 offset:18432
    ds_read_b64_tr_b16 v[130:131], v250 offset:19200
    ds_read_b64_tr_b16 v[132:133], v251 offset:18464
    ds_read_b64_tr_b16 v[134:135], v251 offset:19232
    ds_read_b64_tr_b16 v[136:137], v250 offset:18496
    ds_read_b64_tr_b16 v[138:139], v250 offset:19264
    ds_read_b64_tr_b16 v[140:141], v251 offset:18528
    ds_read_b64_tr_b16 v[142:143], v251 offset:19296
    ds_read_b64_tr_b16 v[144:145], v250 offset:18560
    ds_read_b64_tr_b16 v[146:147], v250 offset:19328
    ds_read_b64_tr_b16 v[148:149], v251 offset:18592
    ds_read_b64_tr_b16 v[150:151], v251 offset:19360
    s_lshl_b32 s40, s100, 7
    s_lshl_b32 s41, s32, 2
    s_add_u32 s40, s40, s41
    s_add_u32 s40, s40, 8585216
    v_mov_b32 v3, 0
    v_mov_b32 v9, s39
    s_waitcnt vmcnt(18)
    s_mov_b64 exec, 1
    buffer_store_dword v9, v3, s[28:31], s40 offen sc1
    s_mov_b64 exec, -1
    s_mov_b32 exec_lo, 0x0fff0fff
    s_mov_b32 exec_hi, 0x0fff0fff
    buffer_load_dwordx4 v[96:99], v65, s[28:31], s52 offen offset:0 sc1
    buffer_load_dwordx4 v[100:103], v65, s[28:31], s52 offen offset:384 sc1
    buffer_load_dwordx4 v[104:107], v65, s[28:31], s52 offen offset:768 sc1
    buffer_load_dwordx4 v[108:111], v65, s[28:31], s52 offen offset:1152 sc1
    buffer_load_dword v112, v64, s[28:31], s45 offen sc1
    s_mov_b64 exec, -1
    v_lshrrev_b32 v22, 5, v0
    v_and_b32 v23, 31, v0
    v_lshlrev_b32 v23, 7, v23
    v_lshl_add_u32 v22, v22, 18, v23
    s_and_b32 s34, s36, 7
    s_mul_i32 s34, s34, 524288
    s_lshl_b32 s40, s63, 22
    s_add_u32 s34, s34, s40
    s_lshl_b32 s40, s62, 12
    s_add_u32 s34, s34, s40
    s_waitcnt vmcnt(6)
    s_waitcnt lgkmcnt(0)
    s_barrier
    buffer_load_dword v23, v22, s[12:15], s34 offen
    ds_read_b64_tr_b16 v[152:153], v248 offset:0
    ds_read_b64_tr_b16 v[154:155], v248 offset:768
    ds_read_b64_tr_b16 v[156:157], v249 offset:32
    ds_read_b64_tr_b16 v[158:159], v249 offset:800
    ds_read_b64_tr_b16 v[160:161], v248 offset:64
    ds_read_b64_tr_b16 v[162:163], v248 offset:832
    s_mov_b32 exec_lo, 0x0fff0fff
    s_mov_b32 exec_hi, 0x0fff0fff
    s_waitcnt vmcnt(5)
    v_xor_b32 v96, s44, v96
    v_xor_b32 v97, s44, v97
    v_xor_b32 v98, s44, v98
    v_xor_b32 v99, s44, v99
    s_waitcnt vmcnt(4)
    v_xor_b32 v100, s44, v100
    v_xor_b32 v101, s44, v101
    v_xor_b32 v102, s44, v102
    v_xor_b32 v103, s44, v103
    s_waitcnt vmcnt(3)
    v_xor_b32 v104, s44, v104
    v_xor_b32 v105, s44, v105
    v_xor_b32 v106, s44, v106
    v_xor_b32 v107, s44, v107
    s_waitcnt vmcnt(2)
    v_xor_b32 v108, s44, v108
    v_xor_b32 v109, s44, v109
    v_xor_b32 v110, s44, v110
    v_xor_b32 v111, s44, v111
    s_waitcnt vmcnt(1)
    v_subrev_u32 v112, s39, v112
    v_lshrrev_b32 v113, 4, v112
    v_min_u32 v113, 1, v113
    v_or3_b32 v3, v96, v97, v98
    v_or3_b32 v3, v3, v99, v100
    v_or3_b32 v3, v3, v101, v102
    v_or3_b32 v3, v3, v103, v104
    v_or3_b32 v3, v3, v105, v106
    v_or3_b32 v3, v3, v107, v108
    v_or3_b32 v3, v3, v109, v110
    v_or3_b32 v3, v3, v111, v113
    v_and_b32 v3, 0xff, v3
    v_cmp_ne_u32 vcc, 0, v3
    s_cbranch_vccnz L_rt1
L_ok1:
    s_getreg_b32 s40, hwreg(HW_REG_XCC_ID, 0, 4)
    v_cmp_ne_u32 vcc, s40, v112
    s_nop 0
    s_cmp_eq_u64 vcc, 0
    s_cselect_b32 s33, 1, 0
    s_mov_b64 exec, -1
    v_add_f32 v96, v96, v100
    v_add_f32 v104, v104, v108
    v_add_f32 v97, v97, v101
    v_add_f32 v105, v105, v109
    v_add_f32 v98, v98, v102
    v_add_f32 v106, v106, v110
    v_add_f32 v99, v99, v103
    v_add_f32 v107, v107, v111
    v_add_f32 v96, v96, v104
    v_add_f32 v97, v97, v105
    v_add_f32 v98, v98, v106
    v_add_f32 v99, v99, v107
    v_mov_b32 v100, v96
    v_mov_b32 v101, v97
    v_mov_b32 v102, v98
    v_mov_b32 v103, v99
    v_permlane16_swap_b32 v96, v100
    v_permlane16_swap_b32 v97, v101
    v_permlane16_swap_b32 v98, v102
    v_permlane16_swap_b32 v99, v103
    v_add_f32 v96, v96, v100
    v_add_f32 v97, v97, v101
    v_add_f32 v98, v98, v102
    v_add_f32 v99, v99, v103
    v_mov_b32 v100, v96
    v_mov_b32 v101, v97
    v_mov_b32 v102, v98
    v_mov_b32 v103, v99
    v_permlane32_swap_b32 v96, v100
    v_permlane32_swap_b32 v97, v101
    v_permlane32_swap_b32 v98, v102
    v_permlane32_swap_b32 v99, v103
    v_add_f32 v96, v96, v100
    v_add_f32 v97, v97, v101
    v_add_f32 v98, v98, v102
    v_add_f32 v99, v99, v103
    s_setprio 3
    s_mov_b64 exec, 0xfff
    ds_write_b128 v66, v[96:99]
    s_mov_b64 exec, -1
    s_setprio 0
    s_waitcnt lgkmcnt(0)
    s_barrier
    ds_read_b128 v[76:79], v15 offset:0
    ds_read_b128 v[108:111], v15 offset:512
    ds_read_b128 v[64:67], v12 offset:0
    ds_read_b128 v[68:71], v13 offset:0
    ds_read_b128 v[72:75], v14 offset:0
    ds_read_b128 v[80:83], v12 offset:256
    ds_read_b128 v[84:87], v13 offset:256
    ds_read_b128 v[88:91], v14 offset:256
    ds_read_b128 v[96:99], v12 offset:512
    ds_read_b128 v[100:103], v13 offset:512
    ds_read_b128 v[124:127], v15 offset:768
    ds_read_b128 v[104:107], v14 offset:512
    ds_read_b128 v[92:95], v15 offset:256
    ds_read_b128 v[112:115], v12 offset:768
    ds_read_b128 v[116:119], v13 offset:768
    ds_read_b128 v[120:123], v14 offset:768
    s_waitcnt lgkmcnt(15)
    v_mfma_f32_16x16x32_bf16 v[32:35], v[176:179], v[76:79], 0
    ds_read_b64_tr_b16 v[164:165], v249 offset:96
    v_mfma_f32_16x16x32_bf16 v[36:39], v[180:183], v[76:79], 0
    ds_read_b64_tr_b16 v[166:167], v249 offset:864
    v_mfma_f32_16x16x32_bf16 v[40:43], v[184:187], v[76:79], 0
    v_mfma_f32_16x16x32_bf16 v[44:47], v[188:191], v[76:79], 0
    ds_read_b64_tr_b16 v[168:169], v248 offset:128
    v_mfma_f32_16x16x32_bf16 v[48:51], v[192:195], v[76:79], 0
    ds_read_b64_tr_b16 v[170:171], v248 offset:896
    s_waitcnt lgkmcnt(4)
    s_barrier
    v_mfma_f32_16x16x32_bf16 v[52:55], v[196:199], v[76:79], 0
    v_mfma_f32_16x16x32_bf16 v[32:35], v[128:131], v[108:111], v[32:35]
    ds_read_b64_tr_b16 v[172:173], v249 offset:160
    v_mfma_f32_16x16x32_bf16 v[36:39], v[132:135], v[108:111], v[36:39]
    ds_read_b64_tr_b16 v[174:175], v249 offset:928
    v_mfma_f32_16x16x32_bf16 v[40:43], v[136:139], v[108:111], v[40:43]
    v_mfma_f32_16x16x32_bf16 v[44:47], v[140:143], v[108:111], v[44:47]
    ds_read_b64_tr_b16 v[128:129], v248 offset:6144
    ds_read_b64_tr_b16 v[130:131], v248 offset:6912
    v_mfma_f32_16x16x32_bf16 v[56:59], v[76:79], v[76:79], 0
    ds_read_b64_tr_b16 v[132:133], v249 offset:6176
    v_mfma_f32_16x16x32_bf16 v[48:51], v[144:147], v[108:111], v[48:51]
    ds_read_b64_tr_b16 v[134:135], v249 offset:6944
    v_mfma_f32_16x16x32_bf16 v[60:63], v[24:27], v[76:79], 0
    ds_read_b64_tr_b16 v[136:137], v248 offset:6208
    v_mfma_f32_16x16x32_bf16 v[52:55], v[148:151], v[108:111], v[52:55]
    ds_read_b64_tr_b16 v[138:139], v248 offset:6976
    v_mfma_f32_16x16x32_bf16 v[32:35], v[152:155], v[64:67], v[32:35]
    ds_read_b64_tr_b16 v[140:141], v249 offset:6240
    ds_read_b64_tr_b16 v[142:143], v249 offset:7008
    v_mfma_f32_16x16x32_bf16 v[56:59], v[108:111], v[108:111], v[56:59]
    ds_read_b64_tr_b16 v[144:145], v248 offset:6272
    v_mfma_f32_16x16x32_bf16 v[36:39], v[156:159], v[64:67], v[36:39]
    ds_read_b64_tr_b16 v[146:147], v248 offset:7040
    v_mfma_f32_16x16x32_bf16 v[60:63], v[24:27], v[108:111], v[60:63]
    ds_read_b64_tr_b16 v[148:149], v249 offset:6304
    v_mfma_f32_16x16x32_bf16 v[40:43], v[160:163], v[64:67], v[40:43]
    ds_read_b64_tr_b16 v[150:151], v249 offset:7072
    s_waitcnt lgkmcnt(12)
    v_mfma_f32_16x16x32_bf16 v[44:47], v[164:167], v[64:67], v[44:47]
    ds_read_b64_tr_b16 v[152:153], v248 offset:12288
    ds_read_b64_tr_b16 v[154:155], v248 offset:13056
    v_mfma_f32_16x16x32_bf16 v[56:59], v[64:67], v[64:67], v[56:59]
    ds_read_b64_tr_b16 v[156:157], v249 offset:12320
    v_lshlrev_b32 v3, 4, v2
    v_mfma_f32_16x16x32_bf16 v[48:51], v[168:171], v[64:67], v[48:51]
    ds_read_b64_tr_b16 v[158:159], v249 offset:13088
    v_add_u32 v3, 158720, v3
    v_mfma_f32_16x16x32_bf16 v[60:63], v[24:27], v[64:67], v[60:63]
    ds_read_b64_tr_b16 v[160:161], v248 offset:12352
    ds_read_b128 v[176:179], v3 offset:512
    v_mfma_f32_16x16x32_bf16 v[52:55], v[172:175], v[64:67], v[52:55]
    ds_read_b64_tr_b16 v[162:163], v248 offset:13120
    ds_read_b128 v[180:183], v3 offset:576
    s_waitcnt lgkmcnt(14)
    v_mfma_f32_16x16x32_bf16 v[32:35], v[128:131], v[68:71], v[32:35]
    ds_read_b64_tr_b16 v[164:165], v249 offset:12384
    ds_read_b64_tr_b16 v[166:167], v249 offset:13152
    v_mfma_f32_16x16x32_bf16 v[56:59], v[68:71], v[68:71], v[56:59]
    ds_read_b64_tr_b16 v[168:169], v248 offset:12416
    ds_read_b128 v[184:187], v3 offset:640
    v_mfma_f32_16x16x32_bf16 v[36:39], v[132:135], v[68:71], v[36:39]
    ds_read_b64_tr_b16 v[170:171], v248 offset:13184
    ds_read_b128 v[188:191], v3 offset:704
    v_mfma_f32_16x16x32_bf16 v[60:63], v[24:27], v[68:71], v[60:63]
    ds_read_b64_tr_b16 v[172:173], v249 offset:12448
    ds_read_b128 v[192:195], v3 offset:768
    v_mfma_f32_16x16x32_bf16 v[40:43], v[136:139], v[68:71], v[40:43]
    ds_read_b64_tr_b16 v[174:175], v249 offset:13216
    ds_read_b128 v[196:199], v3 offset:832
    s_waitcnt lgkmcnt(15)
    v_mfma_f32_16x16x32_bf16 v[44:47], v[140:143], v[68:71], v[44:47]
    ds_read_b64_tr_b16 v[128:129], v248 offset:24576
    ds_read_b64_tr_b16 v[130:131], v248 offset:25344
    v_mfma_f32_16x16x32_bf16 v[56:59], v[72:75], v[72:75], v[56:59]
    ds_read_b64_tr_b16 v[132:133], v249 offset:24608
    v_mfma_f32_16x16x32_bf16 v[48:51], v[144:147], v[68:71], v[48:51]
    ds_read_b64_tr_b16 v[134:135], v249 offset:25376
    v_mfma_f32_16x16x32_bf16 v[60:63], v[24:27], v[72:75], v[60:63]
    ds_read_b64_tr_b16 v[136:137], v248 offset:24640
    v_mfma_f32_16x16x32_bf16 v[52:55], v[148:151], v[68:71], v[52:55]
    ds_read_b64_tr_b16 v[138:139], v248 offset:25408
    s_waitcnt lgkmcnt(15)
    v_mfma_f32_16x16x32_bf16 v[32:35], v[152:155], v[72:75], v[32:35]
    ds_read_b64_tr_b16 v[140:141], v249 offset:24672
    ds_read_b64_tr_b16 v[142:143], v249 offset:25440
    v_mfma_f32_16x16x32_bf16 v[56:59], v[80:83], v[80:83], v[56:59]
    ds_read_b64_tr_b16 v[144:145], v248 offset:24704
    v_mfma_f32_16x16x32_bf16 v[36:39], v[156:159], v[72:75], v[36:39]
    ds_read_b64_tr_b16 v[146:147], v248 offset:25472
    v_mfma_f32_16x16x32_bf16 v[60:63], v[24:27], v[80:83], v[60:63]
    ds_read_b64_tr_b16 v[148:149], v249 offset:24736
    v_mfma_f32_16x16x32_bf16 v[40:43], v[160:163], v[72:75], v[40:43]
    ds_read_b64_tr_b16 v[150:151], v249 offset:25504
    s_waitcnt lgkmcnt(13)
    v_mfma_f32_16x16x32_bf16 v[44:47], v[164:167], v[72:75], v[44:47]
    ds_read_b64_tr_b16 v[152:153], v248 offset:30720
    ds_read_b64_tr_b16 v[154:155], v248 offset:31488
    v_mfma_f32_16x16x32_bf16 v[56:59], v[84:87], v[84:87], v[56:59]
    ds_read_b64_tr_b16 v[156:157], v249 offset:30752
    v_mfma_f32_16x16x32_bf16 v[48:51], v[168:171], v[72:75], v[48:51]
    ds_read_b64_tr_b16 v[158:159], v249 offset:31520
    v_mfma_f32_16x16x32_bf16 v[60:63], v[24:27], v[84:87], v[60:63]
    ds_read_b64_tr_b16 v[160:161], v248 offset:30784
    v_mfma_f32_16x16x32_bf16 v[52:55], v[172:175], v[72:75], v[52:55]
    ds_read_b64_tr_b16 v[162:163], v248 offset:31552
    s_waitcnt lgkmcnt(12)
    v_mfma_f32_16x16x32_bf16 v[32:35], v[128:131], v[80:83], v[32:35]
    ds_read_b64_tr_b16 v[164:165], v249 offset:30816
    ds_read_b64_tr_b16 v[166:167], v249 offset:31584
    v_mfma_f32_16x16x32_bf16 v[56:59], v[88:91], v[88:91], v[56:59]
    ds_read_b64_tr_b16 v[168:169], v248 offset:30848
    v_mfma_f32_16x16x32_bf16 v[36:39], v[132:135], v[80:83], v[36:39]
    ds_read_b64_tr_b16 v[170:171], v248 offset:31616
    v_mfma_f32_16x16x32_bf16 v[60:63], v[24:27], v[88:91], v[60:63]
    ds_read_b64_tr_b16 v[172:173], v249 offset:30880
    v_mfma_f32_16x16x32_bf16 v[40:43], v[136:139], v[80:83], v[40:43]
    ds_read_b64_tr_b16 v[174:175], v249 offset:31648
    s_waitcnt lgkmcnt(12)
    v_mfma_f32_16x16x32_bf16 v[44:47], v[140:143], v[80:83], v[44:47]
    ds_read_b64_tr_b16 v[128:129], v248 offset:36864
    ds_read_b64_tr_b16 v[130:131], v248 offset:37632
    v_mfma_f32_16x16x32_bf16 v[56:59], v[96:99], v[96:99], v[56:59]
    ds_read_b64_tr_b16 v[132:133], v249 offset:36896
    v_mfma_f32_16x16x32_bf16 v[48:51], v[144:147], v[80:83], v[48:51]
    ds_read_b64_tr_b16 v[134:135], v249 offset:37664
    v_mfma_f32_16x16x32_bf16 v[60:63], v[24:27], v[96:99], v[60:63]
    ds_read_b64_tr_b16 v[136:137], v248 offset:36928
    v_mfma_f32_16x16x32_bf16 v[52:55], v[148:151], v[80:83], v[52:55]
    ds_read_b64_tr_b16 v[138:139], v248 offset:37696
    s_waitcnt lgkmcnt(12)
    v_mfma_f32_16x16x32_bf16 v[32:35], v[152:155], v[84:87], v[32:35]
    ds_read_b64_tr_b16 v[140:141], v249 offset:36960
    ds_read_b64_tr_b16 v[142:143], v249 offset:37728
    v_mfma_f32_16x16x32_bf16 v[56:59], v[100:103], v[100:103], v[56:59]
    ds_read_b64_tr_b16 v[144:145], v248 offset:36992
    v_mfma_f32_16x16x32_bf16 v[36:39], v[156:159], v[84:87], v[36:39]
    ds_read_b64_tr_b16 v[146:147], v248 offset:37760
    v_mfma_f32_16x16x32_bf16 v[60:63], v[24:27], v[100:103], v[60:63]
    ds_read_b64_tr_b16 v[148:149], v249 offset:37024
    v_mfma_f32_16x16x32_bf16 v[40:43], v[160:163], v[84:87], v[40:43]
    ds_read_b64_tr_b16 v[150:151], v249 offset:37792
    s_waitcnt lgkmcnt(12)
    v_mfma_f32_16x16x32_bf16 v[44:47], v[164:167], v[84:87], v[44:47]
    ds_read_b64_tr_b16 v[152:153], v250 offset:0
    ds_read_b64_tr_b16 v[154:155], v250 offset:768
    v_mfma_f32_16x16x32_bf16 v[56:59], v[124:127], v[124:127], v[56:59]
    ds_read_b64_tr_b16 v[156:157], v251 offset:32
    v_mfma_f32_16x16x32_bf16 v[48:51], v[168:171], v[84:87], v[48:51]
    ds_read_b64_tr_b16 v[158:159], v251 offset:800
    v_mfma_f32_16x16x32_bf16 v[60:63], v[24:27], v[124:127], v[60:63]
    ds_read_b64_tr_b16 v[160:161], v250 offset:64
    v_mfma_f32_16x16x32_bf16 v[52:55], v[172:175], v[84:87], v[52:55]
    ds_read_b64_tr_b16 v[162:163], v250 offset:832
    s_waitcnt lgkmcnt(12)
    v_mfma_f32_16x16x32_bf16 v[32:35], v[128:131], v[88:91], v[32:35]
    ds_read_b64_tr_b16 v[164:165], v251 offset:96
    ds_read_b64_tr_b16 v[166:167], v251 offset:864
    v_mfma_f32_16x16x32_bf16 v[56:59], v[104:107], v[104:107], v[56:59]
    ds_read_b64_tr_b16 v[168:169], v250 offset:128
    v_mfma_f32_16x16x32_bf16 v[36:39], v[132:135], v[88:91], v[36:39]
    ds_read_b64_tr_b16 v[170:171], v250 offset:896
    v_mfma_f32_16x16x32_bf16 v[60:63], v[24:27], v[104:107], v[60:63]
    ds_read_b64_tr_b16 v[172:173], v251 offset:160
    v_mfma_f32_16x16x32_bf16 v[40:43], v[136:139], v[88:91], v[40:43]
    ds_read_b64_tr_b16 v[174:175], v251 offset:928
    s_waitcnt lgkmcnt(12)
    v_mfma_f32_16x16x32_bf16 v[44:47], v[140:143], v[88:91], v[44:47]
    ds_read_b64_tr_b16 v[128:129], v250 offset:6144
    ds_read_b64_tr_b16 v[130:131], v250 offset:6912
    s_barrier
    v_mfma_f32_16x16x32_bf16 v[56:59], v[92:95], v[92:95], v[56:59]
    ds_read_b64_tr_b16 v[132:133], v251 offset:6176
    v_mfma_f32_16x16x32_bf16 v[48:51], v[144:147], v[88:91], v[48:51]
    ds_read_b64_tr_b16 v[134:135], v251 offset:6944
    v_mfma_f32_16x16x32_bf16 v[60:63], v[24:27], v[92:95], v[60:63]
    ds_read_b64_tr_b16 v[136:137], v250 offset:6208
    v_mfma_f32_16x16x32_bf16 v[52:55], v[148:151], v[88:91], v[52:55]
    ds_read_b64_tr_b16 v[138:139], v250 offset:6976
    s_waitcnt lgkmcnt(12)
    v_mfma_f32_16x16x32_bf16 v[32:35], v[152:155], v[96:99], v[32:35]
    ds_read_b64_tr_b16 v[140:141], v251 offset:6240
    ds_read_b64_tr_b16 v[142:143], v251 offset:7008
    v_mfma_f32_16x16x32_bf16 v[56:59], v[112:115], v[112:115], v[56:59]
    ds_read_b64_tr_b16 v[144:145], v250 offset:6272
    v_mfma_f32_16x16x32_bf16 v[36:39], v[156:159], v[96:99], v[36:39]
    ds_read_b64_tr_b16 v[146:147], v250 offset:7040
    v_mfma_f32_16x16x32_bf16 v[60:63], v[24:27], v[112:115], v[60:63]
    ds_read_b64_tr_b16 v[148:149], v251 offset:6304
    v_mfma_f32_16x16x32_bf16 v[40:43], v[160:163], v[96:99], v[40:43]
    ds_read_b64_tr_b16 v[150:151], v251 offset:7072
    s_waitcnt lgkmcnt(12)
    v_mfma_f32_16x16x32_bf16 v[44:47], v[164:167], v[96:99], v[44:47]
    ds_read_b64_tr_b16 v[152:153], v250 offset:12288
    ds_read_b64_tr_b16 v[154:155], v250 offset:13056
    v_mfma_f32_16x16x32_bf16 v[56:59], v[116:119], v[116:119], v[56:59]
    ds_read_b64_tr_b16 v[156:157], v251 offset:12320
    v_mfma_f32_16x16x32_bf16 v[48:51], v[168:171], v[96:99], v[48:51]
    ds_read_b64_tr_b16 v[158:159], v251 offset:13088
    v_mfma_f32_16x16x32_bf16 v[60:63], v[24:27], v[116:119], v[60:63]
    ds_read_b64_tr_b16 v[160:161], v250 offset:12352
    v_mfma_f32_16x16x32_bf16 v[52:55], v[172:175], v[96:99], v[52:55]
    ds_read_b64_tr_b16 v[162:163], v250 offset:13120
    s_waitcnt lgkmcnt(12)
    v_mfma_f32_16x16x32_bf16 v[32:35], v[128:131], v[100:103], v[32:35]
    ds_read_b64_tr_b16 v[164:165], v251 offset:12384
    ds_read_b64_tr_b16 v[166:167], v251 offset:13152
    v_mfma_f32_16x16x32_bf16 v[56:59], v[120:123], v[120:123], v[56:59]
    ds_read_b64_tr_b16 v[168:169], v250 offset:12416
    v_mfma_f32_16x16x32_bf16 v[36:39], v[132:135], v[100:103], v[36:39]
    ds_read_b64_tr_b16 v[170:171], v250 offset:13184
    v_mfma_f32_16x16x32_bf16 v[60:63], v[24:27], v[120:123], v[60:63]
    ds_read_b64_tr_b16 v[172:173], v251 offset:12448
    v_mfma_f32_16x16x32_bf16 v[40:43], v[136:139], v[100:103], v[40:43]
    ds_read_b64_tr_b16 v[174:175], v251 offset:13216
    s_waitcnt lgkmcnt(12)
    v_mfma_f32_16x16x32_bf16 v[44:47], v[140:143], v[100:103], v[44:47]
    ds_read_b64_tr_b16 v[128:129], v250 offset:24576
    ds_read_b64_tr_b16 v[130:131], v250 offset:25344
    v_mfma_f32_16x16x32_bf16 v[48:51], v[144:147], v[100:103], v[48:51]
    ds_read_b64_tr_b16 v[132:133], v251 offset:24608
    ds_read_b64_tr_b16 v[134:135], v251 offset:25376
    v_mfma_f32_16x16x32_bf16 v[52:55], v[148:151], v[100:103], v[52:55]
    ds_read_b64_tr_b16 v[136:137], v250 offset:24640
    ds_read_b64_tr_b16 v[138:139], v250 offset:25408
    s_waitcnt lgkmcnt(12)
    v_mfma_f32_16x16x32_bf16 v[32:35], v[200:203], v[124:127], v[32:35]
    ds_read_b64_tr_b16 v[140:141], v251 offset:24672
    ds_read_b64_tr_b16 v[142:143], v251 offset:25440
    v_mfma_f32_16x16x32_bf16 v[36:39], v[204:207], v[124:127], v[36:39]
    ds_read_b64_tr_b16 v[144:145], v250 offset:24704
    s_mov_b32 vcc_lo, 0x22222222
    v_mfma_f32_16x16x32_bf16 v[32:35], v[152:155], v[104:107], v[32:35]
    ds_read_b64_tr_b16 v[146:147], v250 offset:25472
    s_mov_b32 vcc_hi, 0x22222222
    v_mfma_f32_16x16x32_bf16 v[36:39], v[156:159], v[104:107], v[36:39]
    ds_read_b64_tr_b16 v[148:149], v251 offset:24736
    v_cndmask_b32 v8, v56, v57, vcc
    v_mfma_f32_16x16x32_bf16 v[40:43], v[160:163], v[104:107], v[40:43]
    ds_read_b64_tr_b16 v[150:151], v251 offset:25504
    s_mov_b32 vcc_lo, 0x44444444
    s_waitcnt lgkmcnt(12)
    v_mfma_f32_16x16x32_bf16 v[40:43], v[208:211], v[124:127], v[40:43]
    ds_read_b64_tr_b16 v[152:153], v250 offset:30720
    ds_read_b64_tr_b16 v[154:155], v250 offset:31488
    v_mfma_f32_16x16x32_bf16 v[44:47], v[212:215], v[124:127], v[44:47]
    ds_read_b64_tr_b16 v[156:157], v251 offset:30752
    s_mov_b32 vcc_hi, 0x44444444
    v_mfma_f32_16x16x32_bf16 v[44:47], v[164:167], v[104:107], v[44:47]
    ds_read_b64_tr_b16 v[158:159], v251 offset:31520
    v_cndmask_b32 v8, v8, v58, vcc
    v_mfma_f32_16x16x32_bf16 v[48:51], v[168:171], v[104:107], v[48:51]
    ds_read_b64_tr_b16 v[160:161], v250 offset:30784
    s_mov_b32 vcc_lo, 0x88888888
    v_mfma_f32_16x16x32_bf16 v[52:55], v[172:175], v[104:107], v[52:55]
    ds_read_b64_tr_b16 v[162:163], v250 offset:31552
    s_mov_b32 vcc_hi, 0x88888888
    s_waitcnt lgkmcnt(12)
    v_mfma_f32_16x16x32_bf16 v[48:51], v[216:219], v[124:127], v[48:51]
    ds_read_b64_tr_b16 v[164:165], v251 offset:30816
    ds_read_b64_tr_b16 v[166:167], v251 offset:31584
    v_mfma_f32_16x16x32_bf16 v[52:55], v[220:223], v[124:127], v[52:55]
    ds_read_b64_tr_b16 v[168:169], v250 offset:30848
    v_cndmask_b32 v8, v8, v59, vcc
    v_mfma_f32_16x16x32_bf16 v[32:35], v[128:131], v[112:115], v[32:35]
    ds_read_b64_tr_b16 v[170:171], v250 offset:31616
    s_mov_b32 vcc_lo, 0x00f0000f
    v_mfma_f32_16x16x32_bf16 v[36:39], v[132:135], v[112:115], v[36:39]
    ds_read_b64_tr_b16 v[172:173], v251 offset:30880
    s_mov_b32 vcc_hi, 0xf0000f00
    v_mfma_f32_16x16x32_bf16 v[40:43], v[136:139], v[112:115], v[40:43]
    ds_read_b64_tr_b16 v[174:175], v251 offset:31648
    v_cndmask_b32 v8, 0, v8, vcc
    s_waitcnt lgkmcnt(12)
    v_mfma_f32_16x16x32_bf16 v[32:35], v[224:227], v[92:95], v[32:35]
    ds_read_b64_tr_b16 v[128:129], v250 offset:36864
    ds_read_b64_tr_b16 v[130:131], v250 offset:37632
    v_mfma_f32_16x16x32_bf16 v[36:39], v[228:231], v[92:95], v[36:39]
    ds_read_b64_tr_b16 v[132:133], v251 offset:36896
    v_mov_b32 v9, v8
    v_mfma_f32_16x16x32_bf16 v[44:47], v[140:143], v[112:115], v[44:47]
    ds_read_b64_tr_b16 v[134:135], v251 offset:37664
    v_mul_f32 v11, 0xbb000000, v60
    v_mfma_f32_16x16x32_bf16 v[48:51], v[144:147], v[112:115], v[48:51]
    ds_read_b64_tr_b16 v[136:137], v250 offset:36928
    v_permlane16_swap_b32 v8, v9
    v_mfma_f32_16x16x32_bf16 v[52:55], v[148:151], v[112:115], v[52:55]
    ds_read_b64_tr_b16 v[138:139], v250 offset:37696
    v_add_f32 v8, v8, v9
    s_waitcnt lgkmcnt(12)
    v_mfma_f32_16x16x32_bf16 v[40:43], v[232:235], v[92:95], v[40:43]
    ds_read_b64_tr_b16 v[140:141], v251 offset:36960
    ds_read_b64_tr_b16 v[142:143], v251 offset:37728
    v_mfma_f32_16x16x32_bf16 v[44:47], v[236:239], v[92:95], v[44:47]
    ds_read_b64_tr_b16 v[144:145], v250 offset:36992
    v_mov_b32 v9, v8
    v_mfma_f32_16x16x32_bf16 v[32:35], v[152:155], v[116:119], v[32:35]
    ds_read_b64_tr_b16 v[146:147], v250 offset:37760
    v_permlane32_swap_b32 v8, v9
    v_mfma_f32_16x16x32_bf16 v[36:39], v[156:159], v[116:119], v[36:39]
    ds_read_b64_tr_b16 v[148:149], v251 offset:37024
    v_add_f32 v8, v8, v9
    v_mfma_f32_16x16x32_bf16 v[40:43], v[160:163], v[116:119], v[40:43]
    ds_read_b64_tr_b16 v[150:151], v251 offset:37792
    v_mul_f32 v8, 0x3b000000, v8
    s_waitcnt lgkmcnt(12)
    v_mfma_f32_16x16x32_bf16 v[48:51], v[240:243], v[92:95], v[48:51]
    v_fma_f32 v8, -v11, v11, v8
    v_max_f32 v8, 0, v8
    v_mfma_f32_16x16x32_bf16 v[52:55], v[244:247], v[92:95], v[52:55]
    v_add_f32 v8, 0x3727c5ac, v8
    v_rsq_f32 v10, v8
    v_mfma_f32_16x16x32_bf16 v[44:47], v[164:167], v[116:119], v[44:47]
    v_mfma_f32_16x16x32_bf16 v[48:51], v[168:171], v[116:119], v[48:51]
    v_mfma_f32_16x16x32_bf16 v[52:55], v[172:175], v[116:119], v[52:55]
    s_waitcnt lgkmcnt(6)
    v_mfma_f32_16x16x32_bf16 v[32:35], v[128:131], v[120:123], v[32:35]
    v_mfma_f32_16x16x32_bf16 v[36:39], v[132:135], v[120:123], v[36:39]
    v_mfma_f32_16x16x32_bf16 v[40:43], v[136:139], v[120:123], v[40:43]
    s_waitcnt lgkmcnt(0)
    v_mfma_f32_16x16x32_bf16 v[44:47], v[140:143], v[120:123], v[44:47]
    v_mfma_f32_16x16x32_bf16 v[48:51], v[144:147], v[120:123], v[48:51]
    v_mfma_f32_16x16x32_bf16 v[52:55], v[148:151], v[120:123], v[52:55]
    v_lshlrev_b32 v3, 4, v2
    v_add_u32 v3, 158720, v3
    ds_read_b128 v[200:203], v3 offset:0
    ds_read_b128 v[204:207], v3 offset:64
    ds_read_b128 v[208:211], v3 offset:128
    ds_read_b128 v[212:215], v3 offset:192
    ds_read_b128 v[216:219], v3 offset:256
    ds_read_b128 v[220:223], v3 offset:320
    v_mov_b32 v8, 0xbdd2d3e8
    v_mov_b32 v9, 0xc0135761
    v_pk_fma_f32 v[32:33], v[176:177], v[10:11], v[32:33] op_sel:[0,1,0] op_sel_hi:[1,1,1]
    v_pk_fma_f32 v[34:35], v[178:179], v[10:11], v[34:35] op_sel:[0,1,0] op_sel_hi:[1,1,1]
    v_pk_fma_f32 v[36:37], v[180:181], v[10:11], v[36:37] op_sel:[0,1,0] op_sel_hi:[1,1,1]
    v_pk_fma_f32 v[38:39], v[182:183], v[10:11], v[38:39] op_sel:[0,1,0] op_sel_hi:[1,1,1]
    v_pk_fma_f32 v[40:41], v[184:185], v[10:11], v[40:41] op_sel:[0,1,0] op_sel_hi:[1,1,1]
    v_pk_fma_f32 v[42:43], v[186:187], v[10:11], v[42:43] op_sel:[0,1,0] op_sel_hi:[1,1,1]
    v_pk_fma_f32 v[44:45], v[188:189], v[10:11], v[44:45] op_sel:[0,1,0] op_sel_hi:[1,1,1]
    v_pk_fma_f32 v[46:47], v[190:191], v[10:11], v[46:47] op_sel:[0,1,0] op_sel_hi:[1,1,1]
    v_pk_fma_f32 v[48:49], v[192:193], v[10:11], v[48:49] op_sel:[0,1,0] op_sel_hi:[1,1,1]
    v_pk_fma_f32 v[50:51], v[194:195], v[10:11], v[50:51] op_sel:[0,1,0] op_sel_hi:[1,1,1]
    v_pk_fma_f32 v[52:53], v[196:197], v[10:11], v[52:53] op_sel:[0,1,0] op_sel_hi:[1,1,1]
    v_pk_fma_f32 v[54:55], v[198:199], v[10:11], v[54:55] op_sel:[0,1,0] op_sel_hi:[1,1,1]
    v_pk_mul_f32 v[32:33], v[32:33], v[10:11] op_sel_hi:[1,0]
    v_pk_mul_f32 v[34:35], v[34:35], v[10:11] op_sel_hi:[1,0]
    v_pk_mul_f32 v[36:37], v[36:37], v[10:11] op_sel_hi:[1,0]
    v_pk_mul_f32 v[38:39], v[38:39], v[10:11] op_sel_hi:[1,0]
    v_pk_mul_f32 v[40:41], v[40:41], v[10:11] op_sel_hi:[1,0]
    v_pk_mul_f32 v[42:43], v[42:43], v[10:11] op_sel_hi:[1,0]
    v_pk_mul_f32 v[44:45], v[44:45], v[10:11] op_sel_hi:[1,0]
    v_pk_mul_f32 v[46:47], v[46:47], v[10:11] op_sel_hi:[1,0]
    v_pk_mul_f32 v[48:49], v[48:49], v[10:11] op_sel_hi:[1,0]
    v_pk_mul_f32 v[50:51], v[50:51], v[10:11] op_sel_hi:[1,0]
    v_pk_mul_f32 v[52:53], v[52:53], v[10:11] op_sel_hi:[1,0]
    v_pk_mul_f32 v[54:55], v[54:55], v[10:11] op_sel_hi:[1,0]
    v_pk_mul_f32 v[128:129], v[32:33], v[32:33]
    v_pk_mul_f32 v[130:131], v[34:35], v[34:35]
    v_pk_mul_f32 v[132:133], v[36:37], v[36:37]
    v_pk_mul_f32 v[134:135], v[38:39], v[38:39]
    v_pk_mul_f32 v[136:137], v[40:41], v[40:41]
    v_pk_mul_f32 v[138:139], v[42:43], v[42:43]
    v_pk_mul_f32 v[140:141], v[44:45], v[44:45]
    v_pk_mul_f32 v[142:143], v[46:47], v[46:47]
    v_pk_mul_f32 v[144:145], v[48:49], v[48:49]
    v_pk_mul_f32 v[146:147], v[50:51], v[50:51]
    v_pk_mul_f32 v[148:149], v[52:53], v[52:53]
    v_pk_mul_f32 v[150:151], v[54:55], v[54:55]
    v_pk_fma_f32 v[128:129], v[128:129], v[8:9], v[8:9] op_sel:[0,0,1] op_sel_hi:[1,0,1]
    v_pk_fma_f32 v[130:131], v[130:131], v[8:9], v[8:9] op_sel:[0,0,1] op_sel_hi:[1,0,1]
    v_pk_fma_f32 v[132:133], v[132:133], v[8:9], v[8:9] op_sel:[0,0,1] op_sel_hi:[1,0,1]
    v_pk_fma_f32 v[134:135], v[134:135], v[8:9], v[8:9] op_sel:[0,0,1] op_sel_hi:[1,0,1]
    v_pk_fma_f32 v[136:137], v[136:137], v[8:9], v[8:9] op_sel:[0,0,1] op_sel_hi:[1,0,1]
    v_pk_fma_f32 v[138:139], v[138:139], v[8:9], v[8:9] op_sel:[0,0,1] op_sel_hi:[1,0,1]
    v_pk_fma_f32 v[140:141], v[140:141], v[8:9], v[8:9] op_sel:[0,0,1] op_sel_hi:[1,0,1]
    v_pk_fma_f32 v[142:143], v[142:143], v[8:9], v[8:9] op_sel:[0,0,1] op_sel_hi:[1,0,1]
    v_pk_fma_f32 v[144:145], v[144:145], v[8:9], v[8:9] op_sel:[0,0,1] op_sel_hi:[1,0,1]
    v_pk_fma_f32 v[146:147], v[146:147], v[8:9], v[8:9] op_sel:[0,0,1] op_sel_hi:[1,0,1]
    v_pk_fma_f32 v[148:149], v[148:149], v[8:9], v[8:9] op_sel:[0,0,1] op_sel_hi:[1,0,1]
    v_pk_fma_f32 v[150:151], v[150:151], v[8:9], v[8:9] op_sel:[0,0,1] op_sel_hi:[1,0,1]
    v_pk_mul_f32 v[128:129], v[128:129], v[32:33]
    v_pk_mul_f32 v[130:131], v[130:131], v[34:35]
    v_pk_mul_f32 v[132:133], v[132:133], v[36:37]
    v_pk_mul_f32 v[134:135], v[134:135], v[38:39]
    v_pk_mul_f32 v[136:137], v[136:137], v[40:41]
    v_pk_mul_f32 v[138:139], v[138:139], v[42:43]
    v_pk_mul_f32 v[140:141], v[140:141], v[44:45]
    v_pk_mul_f32 v[142:143], v[142:143], v[46:47]
    v_pk_mul_f32 v[144:145], v[144:145], v[48:49]
    v_pk_mul_f32 v[146:147], v[146:147], v[50:51]
    v_pk_mul_f32 v[148:149], v[148:149], v[52:53]
    v_pk_mul_f32 v[150:151], v[150:151], v[54:55]
    v_exp_f32 v128, v128
    v_exp_f32 v129, v129
    v_exp_f32 v130, v130
    v_exp_f32 v131, v131
    v_exp_f32 v132, v132
    v_exp_f32 v133, v133
    v_exp_f32 v134, v134
    v_exp_f32 v135, v135
    v_exp_f32 v136, v136
    v_exp_f32 v137, v137
    v_exp_f32 v138, v138
    v_exp_f32 v139, v139
    v_exp_f32 v140, v140
    v_exp_f32 v141, v141
    v_exp_f32 v142, v142
    v_exp_f32 v143, v143
    v_exp_f32 v144, v144
    v_exp_f32 v145, v145
    v_exp_f32 v146, v146
    v_exp_f32 v147, v147
    v_exp_f32 v148, v148
    v_exp_f32 v149, v149
    v_exp_f32 v150, v150
    v_exp_f32 v151, v151
    v_pk_add_f32 v[128:129], v[128:129], 1.0 op_sel_hi:[1,0]
    v_pk_add_f32 v[130:131], v[130:131], 1.0 op_sel_hi:[1,0]
    v_pk_add_f32 v[132:133], v[132:133], 1.0 op_sel_hi:[1,0]
    v_pk_add_f32 v[134:135], v[134:135], 1.0 op_sel_hi:[1,0]
    v_pk_add_f32 v[136:137], v[136:137], 1.0 op_sel_hi:[1,0]
    v_pk_add_f32 v[138:139], v[138:139], 1.0 op_sel_hi:[1,0]
    v_pk_add_f32 v[140:141], v[140:141], 1.0 op_sel_hi:[1,0]
    v_pk_add_f32 v[142:143], v[142:143], 1.0 op_sel_hi:[1,0]
    v_pk_add_f32 v[144:145], v[144:145], 1.0 op_sel_hi:[1,0]
    v_pk_add_f32 v[146:147], v[146:147], 1.0 op_sel_hi:[1,0]
    v_pk_add_f32 v[148:149], v[148:149], 1.0 op_sel_hi:[1,0]
    v_pk_add_f32 v[150:151], v[150:151], 1.0 op_sel_hi:[1,0]
    v_rcp_f32 v128, v128
    v_rcp_f32 v129, v129
    v_rcp_f32 v130, v130
    v_rcp_f32 v131, v131
    v_rcp_f32 v132, v132
    v_rcp_f32 v133, v133
    v_rcp_f32 v134, v134
    v_rcp_f32 v135, v135
    v_rcp_f32 v136, v136
    v_rcp_f32 v137, v137
    v_rcp_f32 v138, v138
    v_rcp_f32 v139, v139
    v_rcp_f32 v140, v140
    v_rcp_f32 v141, v141
    v_rcp_f32 v142, v142
    v_rcp_f32 v143, v143
    v_rcp_f32 v144, v144
    v_rcp_f32 v145, v145
    v_rcp_f32 v146, v146
    v_rcp_f32 v147, v147
    v_rcp_f32 v148, v148
    v_rcp_f32 v149, v149
    v_rcp_f32 v150, v150
    v_rcp_f32 v151, v151
    v_pk_mul_f32 v[32:33], v[32:33], v[128:129]
    v_pk_mul_f32 v[34:35], v[34:35], v[130:131]
    v_pk_mul_f32 v[36:37], v[36:37], v[132:133]
    v_pk_mul_f32 v[38:39], v[38:39], v[134:135]
    v_pk_mul_f32 v[40:41], v[40:41], v[136:137]
    v_pk_mul_f32 v[42:43], v[42:43], v[138:139]
    v_pk_mul_f32 v[44:45], v[44:45], v[140:141]
    v_pk_mul_f32 v[46:47], v[46:47], v[142:143]
    v_pk_mul_f32 v[48:49], v[48:49], v[144:145]
    v_pk_mul_f32 v[50:51], v[50:51], v[146:147]
    v_pk_mul_f32 v[52:53], v[52:53], v[148:149]
    v_pk_mul_f32 v[54:55], v[54:55], v[150:151]
    v_pk_add_f32 v[4:5], v[32:33], v[34:35]
    v_pk_mul_f32 v[6:7], v[32:33], v[32:33]
    v_pk_fma_f32 v[6:7], v[34:35], v[34:35], v[6:7]
    v_pk_add_f32 v[4:5], v[4:5], v[36:37]
    v_pk_fma_f32 v[6:7], v[36:37], v[36:37], v[6:7]
    v_pk_add_f32 v[4:5], v[4:5], v[38:39]
    v_pk_fma_f32 v[6:7], v[38:39], v[38:39], v[6:7]
    v_pk_add_f32 v[4:5], v[4:5], v[40:41]
    v_pk_fma_f32 v[6:7], v[40:41], v[40:41], v[6:7]
    v_pk_add_f32 v[4:5], v[4:5], v[42:43]
    v_pk_fma_f32 v[6:7], v[42:43], v[42:43], v[6:7]
    v_pk_add_f32 v[4:5], v[4:5], v[44:45]
    v_pk_fma_f32 v[6:7], v[44:45], v[44:45], v[6:7]
    v_pk_add_f32 v[4:5], v[4:5], v[46:47]
    v_pk_fma_f32 v[6:7], v[46:47], v[46:47], v[6:7]
    v_pk_add_f32 v[4:5], v[4:5], v[48:49]
    v_pk_fma_f32 v[6:7], v[48:49], v[48:49], v[6:7]
    v_pk_add_f32 v[4:5], v[4:5], v[50:51]
    v_pk_fma_f32 v[6:7], v[50:51], v[50:51], v[6:7]
    v_pk_add_f32 v[4:5], v[4:5], v[52:53]
    v_pk_fma_f32 v[6:7], v[52:53], v[52:53], v[6:7]
    v_pk_add_f32 v[4:5], v[4:5], v[54:55]
    v_pk_fma_f32 v[6:7], v[54:55], v[54:55], v[6:7]
    v_add_f32 v4, v4, v5
    v_add_f32 v6, v6, v7
    v_lshlrev_b32 v7, 2, v0
    s_nop 0
    v_permlane16_swap_b32 v4, v6
    v_add_f32 v4, v4, v6
    v_mov_b32 v5, v4
    s_nop 1
    v_permlane32_swap_b32 v4, v5
    v_add_f32 v4, v4, v5
    s_and_b32 s44, s39, 0xfff
    v_and_b32 v4, 0xfffff000, v4
    v_or_b32 v4, s44, v4
    s_mov_b32 exec_hi, 0
    s_cmp_eq_u32 s33, 0
    s_cbranch_scc1 L_ls2
    buffer_store_dword v4, v7, s[28:31], s47 offen
L_lb2:
    s_mov_b64 exec, -1
    s_waitcnt lgkmcnt(5)
    v_pk_mul_f32 v[128:129], v[200:201], v[10:11] op_sel:[0,1] op_sel_hi:[1,1]
    v_pk_mul_f32 v[130:131], v[202:203], v[10:11] op_sel:[0,1] op_sel_hi:[1,1]
    s_waitcnt lgkmcnt(4)
    v_pk_mul_f32 v[132:133], v[204:205], v[10:11] op_sel:[0,1] op_sel_hi:[1,1]
    v_pk_mul_f32 v[134:135], v[206:207], v[10:11] op_sel:[0,1] op_sel_hi:[1,1]
    s_waitcnt lgkmcnt(3)
    v_pk_mul_f32 v[136:137], v[208:209], v[10:11] op_sel:[0,1] op_sel_hi:[1,1]
    v_pk_mul_f32 v[138:139], v[210:211], v[10:11] op_sel:[0,1] op_sel_hi:[1,1]
    s_waitcnt lgkmcnt(2)
    v_pk_mul_f32 v[140:141], v[212:213], v[10:11] op_sel:[0,1] op_sel_hi:[1,1]
    v_pk_mul_f32 v[142:143], v[214:215], v[10:11] op_sel:[0,1] op_sel_hi:[1,1]
    s_waitcnt lgkmcnt(1)
    v_pk_mul_f32 v[144:145], v[216:217], v[10:11] op_sel:[0,1] op_sel_hi:[1,1]
    v_pk_mul_f32 v[146:147], v[218:219], v[10:11] op_sel:[0,1] op_sel_hi:[1,1]
    s_waitcnt lgkmcnt(0)
    v_pk_mul_f32 v[148:149], v[220:221], v[10:11] op_sel:[0,1] op_sel_hi:[1,1]
    v_pk_mul_f32 v[150:151], v[222:223], v[10:11] op_sel:[0,1] op_sel_hi:[1,1]
    s_barrier
    ds_read_b128 v[152:155], v20 offset:0
    ds_read_b128 v[156:159], v20 offset:1024
    ds_read_b128 v[160:163], v20 offset:2048
    ds_read_b128 v[164:167], v20 offset:3072
    ds_read_b128 v[168:171], v20 offset:4096
    ds_read_b128 v[172:175], v20 offset:5120
    s_waitcnt lgkmcnt(3)
    v_mfma_f32_16x16x32_bf16 v[128:131], v[152:155], v[64:67], v[128:131]
    ds_read_b128 v[176:179], v20 offset:6144
    buffer_load_dword v4, v17, s[28:31], s101 offen offset:0 sc1
    buffer_load_dword v5, v17, s[28:31], s101 offen offset:128 sc1
    buffer_load_dword v6, v17, s[28:31], s101 offen offset:256 sc1
    buffer_load_dword v7, v17, s[28:31], s101 offen offset:384 sc1
    v_mfma_f32_16x16x32_bf16 v[132:135], v[156:159], v[64:67], v[132:135]
    ds_read_b128 v[180:183], v20 offset:7168
    v_mfma_f32_16x16x32_bf16 v[136:139], v[160:163], v[64:67], v[136:139]
    ds_read_b128 v[184:187], v20 offset:8192
    s_waitcnt lgkmcnt(3)
    v_mfma_f32_16x16x32_bf16 v[140:143], v[164:167], v[64:67], v[140:143]
    ds_read_b128 v[152:155], v20 offset:9216
    v_mfma_f32_16x16x32_bf16 v[144:147], v[168:171], v[64:67], v[144:147]
    ds_read_b128 v[156:159], v20 offset:10240
    v_mfma_f32_16x16x32_bf16 v[148:151], v[172:175], v[64:67], v[148:151]
    ds_read_b128 v[160:163], v20 offset:11264
    s_waitcnt lgkmcnt(3)
    v_mfma_f32_16x16x32_bf16 v[128:131], v[176:179], v[68:71], v[128:131]
    v_mfma_f32_16x16x32_bf16 v[132:135], v[180:183], v[68:71], v[132:135]
    v_mfma_f32_16x16x32_bf16 v[136:139], v[184:187], v[68:71], v[136:139]
    s_waitcnt lgkmcnt(0)
    v_mfma_f32_16x16x32_bf16 v[140:143], v[152:155], v[68:71], v[140:143]
    v_mfma_f32_16x16x32_bf16 v[144:147], v[156:159], v[68:71], v[144:147]
    v_mfma_f32_16x16x32_bf16 v[148:151], v[160:163], v[68:71], v[148:151]
    s_waitcnt vmcnt(3)
    v_xor_b32 v4, s44, v4
    s_waitcnt vmcnt(2)
    v_xor_b32 v5, s44, v5
    s_waitcnt vmcnt(1)
    v_xor_b32 v6, s44, v6
    s_waitcnt vmcnt(0)
    v_xor_b32 v7, s44, v7
    v_or3_b32 v3, v4, v5, v6
    v_or_b32 v3, v3, v7
    v_and_b32 v3, 0xfff, v3
    v_cmp_ne_u32 vcc, 0, v3
    s_cbranch_vccnz L_rt3
L_ok3:
    s_setprio 3
    v_add_f32 v4, v4, v5
    v_add_f32 v6, v6, v7
    v_add_f32 v4, v4, v6
    v_mov_b32 v5, v4
    s_nop 1
    v_permlane32_swap_b32 v4, v5
    v_add_f32 v4, v4, v5
    v_mov_b32 v5, v4
    s_nop 1
    v_permlane16_swap_b32 v4, v5
    v_mul_f32 v7, 0xbabe82fa, v4
    v_mul_f32 v5, 0x3abe82fa, v5
    v_fma_f32 v5, -v7, v7, v5
    v_max_f32 v5, 0, v5
    v_add_f32 v5, 0x3727c5ac, v5
    v_rsq_f32 v6, v5
    s_nop 0
    v_mul_f32 v7, v7, v6
    v_pk_fma_f32 v[32:33], v[32:33], v[6:7], v[6:7] op_sel:[0,0,1] op_sel_hi:[1,0,1]
    v_pk_fma_f32 v[34:35], v[34:35], v[6:7], v[6:7] op_sel:[0,0,1] op_sel_hi:[1,0,1]
    v_pk_fma_f32 v[36:37], v[36:37], v[6:7], v[6:7] op_sel:[0,0,1] op_sel_hi:[1,0,1]
    v_pk_fma_f32 v[38:39], v[38:39], v[6:7], v[6:7] op_sel:[0,0,1] op_sel_hi:[1,0,1]
    v_cvt_pk_bf16_f32 v32, v32, v33
    v_cvt_pk_bf16_f32 v33, v34, v35
    v_cvt_pk_bf16_f32 v34, v36, v37
    v_cvt_pk_bf16_f32 v35, v38, v39
    s_nop 0
    v_permlane16_swap_b32 v32, v34
    v_permlane16_swap_b32 v33, v35
    buffer_store_dwordx4 v[32:35], v16, s[28:31], s46 offen offset:0 sc1
    v_pk_fma_f32 v[40:41], v[40:41], v[6:7], v[6:7] op_sel:[0,0,1] op_sel_hi:[1,0,1]
    v_pk_fma_f32 v[42:43], v[42:43], v[6:7], v[6:7] op_sel:[0,0,1] op_sel_hi:[1,0,1]
    v_pk_fma_f32 v[44:45], v[44:45], v[6:7], v[6:7] op_sel:[0,0,1] op_sel_hi:[1,0,1]
    v_pk_fma_f32 v[46:47], v[46:47], v[6:7], v[6:7] op_sel:[0,0,1] op_sel_hi:[1,0,1]
    v_cvt_pk_bf16_f32 v36, v40, v41
    v_cvt_pk_bf16_f32 v37, v42, v43
    v_cvt_pk_bf16_f32 v38, v44, v45
    v_cvt_pk_bf16_f32 v39, v46, v47
    s_nop 0
    v_permlane16_swap_b32 v36, v38
    v_permlane16_swap_b32 v37, v39
    buffer_store_dwordx4 v[36:39], v16, s[28:31], s46 offen offset:256 sc1
    v_pk_fma_f32 v[48:49], v[48:49], v[6:7], v[6:7] op_sel:[0,0,1] op_sel_hi:[1,0,1]
    v_pk_fma_f32 v[50:51], v[50:51], v[6:7], v[6:7] op_sel:[0,0,1] op_sel_hi:[1,0,1]
    v_pk_fma_f32 v[52:53], v[52:53], v[6:7], v[6:7] op_sel:[0,0,1] op_sel_hi:[1,0,1]
    v_pk_fma_f32 v[54:55], v[54:55], v[6:7], v[6:7] op_sel:[0,0,1] op_sel_hi:[1,0,1]
    v_cvt_pk_bf16_f32 v40, v48, v49
    v_cvt_pk_bf16_f32 v41, v50, v51
    v_cvt_pk_bf16_f32 v42, v52, v53
    v_cvt_pk_bf16_f32 v43, v54, v55
    s_nop 0
    v_permlane16_swap_b32 v40, v42
    v_permlane16_swap_b32 v41, v43
    buffer_store_dwordx4 v[40:43], v16, s[28:31], s46 offen offset:512 sc1
    ds_read_b128 v[152:155], v20 offset:12288
    ds_read_b128 v[156:159], v20 offset:13312
    ds_read_b128 v[160:163], v20 offset:14336
    ds_read_b128 v[164:167], v20 offset:15360
    ds_read_b128 v[168:171], v20 offset:16384
    ds_read_b128 v[172:175], v20 offset:17408
    s_waitcnt lgkmcnt(3)
    v_mfma_f32_16x16x32_bf16 v[128:131], v[152:155], v[72:75], v[128:131]
    ds_read_b128 v[176:179], v20 offset:18432
    v_bfe_u32 v4, v0, 2, 2
    v_mfma_f32_16x16x32_bf16 v[132:135], v[156:159], v[72:75], v[132:135]
    ds_read_b128 v[180:183], v20 offset:19456
    v_and_b32 v5, 2, v4
    v_mfma_f32_16x16x32_bf16 v[136:139], v[160:163], v[72:75], v[136:139]
    ds_read_b128 v[184:187], v20 offset:20480
    v_and_b32 v6, 1, v4
    s_waitcnt lgkmcnt(3)
    v_mfma_f32_16x16x32_bf16 v[140:143], v[164:167], v[72:75], v[140:143]
    ds_read_b128 v[152:155], v20 offset:21504
    v_lshl_or_b32 v5, v5, 1, v6
    v_mfma_f32_16x16x32_bf16 v[144:147], v[168:171], v[72:75], v[144:147]
    ds_read_b128 v[156:159], v20 offset:22528
    v_lshlrev_b32 v6, 1, v2
    v_mfma_f32_16x16x32_bf16 v[148:151], v[172:175], v[72:75], v[148:151]
    ds_read_b128 v[160:163], v20 offset:23552
    v_xor_b32 v5, v5, v6
    s_waitcnt lgkmcnt(3)
    v_mfma_f32_16x16x32_bf16 v[128:131], v[176:179], v[76:79], v[128:131]
    v_mul_u32_u24 v4, 768, v4
    v_lshl_add_u32 v4, v5, 5, v4
    v_mfma_f32_16x16x32_bf16 v[132:135], v[180:183], v[76:79], v[132:135]
    v_and_b32 v5, 3, v0
    v_lshl_add_u32 v4, v5, 3, v4
    v_mfma_f32_16x16x32_bf16 v[136:139], v[184:187], v[76:79], v[136:139]
    v_add_u32 v12, 16384, v4
    v_xor_b32 v13, 32, v12
    s_waitcnt lgkmcnt(0)
    v_mfma_f32_16x16x32_bf16 v[140:143], v[152:155], v[76:79], v[140:143]
    v_add_u32 v14, 49152, v12
    v_add_u32 v15, 49152, v13
    v_mfma_f32_16x16x32_bf16 v[144:147], v[156:159], v[76:79], v[144:147]
    v_lshrrev_b32 v8, 5, v0
    v_and_b32 v3, 31, v0
    v_mfma_f32_16x16x32_bf16 v[148:151], v[160:163], v[76:79], v[148:151]
    v_lshlrev_b32 v9, 3, v8
    v_xor_b32 v3, v3, v9
    v_lshlrev_b32 v3, 4, v3
    v_lshl_add_u32 v3, v8, 18, v3
    v_xor_b32 v9, 0, v3
    v_add_u32 v18, 0, v9
    v_xor_b32 v9, 32, v3
    v_add_u32 v19, 523264, v9
    v_xor_b32 v9, 64, v3
    v_add_u32 v22, 1046528, v9
    v_xor_b32 v9, 96, v3
    v_add_u32 v23, 1569792, v9
    v_xor_b32 v9, 16, v3
    v_add_u32 v24, 2097152, v9
    v_xor_b32 v9, 48, v3
    v_add_u32 v25, 2620416, v9
    v_xor_b32 v9, 80, v3
    v_add_u32 v26, 3143680, v9
    v_xor_b32 v9, 112, v3
    v_add_u32 v27, 3666944, v9
    s_lshl_b32 s49, s62, 12
    s_lshl_b32 s40, s63, 22
    s_add_u32 s49, s49, s40
    v_and_b32 v8, 6, v1
    v_lshrrev_b32 v9, 3, v1
    v_or_b32 v8, v8, v9
    v_xor_b32 v9, v1, v2
    v_and_b32 v9, 1, v9
    v_lshl_or_b32 v8, v9, 3, v8
    v_lshrrev_b32 v9, 1, v2
    v_lshl_or_b32 v8, v9, 4, v8
    v_lshl_or_b32 v8, v1, 5, v8
    v_lshl_add_u32 v56, v8, 4, s59
    v_xor_b32 v57, 16, v56
    v_xor_b32 v58, 32, v56
    v_xor_b32 v59, 48, v56
    v_xor_b32 v60, 64, v56
    v_xor_b32 v61, 80, v56
    v_xor_b32 v62, 96, v56
    v_xor_b32 v63, 112, v56
    s_lshl_b32 s40, s100, 7
    s_lshl_b32 s41, s32, 2
    s_add_u32 s40, s40, s41
    s_add_u32 s40, s40, 8552448
    v_mov_b32 v3, 0
    v_mov_b32 v9, s39
    s_waitcnt vmcnt(0)
    s_mov_b64 exec, 1
    buffer_store_dword v9, v3, s[28:31], s40 offen sc1
    s_mov_b64 exec, -1
    s_setprio 0
    ds_read_b128 v[152:155], v20 offset:24576
    ds_read_b128 v[156:159], v20 offset:25600
    ds_read_b128 v[160:163], v20 offset:26624
    ds_read_b128 v[164:167], v20 offset:27648
    ds_read_b128 v[168:171], v20 offset:28672
    ds_read_b128 v[172:175], v20 offset:29696
    s_waitcnt lgkmcnt(3)
    v_mfma_f32_16x16x32_bf16 v[128:131], v[152:155], v[80:83], v[128:131]
    ds_read_b128 v[176:179], v20 offset:30720
    v_mfma_f32_16x16x32_bf16 v[132:135], v[156:159], v[80:83], v[132:135]
    ds_read_b128 v[180:183], v20 offset:31744
    v_mfma_f32_16x16x32_bf16 v[136:139], v[160:163], v[80:83], v[136:139]
    ds_read_b128 v[184:187], v20 offset:32768
    s_waitcnt lgkmcnt(3)
    v_mfma_f32_16x16x32_bf16 v[140:143], v[164:167], v[80:83], v[140:143]
    ds_read_b128 v[152:155], v20 offset:33792
    v_mfma_f32_16x16x32_bf16 v[144:147], v[168:171], v[80:83], v[144:147]
    ds_read_b128 v[156:159], v20 offset:34816
    v_mfma_f32_16x16x32_bf16 v[148:151], v[172:175], v[80:83], v[148:151]
    ds_read_b128 v[160:163], v20 offset:35840
    s_waitcnt lgkmcnt(3)
    v_mfma_f32_16x16x32_bf16 v[128:131], v[176:179], v[84:87], v[128:131]
    ds_read_b128 v[164:167], v20 offset:36864
    v_mfma_f32_16x16x32_bf16 v[132:135], v[180:183], v[84:87], v[132:135]
    ds_read_b128 v[168:171], v20 offset:37888
    v_mfma_f32_16x16x32_bf16 v[136:139], v[184:187], v[84:87], v[136:139]
    ds_read_b128 v[172:175], v20 offset:38912
    s_waitcnt lgkmcnt(3)
    v_mfma_f32_16x16x32_bf16 v[140:143], v[152:155], v[84:87], v[140:143]
    ds_read_b128 v[176:179], v20 offset:39936
    v_mfma_f32_16x16x32_bf16 v[144:147], v[156:159], v[84:87], v[144:147]
    ds_read_b128 v[180:183], v20 offset:40960
    v_mfma_f32_16x16x32_bf16 v[148:151], v[160:163], v[84:87], v[148:151]
    ds_read_b128 v[184:187], v20 offset:41984
    s_waitcnt lgkmcnt(3)
    v_mfma_f32_16x16x32_bf16 v[128:131], v[164:167], v[88:91], v[128:131]
    ds_read_b128 v[152:155], v20 offset:43008
    v_mfma_f32_16x16x32_bf16 v[132:135], v[168:171], v[88:91], v[132:135]
    ds_read_b128 v[156:159], v20 offset:44032
    v_mfma_f32_16x16x32_bf16 v[136:139], v[172:175], v[88:91], v[136:139]
    ds_read_b128 v[160:163], v20 offset:45056
    s_waitcnt lgkmcnt(3)
    v_mfma_f32_16x16x32_bf16 v[140:143], v[176:179], v[88:91], v[140:143]
    ds_read_b128 v[164:167], v20 offset:46080
    v_mfma_f32_16x16x32_bf16 v[144:147], v[180:183], v[88:91], v[144:147]
    ds_read_b128 v[168:171], v20 offset:47104
    v_mfma_f32_16x16x32_bf16 v[148:151], v[184:187], v[88:91], v[148:151]
    ds_read_b128 v[172:175], v20 offset:48128
    s_waitcnt lgkmcnt(3)
    v_mfma_f32_16x16x32_bf16 v[128:131], v[152:155], v[92:95], v[128:131]
    v_mfma_f32_16x16x32_bf16 v[132:135], v[156:159], v[92:95], v[132:135]
    v_mfma_f32_16x16x32_bf16 v[136:139], v[160:163], v[92:95], v[136:139]
    s_waitcnt lgkmcnt(0)
    v_mfma_f32_16x16x32_bf16 v[140:143], v[164:167], v[92:95], v[140:143]
    v_mfma_f32_16x16x32_bf16 v[144:147], v[168:171], v[92:95], v[144:147]
    v_mfma_f32_16x16x32_bf16 v[148:151], v[172:175], v[92:95], v[148:151]
    s_barrier
    ds_read_b128 v[192:195], v56 offset:0
    ds_read_b128 v[196:199], v57 offset:0
    ds_read_b128 v[200:203], v58 offset:0
    ds_read_b128 v[204:207], v59 offset:0
    ds_read_b128 v[208:211], v60 offset:0
    ds_read_b128 v[212:215], v61 offset:0
    ds_read_b128 v[216:219], v62 offset:0
    ds_read_b128 v[220:223], v63 offset:0
    ds_read_b128 v[224:227], v56 offset:8192
    ds_read_b128 v[228:231], v57 offset:8192
    ds_read_b128 v[232:235], v58 offset:8192
    ds_read_b128 v[236:239], v59 offset:8192
    ds_read_b128 v[240:243], v60 offset:8192
    ds_read_b128 v[244:247], v61 offset:8192
    ds_read_b128 v[248:251], v62 offset:8192
    ds_read_b128 v[252:255], v63 offset:8192
    s_waitcnt lgkmcnt(0)
    ds_read_b128 v[152:155], v21 offset:0
    s_add_u32 s48, s96, 6
    ds_read_b128 v[156:159], v21 offset:1024
    s_and_b32 s48, s48, 7
    ds_read_b128 v[160:163], v21 offset:2048
    s_lshl_b32 s48, s48, 9
    ds_read_b128 v[164:167], v21 offset:3072
    s_add_u32 s48, s48, s49
    ds_read_b128 v[168:171], v21 offset:4096
    s_add_u32 m0, s59, 0
    ds_read_b128 v[172:175], v21 offset:5120
    buffer_load_dwordx4 v18, s[12:15], s48 offen offset:0  lds
    s_waitcnt lgkmcnt(3)
    v_mfma_f32_16x16x32_bf16 v[128:131], v[152:155], v[96:99], v[128:131]
    ds_read_b128 v[176:179], v21 offset:6144
    v_mfma_f32_16x16x32_bf16 v[132:135], v[156:159], v[96:99], v[132:135]
    ds_read_b128 v[180:183], v21 offset:7168
    v_mfma_f32_16x16x32_bf16 v[136:139], v[160:163], v[96:99], v[136:139]
    ds_read_b128 v[184:187], v21 offset:8192
    s_waitcnt lgkmcnt(3)
    v_mfma_f32_16x16x32_bf16 v[140:143], v[164:167], v[96:99], v[140:143]
    ds_read_b128 v[152:155], v21 offset:9216
    buffer_load_dwordx4 v19, s[12:15], s48 offen offset:1024  lds
    v_mfma_f32_16x16x32_bf16 v[144:147], v[168:171], v[96:99], v[144:147]
    ds_read_b128 v[156:159], v21 offset:10240
    v_mfma_f32_16x16x32_bf16 v[148:151], v[172:175], v[96:99], v[148:151]
    ds_read_b128 v[160:163], v21 offset:11264
    s_waitcnt lgkmcnt(3)
    v_mfma_f32_16x16x32_bf16 v[128:131], v[176:179], v[100:103], v[128:131]
    ds_read_b128 v[164:167], v21 offset:12288
    v_mfma_f32_16x16x32_bf16 v[132:135], v[180:183], v[100:103], v[132:135]
    ds_read_b128 v[168:171], v21 offset:13312
    buffer_load_dwordx4 v22, s[12:15], s48 offen offset:2048  lds
    v_mfma_f32_16x16x32_bf16 v[136:139], v[184:187], v[100:103], v[136:139]
    ds_read_b128 v[172:175], v21 offset:14336
    s_waitcnt lgkmcnt(3)
    v_mfma_f32_16x16x32_bf16 v[140:143], v[152:155], v[100:103], v[140:143]
    ds_read_b128 v[176:179], v21 offset:15360
    v_mfma_f32_16x16x32_bf16 v[144:147], v[156:159], v[100:103], v[144:147]
    ds_read_b128 v[180:183], v21 offset:16384
    v_mfma_f32_16x16x32_bf16 v[148:151], v[160:163], v[100:103], v[148:151]
    ds_read_b128 v[184:187], v21 offset:17408
    buffer_load_dwordx4 v23, s[12:15], s48 offen offset:3072  lds
    s_waitcnt lgkmcnt(3)
    v_mfma_f32_16x16x32_bf16 v[128:131], v[164:167], v[104:107], v[128:131]
    ds_read_b128 v[152:155], v21 offset:18432
    v_mfma_f32_16x16x32_bf16 v[132:135], v[168:171], v[104:107], v[132:135]
    s_add_u32 m0, s59, 4096
    ds_read_b128 v[156:159], v21 offset:19456
    v_mfma_f32_16x16x32_bf16 v[136:139], v[172:175], v[104:107], v[136:139]
    ds_read_b128 v[160:163], v21 offset:20480
    s_waitcnt lgkmcnt(3)
    v_mfma_f32_16x16x32_bf16 v[140:143], v[176:179], v[104:107], v[140:143]
    buffer_load_dwordx4 v24, s[12:15], s48 offen offset:0  lds
    ds_read_b128 v[164:167], v21 offset:21504
    v_mfma_f32_16x16x32_bf16 v[144:147], v[180:183], v[104:107], v[144:147]
    ds_read_b128 v[168:171], v21 offset:22528
    v_mfma_f32_16x16x32_bf16 v[148:151], v[184:187], v[104:107], v[148:151]
    ds_read_b128 v[172:175], v21 offset:23552
    s_waitcnt lgkmcnt(3)
    v_mfma_f32_16x16x32_bf16 v[128:131], v[152:155], v[108:111], v[128:131]
    ds_read_b128 v[176:179], v21 offset:24576
    v_mfma_f32_16x16x32_bf16 v[132:135], v[156:159], v[108:111], v[132:135]
    buffer_load_dwordx4 v25, s[12:15], s48 offen offset:1024  lds
    ds_read_b128 v[180:183], v21 offset:25600
    v_mfma_f32_16x16x32_bf16 v[136:139], v[160:163], v[108:111], v[136:139]
    ds_read_b128 v[184:187], v21 offset:26624
    s_waitcnt lgkmcnt(3)
    v_mfma_f32_16x16x32_bf16 v[140:143], v[164:167], v[108:111], v[140:143]
    ds_read_b128 v[152:155], v21 offset:27648
    v_mfma_f32_16x16x32_bf16 v[144:147], v[168:171], v[108:111], v[144:147]
    ds_read_b128 v[156:159], v21 offset:28672
    v_mfma_f32_16x16x32_bf16 v[148:151], v[172:175], v[108:111], v[148:151]
    buffer_load_dwordx4 v26, s[12:15], s48 offen offset:2048  lds
    ds_read_b128 v[160:163], v21 offset:29696
    s_waitcnt lgkmcnt(3)
    v_mfma_f32_16x16x32_bf16 v[128:131], v[176:179], v[112:115], v[128:131]
    ds_read_b128 v[164:167], v21 offset:30720
    s_barrier
    buffer_load_dwordx4 v27, s[12:15], s48 offen offset:3072  lds
    v_mfma_f32_16x16x32_bf16 v[132:135], v[180:183], v[112:115], v[132:135]
    ds_read_b128 v[168:171], v21 offset:31744
    v_mfma_f32_16x16x32_bf16 v[136:139], v[184:187], v[112:115], v[136:139]
    s_add_u32 s48, s96, 7
    ds_read_b128 v[172:175], v21 offset:32768
    s_and_b32 s48, s48, 7
    s_waitcnt lgkmcnt(3)
    v_mfma_f32_16x16x32_bf16 v[140:143], v[152:155], v[112:115], v[140:143]
    s_lshl_b32 s48, s48, 9
    ds_read_b128 v[176:179], v21 offset:33792
    s_add_u32 s48, s48, s49
    v_mfma_f32_16x16x32_bf16 v[144:147], v[156:159], v[112:115], v[144:147]
    s_add_u32 m0, s59, 8192
    ds_read_b128 v[180:183], v21 offset:34816
    buffer_load_dwordx4 v18, s[12:15], s48 offen offset:0  lds
    v_mfma_f32_16x16x32_bf16 v[148:151], v[160:163], v[112:115], v[148:151]
    ds_read_b128 v[184:187], v21 offset:35840
    s_waitcnt lgkmcnt(3)
    v_mfma_f32_16x16x32_bf16 v[128:131], v[164:167], v[116:119], v[128:131]
    ds_read_b128 v[152:155], v21 offset:36864
    v_mfma_f32_16x16x32_bf16 v[132:135], v[168:171], v[116:119], v[132:135]
    ds_read_b128 v[156:159], v21 offset:37888
    v_mfma_f32_16x16x32_bf16 v[136:139], v[172:175], v[116:119], v[136:139]
    ds_read_b128 v[160:163], v21 offset:38912
    buffer_load_dwordx4 v19, s[12:15], s48 offen offset:1024  lds
    s_waitcnt lgkmcnt(3)
    v_mfma_f32_16x16x32_bf16 v[140:143], v[176:179], v[116:119], v[140:143]
    ds_read_b128 v[164:167], v21 offset:39936
    v_mfma_f32_16x16x32_bf16 v[144:147], v[180:183], v[116:119], v[144:147]
    ds_read_b128 v[168:171], v21 offset:40960
    v_mfma_f32_16x16x32_bf16 v[148:151], v[184:187], v[116:119], v[148:151]
    ds_read_b128 v[172:175], v21 offset:41984
    s_waitcnt lgkmcnt(3)
    v_mfma_f32_16x16x32_bf16 v[128:131], v[152:155], v[120:123], v[128:131]
    ds_read_b128 v[176:179], v21 offset:43008
    buffer_load_dwordx4 v22, s[12:15], s48 offen offset:2048  lds
    v_mfma_f32_16x16x32_bf16 v[132:135], v[156:159], v[120:123], v[132:135]
    ds_read_b128 v[180:183], v21 offset:44032
    v_mfma_f32_16x16x32_bf16 v[136:139], v[160:163], v[120:123], v[136:139]
    ds_read_b128 v[184:187], v21 offset:45056
    s_waitcnt lgkmcnt(3)
    v_mfma_f32_16x16x32_bf16 v[140:143], v[164:167], v[120:123], v[140:143]
    ds_read_b128 v[152:155], v21 offset:46080
    v_mfma_f32_16x16x32_bf16 v[144:147], v[168:171], v[120:123], v[144:147]
    ds_read_b128 v[156:159], v21 offset:47104
    buffer_load_dwordx4 v23, s[12:15], s48 offen offset:3072  lds
    v_mfma_f32_16x16x32_bf16 v[148:151], v[172:175], v[120:123], v[148:151]
    ds_read_b128 v[160:163], v21 offset:48128
    s_waitcnt lgkmcnt(3)
    v_mfma_f32_16x16x32_bf16 v[128:131], v[176:179], v[124:127], v[128:131]
    s_add_u32 m0, s59, 12288
    v_mfma_f32_16x16x32_bf16 v[132:135], v[180:183], v[124:127], v[132:135]
    v_mfma_f32_16x16x32_bf16 v[136:139], v[184:187], v[124:127], v[136:139]
    s_waitcnt lgkmcnt(0)
    v_mfma_f32_16x16x32_bf16 v[140:143], v[152:155], v[124:127], v[140:143]
    buffer_load_dwordx4 v24, s[12:15], s48 offen offset:0  lds
    v_mfma_f32_16x16x32_bf16 v[144:147], v[156:159], v[124:127], v[144:147]
    v_mfma_f32_16x16x32_bf16 v[148:151], v[160:163], v[124:127], v[148:151]
    v_pk_mul_f32 v[32:33], v[128:129], v[10:11] op_sel_hi:[1,0]
    v_pk_mul_f32 v[34:35], v[130:131], v[10:11] op_sel_hi:[1,0]
    v_pk_mul_f32 v[36:37], v[132:133], v[10:11] op_sel_hi:[1,0]
    v_pk_mul_f32 v[38:39], v[134:135], v[10:11] op_sel_hi:[1,0]
    v_pk_mul_f32 v[40:41], v[136:137], v[10:11] op_sel_hi:[1,0]
    v_pk_mul_f32 v[42:43], v[138:139], v[10:11] op_sel_hi:[1,0]
    v_pk_mul_f32 v[44:45], v[140:141], v[10:11] op_sel_hi:[1,0]
    v_pk_mul_f32 v[46:47], v[142:143], v[10:11] op_sel_hi:[1,0]
    buffer_load_dwordx4 v25, s[12:15], s48 offen offset:1024  lds
    v_pk_mul_f32 v[48:49], v[144:145], v[10:11] op_sel_hi:[1,0]
    v_pk_mul_f32 v[50:51], v[146:147], v[10:11] op_sel_hi:[1,0]
    v_pk_mul_f32 v[52:53], v[148:149], v[10:11] op_sel_hi:[1,0]
    v_pk_mul_f32 v[54:55], v[150:151], v[10:11] op_sel_hi:[1,0]
    buffer_load_dwordx4 v26, s[12:15], s48 offen offset:2048  lds
    buffer_load_dwordx4 v27, s[12:15], s48 offen offset:3072  lds
    s_cmp_eq_u32 s36, 0
    s_cselect_b32 s41, 5, 0
    v_mov_b32 v7, 2147418112
    s_mov_b32 s42, 5376
    v_add_u32 v4, 0, v0
    v_mul_u32_u24 v5, 171, v4
    v_lshrrev_b32 v5, 13, v5
    v_mul_u32_u24 v6, 48, v5
    v_sub_u32 v6, v4, v6
    v_lshrrev_b32 v4, 1, v6
    v_xor_b32 v4, v4, v5
    v_and_b32 v4, 1, v4
    v_lshrrev_b32 v6, 4, v6
    v_lshl_or_b32 v4, v6, 1, v4
    v_cmp_le_u32 vcc, s41, v4
    v_lshlrev_b32 v6, 4, v0
    v_mad_u32_u24 v5, v5, s42, v6
    v_cndmask_b32 v8, v7, v5, vcc
    v_add_u32 v4, 64, v0
    v_mul_u32_u24 v5, 171, v4
    v_lshrrev_b32 v5, 13, v5
    v_mul_u32_u24 v6, 48, v5
    v_sub_u32 v6, v4, v6
    v_lshrrev_b32 v4, 1, v6
    v_xor_b32 v4, v4, v5
    v_and_b32 v4, 1, v4
    v_lshrrev_b32 v6, 4, v6
    v_lshl_or_b32 v4, v6, 1, v4
    v_cmp_le_u32 vcc, s41, v4
    v_lshlrev_b32 v6, 4, v0
    v_mad_u32_u24 v5, v5, s42, v6
    v_cndmask_b32 v9, v7, v5, vcc
    v_add_u32 v4, 128, v0
    v_mul_u32_u24 v5, 171, v4
    v_lshrrev_b32 v5, 13, v5
    v_mul_u32_u24 v6, 48, v5
    v_sub_u32 v6, v4, v6
    v_lshrrev_b32 v4, 1, v6
    v_xor_b32 v4, v4, v5
    v_and_b32 v4, 1, v4
    v_lshrrev_b32 v6, 4, v6
    v_lshl_or_b32 v4, v6, 1, v4
    v_cmp_le_u32 vcc, s41, v4
    v_lshlrev_b32 v6, 4, v0
    v_mad_u32_u24 v5, v5, s42, v6
    v_cndmask_b32 v10, v7, v5, vcc
    s_mul_i32 s55, s32, 6144
    s_mul_i32 s41, s32, 49152
    s_add_u32 s54, s98, s41
    v_lshlrev_b32 v16, 4, v0
    s_mul_i32 s40, s32, 6144
    s_add_u32 s40, s40, 90112
    v_add_u32 v17, s40, v16
    v_lshrrev_b32 v4, 3, v0
    v_and_b32 v5, 7, v0
    v_lshlrev_b32 v3, 1, v2
    v_xor_b32 v5, v5, v3
    v_lshlrev_b32 v5, 4, v5
    v_lshl_add_u32 v11, v4, 10, v5
    s_lshl_b32 s50, s32, 13
    s_lshl_b32 s46, s36, 7
    s_add_u32 s50, s50, s46
    s_lshl_b32 s51, s32, 10
    v_add_u32 v6, 98304, v12
    v_add_u32 v7, 98304, v13
    s_waitcnt vmcnt(0)
    ds_read_b128 v[128:131], v56 offset:0
    ds_read_b128 v[132:135], v57 offset:0
    ds_read_b128 v[136:139], v58 offset:0
    ds_read_b128 v[140:143], v59 offset:0
    ds_read_b128 v[144:147], v60 offset:0
    ds_read_b128 v[148:151], v61 offset:0
    ds_read_b128 v[152:155], v62 offset:0
    ds_read_b128 v[156:159], v63 offset:0
    ds_read_b128 v[160:163], v56 offset:8192
    ds_read_b128 v[164:167], v57 offset:8192
    ds_read_b128 v[168:171], v58 offset:8192
    ds_read_b128 v[172:175], v59 offset:8192
    ds_read_b128 v[176:179], v60 offset:8192
    ds_read_b128 v[180:183], v61 offset:8192
    ds_read_b128 v[184:187], v62 offset:8192
    ds_read_b128 v[188:191], v63 offset:8192
    s_waitcnt lgkmcnt(0)
    s_barrier
    s_add_u32 s48, s96, 1
    s_and_b32 s48, s48, 7
    s_mul_i32 s48, s48, 768
    s_add_u32 s48, s48, s54
    s_add_u32 s48, s48, 0
    s_add_u32 m0, s55, 114688
    s_nop 0
    buffer_load_dwordx4 v8, s[28:31], s48 offen offset:0 sc1 lds
    buffer_load_dwordx4 v9, s[28:31], s48 offen offset:1024 sc1 lds
    buffer_load_dwordx4 v10, s[28:31], s48 offen offset:2048 sc1 lds
    s_add_u32 s48, s48, 24576
    s_add_u32 m0, s55, 117760
    s_nop 0
    buffer_load_dwordx4 v8, s[28:31], s48 offen offset:0 sc1 lds
    buffer_load_dwordx4 v9, s[28:31], s48 offen offset:1024 sc1 lds
    buffer_load_dwordx4 v10, s[28:31], s48 offen offset:2048 sc1 lds
    s_add_u32 s48, s96, 1
    s_and_b32 s48, s48, 7
    s_mul_i32 s48, s48, 768
    s_add_u32 s48, s48, s54
    s_add_u32 s48, s48, 196608
    s_add_u32 m0, s55, 16384
    s_nop 0
    buffer_load_dwordx4 v8, s[28:31], s48 offen offset:0 sc1 lds
    buffer_load_dwordx4 v9, s[28:31], s48 offen offset:1024 sc1 lds
    buffer_load_dwordx4 v10, s[28:31], s48 offen offset:2048 sc1 lds
    s_add_u32 s48, s48, 24576
    s_add_u32 m0, s55, 19456
    s_nop 0
    buffer_load_dwordx4 v8, s[28:31], s48 offen offset:0 sc1 lds
    buffer_load_dwordx4 v9, s[28:31], s48 offen offset:1024 sc1 lds
    buffer_load_dwordx4 v10, s[28:31], s48 offen offset:2048 sc1 lds
    s_barrier
    s_add_u32 s48, s96, 2
    s_and_b32 s48, s48, 7
    s_mul_i32 s48, s48, 768
    s_add_u32 s48, s48, s54
    s_add_u32 s48, s48, 0
    s_add_u32 m0, s55, 40960
    s_nop 0
    buffer_load_dwordx4 v8, s[28:31], s48 offen offset:0 sc1 lds
    v_mov_b32 v112, 0xbdd2d3e8
    v_mul_f32 v88, v32, v32
    v_mul_f32 v89, v33, v33
    v_mul_f32 v90, v34, v34
    v_mul_f32 v91, v35, v35
    buffer_load_dwordx4 v9, s[28:31], s48 offen offset:1024 sc1 lds
    v_mul_f32 v92, v36, v36
    v_mul_f32 v93, v37, v37
    v_mul_f32 v94, v38, v38
    v_mul_f32 v95, v39, v39
    v_fmaak_f32 v88, v88, v112, 0xc0135761
    buffer_load_dwordx4 v10, s[28:31], s48 offen offset:2048 sc1 lds
    v_fmaak_f32 v89, v89, v112, 0xc0135761
    v_fmaak_f32 v90, v90, v112, 0xc0135761
    v_fmaak_f32 v91, v91, v112, 0xc0135761
    v_fmaak_f32 v92, v92, v112, 0xc0135761
    v_fmaak_f32 v93, v93, v112, 0xc0135761
    s_add_u32 s48, s48, 24576
    s_add_u32 m0, s55, 44032
    s_nop 0
    buffer_load_dwordx4 v8, s[28:31], s48 offen offset:0 sc1 lds
    v_fmaak_f32 v94, v94, v112, 0xc0135761
    v_fmaak_f32 v95, v95, v112, 0xc0135761
    v_mul_f32 v88, v88, v32
    v_mul_f32 v89, v89, v33
    v_mul_f32 v90, v90, v34
    buffer_load_dwordx4 v9, s[28:31], s48 offen offset:1024 sc1 lds
    v_mul_f32 v91, v91, v35
    v_mul_f32 v92, v92, v36
    v_mul_f32 v93, v93, v37
    v_mul_f32 v94, v94, v38
    v_mul_f32 v95, v95, v39
    buffer_load_dwordx4 v10, s[28:31], s48 offen offset:2048 sc1 lds
    v_exp_f32 v88, v88
    v_exp_f32 v89, v89
    v_exp_f32 v90, v90
    v_exp_f32 v91, v91
    v_exp_f32 v92, v92
    s_waitcnt vmcnt(12)
    s_barrier
    s_and_b32 s48, s50, 16383
    s_add_u32 m0, s51, 0
    s_nop 0
    buffer_load_dwordx4 v11, s[20:23], s48 offen lds
    v_exp_f32 v93, v93
    v_exp_f32 v94, v94
    v_exp_f32 v95, v95
    v_add_f32 v88, 1.0, v88
    v_add_f32 v89, 1.0, v89
    s_add_u32 s48, s96, 2
    s_and_b32 s48, s48, 7
    s_mul_i32 s48, s48, 768
    s_add_u32 s48, s48, s54
    s_add_u32 s48, s48, 196608
    s_add_u32 m0, s55, 65536
    s_nop 0
    buffer_load_dwordx4 v8, s[28:31], s48 offen offset:0 sc1 lds
    v_add_f32 v90, 1.0, v90
    v_add_f32 v91, 1.0, v91
    v_add_f32 v92, 1.0, v92
    v_add_f32 v93, 1.0, v93
    v_add_f32 v94, 1.0, v94
    buffer_load_dwordx4 v9, s[28:31], s48 offen offset:1024 sc1 lds
    v_add_f32 v95, 1.0, v95
    v_rcp_f32 v88, v88
    v_rcp_f32 v89, v89
    v_rcp_f32 v90, v90
    v_rcp_f32 v91, v91
    buffer_load_dwordx4 v10, s[28:31], s48 offen offset:2048 sc1 lds
    v_rcp_f32 v92, v92
    v_rcp_f32 v93, v93
    v_rcp_f32 v94, v94
    v_rcp_f32 v95, v95
    v_mul_f32 v32, v32, v88
    s_add_u32 s48, s48, 24576
    s_add_u32 m0, s55, 68608
    s_nop 0
    buffer_load_dwordx4 v8, s[28:31], s48 offen offset:0 sc1 lds
    v_mul_f32 v33, v33, v89
    v_mul_f32 v34, v34, v90
    v_mul_f32 v35, v35, v91
    v_mul_f32 v36, v36, v92
    v_mul_f32 v37, v37, v93
    buffer_load_dwordx4 v9, s[28:31], s48 offen offset:1024 sc1 lds
    v_mul_f32 v38, v38, v94
    v_mul_f32 v39, v39, v95
    v_mul_f32 v96, v40, v40
    v_mul_f32 v97, v41, v41
    v_mul_f32 v98, v42, v42
    buffer_load_dwordx4 v10, s[28:31], s48 offen offset:2048 sc1 lds
    v_mul_f32 v99, v43, v43
    v_mul_f32 v100, v44, v44
    v_mul_f32 v101, v45, v45
    v_mul_f32 v102, v46, v46
    v_mul_f32 v103, v47, v47
    s_waitcnt vmcnt(13)
    s_barrier
    s_add_u32 s48, s50, 16384
    s_add_u32 m0, s51, 4096
    s_nop 0
    buffer_load_dwordx4 v11, s[20:23], s48 offen lds
    v_fmaak_f32 v96, v96, v112, 0xc0135761
    v_fmaak_f32 v97, v97, v112, 0xc0135761
    v_fmaak_f32 v98, v98, v112, 0xc0135761
    v_fmaak_f32 v99, v99, v112, 0xc0135761
    v_fmaak_f32 v100, v100, v112, 0xc0135761
    s_add_u32 s48, s96, 3
    s_and_b32 s48, s48, 7
    s_mul_i32 s48, s48, 768
    s_add_u32 s48, s48, s54
    s_add_u32 s48, s48, 0
    s_add_u32 m0, s55, 90112
    s_nop 0
    buffer_load_dwordx4 v8, s[28:31], s48 offen offset:0 sc1 lds
    v_fmaak_f32 v101, v101, v112, 0xc0135761
    v_fmaak_f32 v102, v102, v112, 0xc0135761
    v_fmaak_f32 v103, v103, v112, 0xc0135761
    v_mul_f32 v96, v96, v40
    v_mul_f32 v97, v97, v41
    buffer_load_dwordx4 v9, s[28:31], s48 offen offset:1024 sc1 lds
    v_mul_f32 v98, v98, v42
    v_mul_f32 v99, v99, v43
    v_mul_f32 v100, v100, v44
    v_mul_f32 v101, v101, v45
    v_mul_f32 v102, v102, v46
    buffer_load_dwordx4 v10, s[28:31], s48 offen offset:2048 sc1 lds
    v_mul_f32 v103, v103, v47
    v_exp_f32 v96, v96
    v_exp_f32 v97, v97
    v_exp_f32 v98, v98
    v_exp_f32 v99, v99
    s_add_u32 s48, s48, 24576
    s_add_u32 m0, s55, 93184
    s_nop 0
    buffer_load_dwordx4 v8, s[28:31], s48 offen offset:0 sc1 lds
    v_exp_f32 v100, v100
    v_exp_f32 v101, v101
    v_exp_f32 v102, v102
    v_exp_f32 v103, v103
    v_add_f32 v96, 1.0, v96
    buffer_load_dwordx4 v9, s[28:31], s48 offen offset:1024 sc1 lds
    v_add_f32 v97, 1.0, v97
    v_add_f32 v98, 1.0, v98
    v_add_f32 v99, 1.0, v99
    v_add_f32 v100, 1.0, v100
    v_add_f32 v101, 1.0, v101
    buffer_load_dwordx4 v10, s[28:31], s48 offen offset:2048 sc1 lds
    v_add_f32 v102, 1.0, v102
    v_add_f32 v103, 1.0, v103
    v_rcp_f32 v96, v96
    v_rcp_f32 v97, v97
    v_rcp_f32 v98, v98
    s_waitcnt vmcnt(14)
    s_barrier
    s_add_u32 s48, s50, 49152
    s_add_u32 m0, s51, 8192
    s_nop 0
    buffer_load_dwordx4 v11, s[20:23], s48 offen lds
    v_rcp_f32 v99, v99
    v_rcp_f32 v100, v100
    v_rcp_f32 v101, v101
    v_rcp_f32 v102, v102
    v_rcp_f32 v103, v103
    s_add_u32 s48, s96, 3
    s_and_b32 s48, s48, 7
    s_mul_i32 s48, s48, 768
    s_add_u32 s48, s48, s54
    s_add_u32 s48, s48, 196608
    s_add_u32 m0, s55, 114688
    s_nop 0
    buffer_load_dwordx4 v8, s[28:31], s48 offen offset:0 sc1 lds
    v_mul_f32 v40, v40, v96
    v_mul_f32 v41, v41, v97
    v_mul_f32 v42, v42, v98
    v_mul_f32 v43, v43, v99
    v_mul_f32 v44, v44, v100
    buffer_load_dwordx4 v9, s[28:31], s48 offen offset:1024 sc1 lds
    v_mul_f32 v45, v45, v101
    v_mul_f32 v46, v46, v102
    v_mul_f32 v47, v47, v103
    v_mul_f32 v104, v48, v48
    v_mul_f32 v105, v49, v49
    buffer_load_dwordx4 v10, s[28:31], s48 offen offset:2048 sc1 lds
    v_mul_f32 v106, v50, v50
    v_mul_f32 v107, v51, v51
    v_mul_f32 v108, v52, v52
    v_mul_f32 v109, v53, v53
    v_mul_f32 v110, v54, v54
    s_add_u32 s48, s48, 24576
    s_add_u32 m0, s55, 117760
    s_nop 0
    buffer_load_dwordx4 v8, s[28:31], s48 offen offset:0 sc1 lds
    v_mul_f32 v111, v55, v55
    v_fmaak_f32 v104, v104, v112, 0xc0135761
    v_fmaak_f32 v105, v105, v112, 0xc0135761
    v_fmaak_f32 v106, v106, v112, 0xc0135761
    v_fmaak_f32 v107, v107, v112, 0xc0135761
    buffer_load_dwordx4 v9, s[28:31], s48 offen offset:1024 sc1 lds
    v_fmaak_f32 v108, v108, v112, 0xc0135761
    v_fmaak_f32 v109, v109, v112, 0xc0135761
    v_fmaak_f32 v110, v110, v112, 0xc0135761
    v_fmaak_f32 v111, v111, v112, 0xc0135761
    v_mul_f32 v104, v104, v48
    buffer_load_dwordx4 v10, s[28:31], s48 offen offset:2048 sc1 lds
    v_mul_f32 v105, v105, v49
    v_mul_f32 v106, v106, v50
    v_mul_f32 v107, v107, v51
    v_mul_f32 v108, v108, v52
    v_mul_f32 v109, v109, v53
    s_waitcnt vmcnt(14)
    s_barrier
    s_add_u32 s48, s50, 81920
    s_add_u32 m0, s51, 12288
    s_nop 0
    buffer_load_dwordx4 v11, s[20:23], s48 offen lds
    v_mul_f32 v110, v110, v54
    v_mul_f32 v111, v111, v55
    v_exp_f32 v104, v104
    v_exp_f32 v105, v105
    v_exp_f32 v106, v106
    s_add_u32 s48, s96, 4
    s_and_b32 s48, s48, 7
    s_mul_i32 s48, s48, 768
    s_add_u32 s48, s48, s54
    s_add_u32 s48, s48, 0
    s_add_u32 m0, s55, 16384
    s_nop 0
    buffer_load_dwordx4 v8, s[28:31], s48 offen offset:0 sc1 lds
    v_exp_f32 v107, v107
    v_exp_f32 v108, v108
    v_exp_f32 v109, v109
    v_exp_f32 v110, v110
    v_exp_f32 v111, v111
    buffer_load_dwordx4 v9, s[28:31], s48 offen offset:1024 sc1 lds
    v_add_f32 v104, 1.0, v104
    v_add_f32 v105, 1.0, v105
    v_add_f32 v106, 1.0, v106
    v_add_f32 v107, 1.0, v107
    v_add_f32 v108, 1.0, v108
    buffer_load_dwordx4 v10, s[28:31], s48 offen offset:2048 sc1 lds
    v_add_f32 v109, 1.0, v109
    v_add_f32 v110, 1.0, v110
    v_add_f32 v111, 1.0, v111
    v_rcp_f32 v104, v104
    v_rcp_f32 v105, v105
    s_add_u32 s48, s48, 24576
    s_add_u32 m0, s55, 19456
    s_nop 0
    buffer_load_dwordx4 v8, s[28:31], s48 offen offset:0 sc1 lds
    v_rcp_f32 v106, v106
    v_rcp_f32 v107, v107
    v_rcp_f32 v108, v108
    v_rcp_f32 v109, v109
    v_rcp_f32 v110, v110
    buffer_load_dwordx4 v9, s[28:31], s48 offen offset:1024 sc1 lds
    v_rcp_f32 v111, v111
    v_mul_f32 v48, v48, v104
    v_mul_f32 v49, v49, v105
    v_mul_f32 v50, v50, v106
    v_mul_f32 v51, v51, v107
    buffer_load_dwordx4 v10, s[28:31], s48 offen offset:2048 sc1 lds
    v_mul_f32 v52, v52, v108
    v_mul_f32 v53, v53, v109
    v_mul_f32 v54, v54, v110
    v_mul_f32 v55, v55, v111
    v_cvt_pk_bf16_f32 v20, v32, v33
    s_waitcnt vmcnt(14)
    s_barrier
    s_add_u32 s48, s50, 114688
    s_add_u32 m0, s51, 139264
    s_nop 0
    buffer_load_dwordx4 v11, s[20:23], s48 offen lds
    v_cvt_pk_bf16_f32 v21, v34, v35
    v_cvt_pk_bf16_f32 v22, v36, v37
    v_cvt_pk_bf16_f32 v23, v38, v39
    v_cvt_pk_bf16_f32 v24, v40, v41
    v_cvt_pk_bf16_f32 v25, v42, v43
    s_add_u32 s48, s96, 4
    s_and_b32 s48, s48, 7
    s_mul_i32 s48, s48, 768
    s_add_u32 s48, s48, s54
    s_add_u32 s48, s48, 196608
    s_add_u32 m0, s55, 40960
    s_nop 0
    buffer_load_dwordx4 v8, s[28:31], s48 offen offset:0 sc1 lds
    v_cvt_pk_bf16_f32 v26, v44, v45
    v_cvt_pk_bf16_f32 v27, v46, v47
    v_cvt_pk_bf16_f32 v28, v48, v49
    v_cvt_pk_bf16_f32 v29, v50, v51
    v_cvt_pk_bf16_f32 v30, v52, v53
    buffer_load_dwordx4 v9, s[28:31], s48 offen offset:1024 sc1 lds
    v_cvt_pk_bf16_f32 v31, v54, v55
    buffer_load_dwordx4 v10, s[28:31], s48 offen offset:2048 sc1 lds
    s_add_u32 s48, s48, 24576
    s_add_u32 m0, s55, 44032
    s_nop 0
    buffer_load_dwordx4 v8, s[28:31], s48 offen offset:0 sc1 lds
    buffer_load_dwordx4 v9, s[28:31], s48 offen offset:1024 sc1 lds
    buffer_load_dwordx4 v10, s[28:31], s48 offen offset:2048 sc1 lds
    s_waitcnt vmcnt(14)
    s_barrier
    s_add_u32 s48, s50, 147456
    s_add_u32 m0, s51, 143360
    s_nop 0
    buffer_load_dwordx4 v11, s[20:23], s48 offen lds
    s_add_u32 s48, s96, 5
    s_and_b32 s48, s48, 7
    s_mul_i32 s48, s48, 768
    s_add_u32 s48, s48, s54
    s_add_u32 s48, s48, 0
    s_add_u32 m0, s55, 65536
    s_nop 0
    buffer_load_dwordx4 v8, s[28:31], s48 offen offset:0 sc1 lds
    buffer_load_dwordx4 v9, s[28:31], s48 offen offset:1024 sc1 lds
    buffer_load_dwordx4 v10, s[28:31], s48 offen offset:2048 sc1 lds
    s_add_u32 s48, s48, 24576
    s_add_u32 m0, s55, 68608
    s_nop 0
    buffer_load_dwordx4 v8, s[28:31], s48 offen offset:0 sc1 lds
    buffer_load_dwordx4 v9, s[28:31], s48 offen offset:1024 sc1 lds
    buffer_load_dwordx4 v10, s[28:31], s48 offen offset:2048 sc1 lds
    s_waitcnt vmcnt(14)
    s_barrier
    ds_read_b64_tr_b16 v[112:113], v12 offset:0
    ds_read_b64_tr_b16 v[114:115], v12 offset:3072
    ds_read_b64_tr_b16 v[116:117], v13 offset:0
    ds_read_b64_tr_b16 v[118:119], v13 offset:3072
    ds_read_b64_tr_b16 v[120:121], v12 offset:256
    ds_read_b64_tr_b16 v[122:123], v12 offset:3328
    ds_read_b64_tr_b16 v[124:125], v13 offset:256
    ds_read_b64_tr_b16 v[126:127], v13 offset:3328
    ds_read_b64_tr_b16 v[56:57], v12 offset:512
    ds_read_b64_tr_b16 v[58:59], v12 offset:3584
    ds_read_b64_tr_b16 v[60:61], v13 offset:512
    ds_read_b64_tr_b16 v[62:63], v13 offset:3584
    ds_read_b64_tr_b16 v[32:33], v12 offset:6144
    ds_read_b64_tr_b16 v[34:35], v12 offset:9216
    ds_read_b64_tr_b16 v[36:37], v13 offset:6144
    ds_read_b64_tr_b16 v[38:39], v13 offset:9216
    ds_read_b64_tr_b16 v[40:41], v12 offset:6400
    ds_read_b64_tr_b16 v[42:43], v12 offset:9472
    ds_read_b64_tr_b16 v[44:45], v13 offset:6400
    ds_read_b64_tr_b16 v[46:47], v13 offset:9472
    ds_read_b64_tr_b16 v[48:49], v12 offset:6656
    ds_read_b64_tr_b16 v[50:51], v12 offset:9728
    ds_read_b64_tr_b16 v[52:53], v13 offset:6656
    ds_read_b64_tr_b16 v[54:55], v13 offset:9728
    s_waitcnt lgkmcnt(12)
    v_mfma_f32_16x16x32_bf16 v[64:67], v[112:115], v[192:195], 0
    ds_read_b64_tr_b16 v[88:89], v12 offset:12288
    ds_read_b64_tr_b16 v[90:91], v12 offset:15360
    v_mfma_f32_16x16x32_bf16 v[68:71], v[116:119], v[192:195], 0
    ds_read_b64_tr_b16 v[92:93], v13 offset:12288
    ds_read_b64_tr_b16 v[94:95], v13 offset:15360
    v_mfma_f32_16x16x32_bf16 v[72:75], v[120:123], v[192:195], 0
    ds_read_b64_tr_b16 v[96:97], v12 offset:12544
    ds_read_b64_tr_b16 v[98:99], v12 offset:15616
    v_mfma_f32_16x16x32_bf16 v[76:79], v[124:127], v[192:195], 0
    ds_read_b64_tr_b16 v[100:101], v13 offset:12544
    ds_read_b64_tr_b16 v[102:103], v13 offset:15616
    v_mfma_f32_16x16x32_bf16 v[80:83], v[56:59], v[192:195], 0
    ds_read_b64_tr_b16 v[104:105], v12 offset:12800
    ds_read_b64_tr_b16 v[106:107], v12 offset:15872
    v_mfma_f32_16x16x32_bf16 v[84:87], v[60:63], v[192:195], 0
    ds_read_b64_tr_b16 v[108:109], v13 offset:12800
    ds_read_b64_tr_b16 v[110:111], v13 offset:15872
    s_waitcnt lgkmcnt(12)
    v_mfma_f32_16x16x32_bf16 v[64:67], v[32:35], v[196:199], v[64:67]
    ds_read_b64_tr_b16 v[112:113], v12 offset:18432
    ds_read_b64_tr_b16 v[114:115], v12 offset:21504
    v_mfma_f32_16x16x32_bf16 v[68:71], v[36:39], v[196:199], v[68:71]
    ds_read_b64_tr_b16 v[116:117], v13 offset:18432
    ds_read_b64_tr_b16 v[118:119], v13 offset:21504
    v_mfma_f32_16x16x32_bf16 v[72:75], v[40:43], v[196:199], v[72:75]
    ds_read_b64_tr_b16 v[120:121], v12 offset:18688
    ds_read_b64_tr_b16 v[122:123], v12 offset:21760
    v_mfma_f32_16x16x32_bf16 v[76:79], v[44:47], v[196:199], v[76:79]
    ds_read_b64_tr_b16 v[124:125], v13 offset:18688
    ds_read_b64_tr_b16 v[126:127], v13 offset:21760
    v_mfma_f32_16x16x32_bf16 v[80:83], v[48:51], v[196:199], v[80:83]
    ds_read_b64_tr_b16 v[56:57], v12 offset:18944
    ds_read_b64_tr_b16 v[58:59], v12 offset:22016
    v_mfma_f32_16x16x32_bf16 v[84:87], v[52:55], v[196:199], v[84:87]
    ds_read_b64_tr_b16 v[60:61], v13 offset:18944
    ds_read_b64_tr_b16 v[62:63], v13 offset:22016
    s_waitcnt vmcnt(7)
    s_barrier
    s_waitcnt lgkmcnt(12)
    v_mfma_f32_16x16x32_bf16 v[64:67], v[88:91], v[200:203], v[64:67]
    ds_read_b64_tr_b16 v[32:33], v12 offset:24576
    ds_read_b64_tr_b16 v[34:35], v12 offset:27648
    v_mfma_f32_16x16x32_bf16 v[68:71], v[92:95], v[200:203], v[68:71]
    ds_read_b64_tr_b16 v[36:37], v13 offset:24576
    ds_read_b64_tr_b16 v[38:39], v13 offset:27648
    v_mfma_f32_16x16x32_bf16 v[72:75], v[96:99], v[200:203], v[72:75]
    ds_read_b64_tr_b16 v[40:41], v12 offset:24832
    ds_read_b64_tr_b16 v[42:43], v12 offset:27904
    v_mfma_f32_16x16x32_bf16 v[76:79], v[100:103], v[200:203], v[76:79]
    ds_read_b64_tr_b16 v[44:45], v13 offset:24832
    ds_read_b64_tr_b16 v[46:47], v13 offset:27904
    v_mfma_f32_16x16x32_bf16 v[80:83], v[104:107], v[200:203], v[80:83]
    ds_read_b64_tr_b16 v[48:49], v12 offset:25088
    ds_read_b64_tr_b16 v[50:51], v12 offset:28160
    v_mfma_f32_16x16x32_bf16 v[84:87], v[108:111], v[200:203], v[84:87]
    ds_read_b64_tr_b16 v[52:53], v13 offset:25088
    ds_read_b64_tr_b16 v[54:55], v13 offset:28160
    s_waitcnt lgkmcnt(12)
    v_mfma_f32_16x16x32_bf16 v[64:67], v[112:115], v[204:207], v[64:67]
    ds_read_b64_tr_b16 v[88:89], v12 offset:30720
    ds_read_b64_tr_b16 v[90:91], v12 offset:33792
    v_mfma_f32_16x16x32_bf16 v[68:71], v[116:119], v[204:207], v[68:71]
    ds_read_b64_tr_b16 v[92:93], v13 offset:30720
    ds_read_b64_tr_b16 v[94:95], v13 offset:33792
    v_mfma_f32_16x16x32_bf16 v[72:75], v[120:123], v[204:207], v[72:75]
    ds_read_b64_tr_b16 v[96:97], v12 offset:30976
    ds_read_b64_tr_b16 v[98:99], v12 offset:34048
    v_mfma_f32_16x16x32_bf16 v[76:79], v[124:127], v[204:207], v[76:79]
    ds_read_b64_tr_b16 v[100:101], v13 offset:30976
    ds_read_b64_tr_b16 v[102:103], v13 offset:34048
    v_mfma_f32_16x16x32_bf16 v[80:83], v[56:59], v[204:207], v[80:83]
    ds_read_b64_tr_b16 v[104:105], v12 offset:31232
    ds_read_b64_tr_b16 v[106:107], v12 offset:34304
    v_mfma_f32_16x16x32_bf16 v[84:87], v[60:63], v[204:207], v[84:87]
    ds_read_b64_tr_b16 v[108:109], v13 offset:31232
    ds_read_b64_tr_b16 v[110:111], v13 offset:34304
    s_waitcnt lgkmcnt(12)
    v_mfma_f32_16x16x32_bf16 v[64:67], v[32:35], v[208:211], v[64:67]
    ds_read_b64_tr_b16 v[112:113], v12 offset:36864
    ds_read_b64_tr_b16 v[114:115], v12 offset:39936
    v_mfma_f32_16x16x32_bf16 v[68:71], v[36:39], v[208:211], v[68:71]
    ds_read_b64_tr_b16 v[116:117], v13 offset:36864
    ds_read_b64_tr_b16 v[118:119], v13 offset:39936
    v_mfma_f32_16x16x32_bf16 v[72:75], v[40:43], v[208:211], v[72:75]
    ds_read_b64_tr_b16 v[120:121], v12 offset:37120
    ds_read_b64_tr_b16 v[122:123], v12 offset:40192
    v_mfma_f32_16x16x32_bf16 v[76:79], v[44:47], v[208:211], v[76:79]
    ds_read_b64_tr_b16 v[124:125], v13 offset:37120
    ds_read_b64_tr_b16 v[126:127], v13 offset:40192
    v_mfma_f32_16x16x32_bf16 v[80:83], v[48:51], v[208:211], v[80:83]
    ds_read_b64_tr_b16 v[56:57], v12 offset:37376
    ds_read_b64_tr_b16 v[58:59], v12 offset:40448
    v_mfma_f32_16x16x32_bf16 v[84:87], v[52:55], v[208:211], v[84:87]
    ds_read_b64_tr_b16 v[60:61], v13 offset:37376
    ds_read_b64_tr_b16 v[62:63], v13 offset:40448
    s_waitcnt lgkmcnt(12)
    v_mfma_f32_16x16x32_bf16 v[64:67], v[88:91], v[212:215], v[64:67]
    ds_read_b64_tr_b16 v[32:33], v12 offset:43008
    ds_read_b64_tr_b16 v[34:35], v12 offset:46080
    v_mfma_f32_16x16x32_bf16 v[68:71], v[92:95], v[212:215], v[68:71]
    ds_read_b64_tr_b16 v[36:37], v13 offset:43008
    ds_read_b64_tr_b16 v[38:39], v13 offset:46080
    v_mfma_f32_16x16x32_bf16 v[72:75], v[96:99], v[212:215], v[72:75]
    ds_read_b64_tr_b16 v[40:41], v12 offset:43264
    ds_read_b64_tr_b16 v[42:43], v12 offset:46336
    v_mfma_f32_16x16x32_bf16 v[76:79], v[100:103], v[212:215], v[76:79]
    ds_read_b64_tr_b16 v[44:45], v13 offset:43264
    ds_read_b64_tr_b16 v[46:47], v13 offset:46336
    v_mfma_f32_16x16x32_bf16 v[80:83], v[104:107], v[212:215], v[80:83]
    ds_read_b64_tr_b16 v[48:49], v12 offset:43520
    ds_read_b64_tr_b16 v[50:51], v12 offset:46592
    v_mfma_f32_16x16x32_bf16 v[84:87], v[108:111], v[212:215], v[84:87]
    ds_read_b64_tr_b16 v[52:53], v13 offset:43520
    ds_read_b64_tr_b16 v[54:55], v13 offset:46592
    s_waitcnt vmcnt(0)
    s_barrier
    s_waitcnt lgkmcnt(12)
    v_mfma_f32_16x16x32_bf16 v[64:67], v[112:115], v[216:219], v[64:67]
    ds_read_b64_tr_b16 v[88:89], v14 offset:0
    ds_read_b64_tr_b16 v[90:91], v14 offset:3072
    v_mfma_f32_16x16x32_bf16 v[68:71], v[116:119], v[216:219], v[68:71]
    ds_read_b64_tr_b16 v[92:93], v15 offset:0
    ds_read_b64_tr_b16 v[94:95], v15 offset:3072
    v_mfma_f32_16x16x32_bf16 v[72:75], v[120:123], v[216:219], v[72:75]
    ds_read_b64_tr_b16 v[96:97], v14 offset:256
    ds_read_b64_tr_b16 v[98:99], v14 offset:3328
    v_mfma_f32_16x16x32_bf16 v[76:79], v[124:127], v[216:219], v[76:79]
    ds_read_b64_tr_b16 v[100:101], v15 offset:256
    ds_read_b64_tr_b16 v[102:103], v15 offset:3328
    v_mfma_f32_16x16x32_bf16 v[80:83], v[56:59], v[216:219], v[80:83]
    ds_read_b64_tr_b16 v[104:105], v14 offset:512
    ds_read_b64_tr_b16 v[106:107], v14 offset:3584
    v_mfma_f32_16x16x32_bf16 v[84:87], v[60:63], v[216:219], v[84:87]
    ds_read_b64_tr_b16 v[108:109], v15 offset:512
    ds_read_b64_tr_b16 v[110:111], v15 offset:3584
    s_waitcnt lgkmcnt(12)
    v_mfma_f32_16x16x32_bf16 v[64:67], v[32:35], v[220:223], v[64:67]
    ds_read_b64_tr_b16 v[112:113], v14 offset:6144
    ds_read_b64_tr_b16 v[114:115], v14 offset:9216
    v_mfma_f32_16x16x32_bf16 v[68:71], v[36:39], v[220:223], v[68:71]
    ds_read_b64_tr_b16 v[116:117], v15 offset:6144
    ds_read_b64_tr_b16 v[118:119], v15 offset:9216
    v_mfma_f32_16x16x32_bf16 v[72:75], v[40:43], v[220:223], v[72:75]
    ds_read_b64_tr_b16 v[120:121], v14 offset:6400
    ds_read_b64_tr_b16 v[122:123], v14 offset:9472
    v_mfma_f32_16x16x32_bf16 v[76:79], v[44:47], v[220:223], v[76:79]
    ds_read_b64_tr_b16 v[124:125], v15 offset:6400
    ds_read_b64_tr_b16 v[126:127], v15 offset:9472
    v_mfma_f32_16x16x32_bf16 v[80:83], v[48:51], v[220:223], v[80:83]
    ds_read_b64_tr_b16 v[56:57], v14 offset:6656
    ds_read_b64_tr_b16 v[58:59], v14 offset:9728
    v_mfma_f32_16x16x32_bf16 v[84:87], v[52:55], v[220:223], v[84:87]
    ds_read_b64_tr_b16 v[60:61], v15 offset:6656
    ds_read_b64_tr_b16 v[62:63], v15 offset:9728
    s_waitcnt lgkmcnt(12)
    v_mfma_f32_16x16x32_bf16 v[64:67], v[88:91], v[224:227], v[64:67]
    ds_read_b64_tr_b16 v[32:33], v14 offset:12288
    ds_read_b64_tr_b16 v[34:35], v14 offset:15360
    v_mfma_f32_16x16x32_bf16 v[68:71], v[92:95], v[224:227], v[68:71]
    ds_read_b64_tr_b16 v[36:37], v15 offset:12288
    ds_read_b64_tr_b16 v[38:39], v15 offset:15360
    v_mfma_f32_16x16x32_bf16 v[72:75], v[96:99], v[224:227], v[72:75]
    ds_read_b64_tr_b16 v[40:41], v14 offset:12544
    ds_read_b64_tr_b16 v[42:43], v14 offset:15616
    v_mfma_f32_16x16x32_bf16 v[76:79], v[100:103], v[224:227], v[76:79]
    ds_read_b64_tr_b16 v[44:45], v15 offset:12544
    ds_read_b64_tr_b16 v[46:47], v15 offset:15616
    v_mfma_f32_16x16x32_bf16 v[80:83], v[104:107], v[224:227], v[80:83]
    ds_read_b64_tr_b16 v[48:49], v14 offset:12800
    ds_read_b64_tr_b16 v[50:51], v14 offset:15872
    v_mfma_f32_16x16x32_bf16 v[84:87], v[108:111], v[224:227], v[84:87]
    ds_read_b64_tr_b16 v[52:53], v15 offset:12800
    ds_read_b64_tr_b16 v[54:55], v15 offset:15872
    s_waitcnt lgkmcnt(12)
    v_mfma_f32_16x16x32_bf16 v[64:67], v[112:115], v[228:231], v[64:67]
    ds_read_b64_tr_b16 v[88:89], v14 offset:18432
    ds_read_b64_tr_b16 v[90:91], v14 offset:21504
    v_mfma_f32_16x16x32_bf16 v[68:71], v[116:119], v[228:231], v[68:71]
    ds_read_b64_tr_b16 v[92:93], v15 offset:18432
    ds_read_b64_tr_b16 v[94:95], v15 offset:21504
    v_mfma_f32_16x16x32_bf16 v[72:75], v[120:123], v[228:231], v[72:75]
    ds_read_b64_tr_b16 v[96:97], v14 offset:18688
    ds_read_b64_tr_b16 v[98:99], v14 offset:21760
    v_mfma_f32_16x16x32_bf16 v[76:79], v[124:127], v[228:231], v[76:79]
    ds_read_b64_tr_b16 v[100:101], v15 offset:18688
    ds_read_b64_tr_b16 v[102:103], v15 offset:21760
    v_mfma_f32_16x16x32_bf16 v[80:83], v[56:59], v[228:231], v[80:83]
    ds_read_b64_tr_b16 v[104:105], v14 offset:18944
    ds_read_b64_tr_b16 v[106:107], v14 offset:22016
    v_mfma_f32_16x16x32_bf16 v[84:87], v[60:63], v[228:231], v[84:87]
    ds_read_b64_tr_b16 v[108:109], v15 offset:18944
    ds_read_b64_tr_b16 v[110:111], v15 offset:22016
    s_barrier
    s_waitcnt lgkmcnt(12)
    v_mfma_f32_16x16x32_bf16 v[64:67], v[32:35], v[232:235], v[64:67]
    ds_read_b64_tr_b16 v[112:113], v14 offset:24576
    ds_read_b64_tr_b16 v[114:115], v14 offset:27648
    v_mfma_f32_16x16x32_bf16 v[68:71], v[36:39], v[232:235], v[68:71]
    ds_read_b64_tr_b16 v[116:117], v15 offset:24576
    ds_read_b64_tr_b16 v[118:119], v15 offset:27648
    v_mfma_f32_16x16x32_bf16 v[72:75], v[40:43], v[232:235], v[72:75]
    ds_read_b64_tr_b16 v[120:121], v14 offset:24832
    ds_read_b64_tr_b16 v[122:123], v14 offset:27904
    v_mfma_f32_16x16x32_bf16 v[76:79], v[44:47], v[232:235], v[76:79]
    ds_read_b64_tr_b16 v[124:125], v15 offset:24832
    ds_read_b64_tr_b16 v[126:127], v15 offset:27904
    v_mfma_f32_16x16x32_bf16 v[80:83], v[48:51], v[232:235], v[80:83]
    ds_read_b64_tr_b16 v[56:57], v14 offset:25088
    ds_read_b64_tr_b16 v[58:59], v14 offset:28160
    v_mfma_f32_16x16x32_bf16 v[84:87], v[52:55], v[232:235], v[84:87]
    ds_read_b64_tr_b16 v[60:61], v15 offset:25088
    ds_read_b64_tr_b16 v[62:63], v15 offset:28160
    s_waitcnt lgkmcnt(12)
    v_mfma_f32_16x16x32_bf16 v[64:67], v[88:91], v[236:239], v[64:67]
    ds_read_b64_tr_b16 v[32:33], v14 offset:30720
    ds_read_b64_tr_b16 v[34:35], v14 offset:33792
    v_mfma_f32_16x16x32_bf16 v[68:71], v[92:95], v[236:239], v[68:71]
    ds_read_b64_tr_b16 v[36:37], v15 offset:30720
    ds_read_b64_tr_b16 v[38:39], v15 offset:33792
    v_mfma_f32_16x16x32_bf16 v[72:75], v[96:99], v[236:239], v[72:75]
    ds_read_b64_tr_b16 v[40:41], v14 offset:30976
    ds_read_b64_tr_b16 v[42:43], v14 offset:34048
    v_mfma_f32_16x16x32_bf16 v[76:79], v[100:103], v[236:239], v[76:79]
    ds_read_b64_tr_b16 v[44:45], v15 offset:30976
    ds_read_b64_tr_b16 v[46:47], v15 offset:34048
    v_mfma_f32_16x16x32_bf16 v[80:83], v[104:107], v[236:239], v[80:83]
    ds_read_b64_tr_b16 v[48:49], v14 offset:31232
    ds_read_b64_tr_b16 v[50:51], v14 offset:34304
    v_mfma_f32_16x16x32_bf16 v[84:87], v[108:111], v[236:239], v[84:87]
    ds_read_b64_tr_b16 v[52:53], v15 offset:31232
    ds_read_b64_tr_b16 v[54:55], v15 offset:34304
    s_waitcnt lgkmcnt(12)
    v_mfma_f32_16x16x32_bf16 v[64:67], v[112:115], v[240:243], v[64:67]
    ds_read_b64_tr_b16 v[88:89], v14 offset:36864
    ds_read_b64_tr_b16 v[90:91], v14 offset:39936
    v_mfma_f32_16x16x32_bf16 v[68:71], v[116:119], v[240:243], v[68:71]
    ds_read_b64_tr_b16 v[92:93], v15 offset:36864
    ds_read_b64_tr_b16 v[94:95], v15 offset:39936
    v_mfma_f32_16x16x32_bf16 v[72:75], v[120:123], v[240:243], v[72:75]
    ds_read_b64_tr_b16 v[96:97], v14 offset:37120
    ds_read_b64_tr_b16 v[98:99], v14 offset:40192
    v_mfma_f32_16x16x32_bf16 v[76:79], v[124:127], v[240:243], v[76:79]
    ds_read_b64_tr_b16 v[100:101], v15 offset:37120
    ds_read_b64_tr_b16 v[102:103], v15 offset:40192
    v_mfma_f32_16x16x32_bf16 v[80:83], v[56:59], v[240:243], v[80:83]
    ds_read_b64_tr_b16 v[104:105], v14 offset:37376
    ds_read_b64_tr_b16 v[106:107], v14 offset:40448
    v_mfma_f32_16x16x32_bf16 v[84:87], v[60:63], v[240:243], v[84:87]
    ds_read_b64_tr_b16 v[108:109], v15 offset:37376
    ds_read_b64_tr_b16 v[110:111], v15 offset:40448
    s_waitcnt lgkmcnt(12)
    v_mfma_f32_16x16x32_bf16 v[64:67], v[32:35], v[244:247], v[64:67]
    ds_read_b64_tr_b16 v[112:113], v14 offset:43008
    ds_read_b64_tr_b16 v[114:115], v14 offset:46080
    v_mfma_f32_16x16x32_bf16 v[68:71], v[36:39], v[244:247], v[68:71]
    ds_read_b64_tr_b16 v[116:117], v15 offset:43008
    ds_read_b64_tr_b16 v[118:119], v15 offset:46080
    v_mfma_f32_16x16x32_bf16 v[72:75], v[40:43], v[244:247], v[72:75]
    ds_read_b64_tr_b16 v[120:121], v14 offset:43264
    ds_read_b64_tr_b16 v[122:123], v14 offset:46336
    v_mfma_f32_16x16x32_bf16 v[76:79], v[44:47], v[244:247], v[76:79]
    ds_read_b64_tr_b16 v[124:125], v15 offset:43264
    ds_read_b64_tr_b16 v[126:127], v15 offset:46336
    v_mfma_f32_16x16x32_bf16 v[80:83], v[48:51], v[244:247], v[80:83]
    ds_read_b64_tr_b16 v[56:57], v14 offset:43520
    ds_read_b64_tr_b16 v[58:59], v14 offset:46592
    v_mfma_f32_16x16x32_bf16 v[84:87], v[52:55], v[244:247], v[84:87]
    ds_read_b64_tr_b16 v[60:61], v15 offset:43520
    ds_read_b64_tr_b16 v[62:63], v15 offset:46592
    s_barrier
    s_waitcnt lgkmcnt(12)
    v_mfma_f32_16x16x32_bf16 v[64:67], v[88:91], v[248:251], v[64:67]
    ds_read_b64_tr_b16 v[32:33], v6 offset:0
    ds_read_b64_tr_b16 v[34:35], v6 offset:3072
    v_mfma_f32_16x16x32_bf16 v[68:71], v[92:95], v[248:251], v[68:71]
    ds_read_b64_tr_b16 v[36:37], v7 offset:0
    ds_read_b64_tr_b16 v[38:39], v7 offset:3072
    v_mfma_f32_16x16x32_bf16 v[72:75], v[96:99], v[248:251], v[72:75]
    ds_read_b64_tr_b16 v[40:41], v6 offset:256
    ds_read_b64_tr_b16 v[42:43], v6 offset:3328
    v_mfma_f32_16x16x32_bf16 v[76:79], v[100:103], v[248:251], v[76:79]
    ds_read_b64_tr_b16 v[44:45], v7 offset:256
    ds_read_b64_tr_b16 v[46:47], v7 offset:3328
    v_mfma_f32_16x16x32_bf16 v[80:83], v[104:107], v[248:251], v[80:83]
    ds_read_b64_tr_b16 v[48:49], v6 offset:512
    ds_read_b64_tr_b16 v[50:51], v6 offset:3584
    v_mfma_f32_16x16x32_bf16 v[84:87], v[108:111], v[248:251], v[84:87]
    ds_read_b64_tr_b16 v[52:53], v7 offset:512
    ds_read_b64_tr_b16 v[54:55], v7 offset:3584
    s_waitcnt lgkmcnt(12)
    v_mfma_f32_16x16x32_bf16 v[64:67], v[112:115], v[252:255], v[64:67]
    ds_read_b64_tr_b16 v[88:89], v6 offset:6144
    ds_read_b64_tr_b16 v[90:91], v6 offset:9216
    v_mfma_f32_16x16x32_bf16 v[68:71], v[116:119], v[252:255], v[68:71]
    ds_read_b64_tr_b16 v[92:93], v7 offset:6144
    ds_read_b64_tr_b16 v[94:95], v7 offset:9216
    v_mfma_f32_16x16x32_bf16 v[72:75], v[120:123], v[252:255], v[72:75]
    ds_read_b64_tr_b16 v[96:97], v6 offset:6400
    ds_read_b64_tr_b16 v[98:99], v6 offset:9472
    v_mfma_f32_16x16x32_bf16 v[76:79], v[124:127], v[252:255], v[76:79]
    ds_read_b64_tr_b16 v[100:101], v7 offset:6400
    ds_read_b64_tr_b16 v[102:103], v7 offset:9472
    v_mfma_f32_16x16x32_bf16 v[80:83], v[56:59], v[252:255], v[80:83]
    ds_read_b64_tr_b16 v[104:105], v6 offset:6656
    ds_read_b64_tr_b16 v[106:107], v6 offset:9728
    v_mfma_f32_16x16x32_bf16 v[84:87], v[60:63], v[252:255], v[84:87]
    ds_read_b64_tr_b16 v[108:109], v7 offset:6656
    ds_read_b64_tr_b16 v[110:111], v7 offset:9728
    s_waitcnt lgkmcnt(12)
    v_mfma_f32_16x16x32_bf16 v[64:67], v[32:35], v[128:131], v[64:67]
    ds_read_b64_tr_b16 v[112:113], v6 offset:12288
    ds_read_b64_tr_b16 v[114:115], v6 offset:15360
    v_mfma_f32_16x16x32_bf16 v[68:71], v[36:39], v[128:131], v[68:71]
    ds_read_b64_tr_b16 v[116:117], v7 offset:12288
    ds_read_b64_tr_b16 v[118:119], v7 offset:15360
    v_mfma_f32_16x16x32_bf16 v[72:75], v[40:43], v[128:131], v[72:75]
    ds_read_b64_tr_b16 v[120:121], v6 offset:12544
    ds_read_b64_tr_b16 v[122:123], v6 offset:15616
    v_mfma_f32_16x16x32_bf16 v[76:79], v[44:47], v[128:131], v[76:79]
    ds_read_b64_tr_b16 v[124:125], v7 offset:12544
    ds_read_b64_tr_b16 v[126:127], v7 offset:15616
    v_mfma_f32_16x16x32_bf16 v[80:83], v[48:51], v[128:131], v[80:83]
    ds_read_b64_tr_b16 v[56:57], v6 offset:12800
    ds_read_b64_tr_b16 v[58:59], v6 offset:15872
    v_mfma_f32_16x16x32_bf16 v[84:87], v[52:55], v[128:131], v[84:87]
    ds_read_b64_tr_b16 v[60:61], v7 offset:12800
    ds_read_b64_tr_b16 v[62:63], v7 offset:15872
    s_waitcnt lgkmcnt(12)
    v_mfma_f32_16x16x32_bf16 v[64:67], v[88:91], v[132:135], v[64:67]
    ds_read_b64_tr_b16 v[32:33], v6 offset:18432
    ds_read_b64_tr_b16 v[34:35], v6 offset:21504
    v_mfma_f32_16x16x32_bf16 v[68:71], v[92:95], v[132:135], v[68:71]
    ds_read_b64_tr_b16 v[36:37], v7 offset:18432
    ds_read_b64_tr_b16 v[38:39], v7 offset:21504
    v_mfma_f32_16x16x32_bf16 v[72:75], v[96:99], v[132:135], v[72:75]
    ds_read_b64_tr_b16 v[40:41], v6 offset:18688
    ds_read_b64_tr_b16 v[42:43], v6 offset:21760
    v_mfma_f32_16x16x32_bf16 v[76:79], v[100:103], v[132:135], v[76:79]
    ds_read_b64_tr_b16 v[44:45], v7 offset:18688
    ds_read_b64_tr_b16 v[46:47], v7 offset:21760
    v_mfma_f32_16x16x32_bf16 v[80:83], v[104:107], v[132:135], v[80:83]
    ds_read_b64_tr_b16 v[48:49], v6 offset:18944
    ds_read_b64_tr_b16 v[50:51], v6 offset:22016
    v_mfma_f32_16x16x32_bf16 v[84:87], v[108:111], v[132:135], v[84:87]
    ds_read_b64_tr_b16 v[52:53], v7 offset:18944
    ds_read_b64_tr_b16 v[54:55], v7 offset:22016
    s_barrier
    s_waitcnt lgkmcnt(12)
    v_mfma_f32_16x16x32_bf16 v[64:67], v[112:115], v[136:139], v[64:67]
    ds_read_b64_tr_b16 v[88:89], v12 offset:0
    ds_read_b64_tr_b16 v[90:91], v12 offset:3072
    v_mfma_f32_16x16x32_bf16 v[68:71], v[116:119], v[136:139], v[68:71]
    ds_read_b64_tr_b16 v[92:93], v13 offset:0
    ds_read_b64_tr_b16 v[94:95], v13 offset:3072
    v_mfma_f32_16x16x32_bf16 v[72:75], v[120:123], v[136:139], v[72:75]
    ds_read_b64_tr_b16 v[96:97], v12 offset:256
    ds_read_b64_tr_b16 v[98:99], v12 offset:3328
    v_mfma_f32_16x16x32_bf16 v[76:79], v[124:127], v[136:139], v[76:79]
    ds_read_b64_tr_b16 v[100:101], v13 offset:256
    ds_read_b64_tr_b16 v[102:103], v13 offset:3328
    v_mfma_f32_16x16x32_bf16 v[80:83], v[56:59], v[136:139], v[80:83]
    ds_read_b64_tr_b16 v[104:105], v12 offset:512
    ds_read_b64_tr_b16 v[106:107], v12 offset:3584
    v_mfma_f32_16x16x32_bf16 v[84:87], v[60:63], v[136:139], v[84:87]
    ds_read_b64_tr_b16 v[108:109], v13 offset:512
    ds_read_b64_tr_b16 v[110:111], v13 offset:3584
    s_waitcnt lgkmcnt(12)
    v_mfma_f32_16x16x32_bf16 v[64:67], v[32:35], v[140:143], v[64:67]
    ds_read_b64_tr_b16 v[112:113], v12 offset:6144
    ds_read_b64_tr_b16 v[114:115], v12 offset:9216
    v_mfma_f32_16x16x32_bf16 v[68:71], v[36:39], v[140:143], v[68:71]
    ds_read_b64_tr_b16 v[116:117], v13 offset:6144
    ds_read_b64_tr_b16 v[118:119], v13 offset:9216
    v_mfma_f32_16x16x32_bf16 v[72:75], v[40:43], v[140:143], v[72:75]
    ds_read_b64_tr_b16 v[120:121], v12 offset:6400
    ds_read_b64_tr_b16 v[122:123], v12 offset:9472
    v_mfma_f32_16x16x32_bf16 v[76:79], v[44:47], v[140:143], v[76:79]
    ds_read_b64_tr_b16 v[124:125], v13 offset:6400
    ds_read_b64_tr_b16 v[126:127], v13 offset:9472
    v_mfma_f32_16x16x32_bf16 v[80:83], v[48:51], v[140:143], v[80:83]
    ds_read_b64_tr_b16 v[56:57], v12 offset:6656
    ds_read_b64_tr_b16 v[58:59], v12 offset:9728
    v_mfma_f32_16x16x32_bf16 v[84:87], v[52:55], v[140:143], v[84:87]
    ds_read_b64_tr_b16 v[60:61], v13 offset:6656
    ds_read_b64_tr_b16 v[62:63], v13 offset:9728
    s_waitcnt lgkmcnt(12)
    v_mfma_f32_16x16x32_bf16 v[64:67], v[88:91], v[144:147], v[64:67]
    ds_read_b64_tr_b16 v[32:33], v12 offset:12288
    ds_read_b64_tr_b16 v[34:35], v12 offset:15360
    v_mfma_f32_16x16x32_bf16 v[68:71], v[92:95], v[144:147], v[68:71]
    ds_read_b64_tr_b16 v[36:37], v13 offset:12288
    ds_read_b64_tr_b16 v[38:39], v13 offset:15360
    v_mfma_f32_16x16x32_bf16 v[72:75], v[96:99], v[144:147], v[72:75]
    ds_read_b64_tr_b16 v[40:41], v12 offset:12544
    ds_read_b64_tr_b16 v[42:43], v12 offset:15616
    v_mfma_f32_16x16x32_bf16 v[76:79], v[100:103], v[144:147], v[76:79]
    ds_read_b64_tr_b16 v[44:45], v13 offset:12544
    ds_read_b64_tr_b16 v[46:47], v13 offset:15616
    v_mfma_f32_16x16x32_bf16 v[80:83], v[104:107], v[144:147], v[80:83]
    ds_read_b64_tr_b16 v[48:49], v12 offset:12800
    ds_read_b64_tr_b16 v[50:51], v12 offset:15872
    v_mfma_f32_16x16x32_bf16 v[84:87], v[108:111], v[144:147], v[84:87]
    ds_read_b64_tr_b16 v[52:53], v13 offset:12800
    ds_read_b64_tr_b16 v[54:55], v13 offset:15872
    s_waitcnt lgkmcnt(12)
    v_mfma_f32_16x16x32_bf16 v[64:67], v[112:115], v[148:151], v[64:67]
    ds_read_b64_tr_b16 v[88:89], v12 offset:18432
    ds_read_b64_tr_b16 v[90:91], v12 offset:21504
    v_mfma_f32_16x16x32_bf16 v[68:71], v[116:119], v[148:151], v[68:71]
    ds_read_b64_tr_b16 v[92:93], v13 offset:18432
    ds_read_b64_tr_b16 v[94:95], v13 offset:21504
    v_mfma_f32_16x16x32_bf16 v[72:75], v[120:123], v[148:151], v[72:75]
    ds_read_b64_tr_b16 v[96:97], v12 offset:18688
    ds_read_b64_tr_b16 v[98:99], v12 offset:21760
    v_mfma_f32_16x16x32_bf16 v[76:79], v[124:127], v[148:151], v[76:79]
    ds_read_b64_tr_b16 v[100:101], v13 offset:18688
    ds_read_b64_tr_b16 v[102:103], v13 offset:21760
    v_mfma_f32_16x16x32_bf16 v[80:83], v[56:59], v[148:151], v[80:83]
    ds_read_b64_tr_b16 v[104:105], v12 offset:18944
    ds_read_b64_tr_b16 v[106:107], v12 offset:22016
    v_mfma_f32_16x16x32_bf16 v[84:87], v[60:63], v[148:151], v[84:87]
    ds_read_b64_tr_b16 v[108:109], v13 offset:18944
    ds_read_b64_tr_b16 v[110:111], v13 offset:22016
    s_barrier
    s_waitcnt lgkmcnt(12)
    v_mfma_f32_16x16x32_bf16 v[64:67], v[32:35], v[152:155], v[64:67]
    ds_read_b64_tr_b16 v[112:113], v12 offset:24576
    ds_read_b64_tr_b16 v[114:115], v12 offset:27648
    v_mfma_f32_16x16x32_bf16 v[68:71], v[36:39], v[152:155], v[68:71]
    ds_read_b64_tr_b16 v[116:117], v13 offset:24576
    ds_read_b64_tr_b16 v[118:119], v13 offset:27648
    v_mfma_f32_16x16x32_bf16 v[72:75], v[40:43], v[152:155], v[72:75]
    ds_read_b64_tr_b16 v[120:121], v12 offset:24832
    ds_read_b64_tr_b16 v[122:123], v12 offset:27904
    v_mfma_f32_16x16x32_bf16 v[76:79], v[44:47], v[152:155], v[76:79]
    ds_read_b64_tr_b16 v[124:125], v13 offset:24832
    ds_read_b64_tr_b16 v[126:127], v13 offset:27904
    v_mfma_f32_16x16x32_bf16 v[80:83], v[48:51], v[152:155], v[80:83]
    ds_read_b64_tr_b16 v[56:57], v12 offset:25088
    ds_read_b64_tr_b16 v[58:59], v12 offset:28160
    v_mfma_f32_16x16x32_bf16 v[84:87], v[52:55], v[152:155], v[84:87]
    ds_read_b64_tr_b16 v[60:61], v13 offset:25088
    ds_read_b64_tr_b16 v[62:63], v13 offset:28160
    s_waitcnt lgkmcnt(12)
    v_mfma_f32_16x16x32_bf16 v[64:67], v[88:91], v[156:159], v[64:67]
    ds_read_b64_tr_b16 v[32:33], v12 offset:30720
    ds_read_b64_tr_b16 v[34:35], v12 offset:33792
    v_mfma_f32_16x16x32_bf16 v[68:71], v[92:95], v[156:159], v[68:71]
    ds_read_b64_tr_b16 v[36:37], v13 offset:30720
    ds_read_b64_tr_b16 v[38:39], v13 offset:33792
    v_mfma_f32_16x16x32_bf16 v[72:75], v[96:99], v[156:159], v[72:75]
    ds_read_b64_tr_b16 v[40:41], v12 offset:30976
    ds_read_b64_tr_b16 v[42:43], v12 offset:34048
    v_mfma_f32_16x16x32_bf16 v[76:79], v[100:103], v[156:159], v[76:79]
    ds_read_b64_tr_b16 v[44:45], v13 offset:30976
    ds_read_b64_tr_b16 v[46:47], v13 offset:34048
    v_mfma_f32_16x16x32_bf16 v[80:83], v[104:107], v[156:159], v[80:83]
    ds_read_b64_tr_b16 v[48:49], v12 offset:31232
    ds_read_b64_tr_b16 v[50:51], v12 offset:34304
    v_mfma_f32_16x16x32_bf16 v[84:87], v[108:111], v[156:159], v[84:87]
    ds_read_b64_tr_b16 v[52:53], v13 offset:31232
    ds_read_b64_tr_b16 v[54:55], v13 offset:34304
    s_waitcnt lgkmcnt(12)
    v_mfma_f32_16x16x32_bf16 v[64:67], v[112:115], v[160:163], v[64:67]
    ds_read_b64_tr_b16 v[88:89], v12 offset:36864
    ds_read_b64_tr_b16 v[90:91], v12 offset:39936
    v_mfma_f32_16x16x32_bf16 v[68:71], v[116:119], v[160:163], v[68:71]
    ds_read_b64_tr_b16 v[92:93], v13 offset:36864
    ds_read_b64_tr_b16 v[94:95], v13 offset:39936
    v_mfma_f32_16x16x32_bf16 v[72:75], v[120:123], v[160:163], v[72:75]
    ds_read_b64_tr_b16 v[96:97], v12 offset:37120
    ds_read_b64_tr_b16 v[98:99], v12 offset:40192
    v_mfma_f32_16x16x32_bf16 v[76:79], v[124:127], v[160:163], v[76:79]
    ds_read_b64_tr_b16 v[100:101], v13 offset:37120
    ds_read_b64_tr_b16 v[102:103], v13 offset:40192
    v_mfma_f32_16x16x32_bf16 v[80:83], v[56:59], v[160:163], v[80:83]
    ds_read_b64_tr_b16 v[104:105], v12 offset:37376
    ds_read_b64_tr_b16 v[106:107], v12 offset:40448
    v_mfma_f32_16x16x32_bf16 v[84:87], v[60:63], v[160:163], v[84:87]
    ds_read_b64_tr_b16 v[108:109], v13 offset:37376
    ds_read_b64_tr_b16 v[110:111], v13 offset:40448
    s_waitcnt lgkmcnt(12)
    v_mfma_f32_16x16x32_bf16 v[64:67], v[32:35], v[164:167], v[64:67]
    ds_read_b64_tr_b16 v[112:113], v12 offset:43008
    ds_read_b64_tr_b16 v[114:115], v12 offset:46080
    v_mfma_f32_16x16x32_bf16 v[68:71], v[36:39], v[164:167], v[68:71]
    ds_read_b64_tr_b16 v[116:117], v13 offset:43008
    ds_read_b64_tr_b16 v[118:119], v13 offset:46080
    v_mfma_f32_16x16x32_bf16 v[72:75], v[40:43], v[164:167], v[72:75]
    ds_read_b64_tr_b16 v[120:121], v12 offset:43264
    ds_read_b64_tr_b16 v[122:123], v12 offset:46336
    v_mfma_f32_16x16x32_bf16 v[76:79], v[44:47], v[164:167], v[76:79]
    ds_read_b64_tr_b16 v[124:125], v13 offset:43264
    ds_read_b64_tr_b16 v[126:127], v13 offset:46336
    v_mfma_f32_16x16x32_bf16 v[80:83], v[48:51], v[164:167], v[80:83]
    ds_read_b64_tr_b16 v[56:57], v12 offset:43520
    ds_read_b64_tr_b16 v[58:59], v12 offset:46592
    v_mfma_f32_16x16x32_bf16 v[84:87], v[52:55], v[164:167], v[84:87]
    ds_read_b64_tr_b16 v[60:61], v13 offset:43520
    ds_read_b64_tr_b16 v[62:63], v13 offset:46592
    s_waitcnt lgkmcnt(0)
    s_barrier
    ds_read_b128 v[192:195], v17 offset:0
    ds_read_b128 v[196:199], v17 offset:1024
    ds_read_b128 v[200:203], v17 offset:2048
    ds_read_b128 v[204:207], v17 offset:3072
    ds_read_b128 v[208:211], v17 offset:4096
    ds_read_b128 v[212:215], v17 offset:5120
    v_mfma_f32_16x16x32_bf16 v[64:67], v[88:91], v[168:171], v[64:67]
    ds_read_b64_tr_b16 v[32:33], v14 offset:0
    ds_read_b64_tr_b16 v[34:35], v14 offset:3072
    v_mfma_f32_16x16x32_bf16 v[68:71], v[92:95], v[168:171], v[68:71]
    ds_read_b64_tr_b16 v[36:37], v15 offset:0
    ds_read_b64_tr_b16 v[38:39], v15 offset:3072
    v_mfma_f32_16x16x32_bf16 v[72:75], v[96:99], v[168:171], v[72:75]
    ds_read_b64_tr_b16 v[40:41], v14 offset:256
    ds_read_b64_tr_b16 v[42:43], v14 offset:3328
    v_mfma_f32_16x16x32_bf16 v[76:79], v[100:103], v[168:171], v[76:79]
    ds_read_b64_tr_b16 v[44:45], v15 offset:256
    ds_read_b64_tr_b16 v[46:47], v15 offset:3328
    v_mfma_f32_16x16x32_bf16 v[80:83], v[104:107], v[168:171], v[80:83]
    ds_read_b64_tr_b16 v[48:49], v14 offset:512
    ds_read_b64_tr_b16 v[50:51], v14 offset:3584
    v_mfma_f32_16x16x32_bf16 v[84:87], v[108:111], v[168:171], v[84:87]
    ds_read_b64_tr_b16 v[52:53], v15 offset:512
    ds_read_b64_tr_b16 v[54:55], v15 offset:3584
    v_mfma_f32_16x16x32_bf16 v[64:67], v[112:115], v[172:175], v[64:67]
    ds_read_b64_tr_b16 v[88:89], v14 offset:6144
    ds_read_b64_tr_b16 v[90:91], v14 offset:9216
    v_mfma_f32_16x16x32_bf16 v[68:71], v[116:119], v[172:175], v[68:71]
    ds_read_b64_tr_b16 v[92:93], v15 offset:6144
    ds_read_b64_tr_b16 v[94:95], v15 offset:9216
    v_mfma_f32_16x16x32_bf16 v[72:75], v[120:123], v[172:175], v[72:75]
    ds_read_b64_tr_b16 v[96:97], v14 offset:6400
    ds_read_b64_tr_b16 v[98:99], v14 offset:9472
    v_mfma_f32_16x16x32_bf16 v[76:79], v[124:127], v[172:175], v[76:79]
    ds_read_b64_tr_b16 v[100:101], v15 offset:6400
    ds_read_b64_tr_b16 v[102:103], v15 offset:9472
    v_mfma_f32_16x16x32_bf16 v[80:83], v[56:59], v[172:175], v[80:83]
    ds_read_b64_tr_b16 v[104:105], v14 offset:6656
    ds_read_b64_tr_b16 v[106:107], v14 offset:9728
    v_mfma_f32_16x16x32_bf16 v[84:87], v[60:63], v[172:175], v[84:87]
    ds_read_b64_tr_b16 v[108:109], v15 offset:6656
    ds_read_b64_tr_b16 v[110:111], v15 offset:9728
    s_waitcnt lgkmcnt(12)
    v_mfma_f32_16x16x32_bf16 v[64:67], v[32:35], v[176:179], v[64:67]
    ds_read_b64_tr_b16 v[112:113], v14 offset:12288
    ds_read_b64_tr_b16 v[114:115], v14 offset:15360
    v_mfma_f32_16x16x32_bf16 v[68:71], v[36:39], v[176:179], v[68:71]
    ds_read_b64_tr_b16 v[116:117], v15 offset:12288
    ds_read_b64_tr_b16 v[118:119], v15 offset:15360
    v_mfma_f32_16x16x32_bf16 v[72:75], v[40:43], v[176:179], v[72:75]
    ds_read_b64_tr_b16 v[120:121], v14 offset:12544
    ds_read_b64_tr_b16 v[122:123], v14 offset:15616
    v_mfma_f32_16x16x32_bf16 v[76:79], v[44:47], v[176:179], v[76:79]
    ds_read_b64_tr_b16 v[124:125], v15 offset:12544
    ds_read_b64_tr_b16 v[126:127], v15 offset:15616
    v_mfma_f32_16x16x32_bf16 v[80:83], v[48:51], v[176:179], v[80:83]
    ds_read_b64_tr_b16 v[56:57], v14 offset:12800
    ds_read_b64_tr_b16 v[58:59], v14 offset:15872
    v_mfma_f32_16x16x32_bf16 v[84:87], v[52:55], v[176:179], v[84:87]
    ds_read_b64_tr_b16 v[60:61], v15 offset:12800
    ds_read_b64_tr_b16 v[62:63], v15 offset:15872
    s_waitcnt lgkmcnt(12)
    v_mfma_f32_16x16x32_bf16 v[64:67], v[88:91], v[180:183], v[64:67]
    ds_read_b64_tr_b16 v[32:33], v14 offset:18432
    ds_read_b64_tr_b16 v[34:35], v14 offset:21504
    v_mfma_f32_16x16x32_bf16 v[68:71], v[92:95], v[180:183], v[68:71]
    ds_read_b64_tr_b16 v[36:37], v15 offset:18432
    ds_read_b64_tr_b16 v[38:39], v15 offset:21504
    v_mfma_f32_16x16x32_bf16 v[72:75], v[96:99], v[180:183], v[72:75]
    ds_read_b64_tr_b16 v[40:41], v14 offset:18688
    ds_read_b64_tr_b16 v[42:43], v14 offset:21760
    v_mfma_f32_16x16x32_bf16 v[76:79], v[100:103], v[180:183], v[76:79]
    ds_read_b64_tr_b16 v[44:45], v15 offset:18688
    ds_read_b64_tr_b16 v[46:47], v15 offset:21760
    v_mfma_f32_16x16x32_bf16 v[80:83], v[104:107], v[180:183], v[80:83]
    ds_read_b64_tr_b16 v[48:49], v14 offset:18944
    ds_read_b64_tr_b16 v[50:51], v14 offset:22016
    v_mfma_f32_16x16x32_bf16 v[84:87], v[108:111], v[180:183], v[84:87]
    ds_read_b64_tr_b16 v[52:53], v15 offset:18944
    ds_read_b64_tr_b16 v[54:55], v15 offset:22016
    s_waitcnt lgkmcnt(12)
    v_mfma_f32_16x16x32_bf16 v[64:67], v[112:115], v[184:187], v[64:67]
    v_lshlrev_b32 v216, 16, v20
    v_and_b32 v217, 0xffff0000, v20
    v_mfma_f32_16x16x32_bf16 v[68:71], v[116:119], v[184:187], v[68:71]
    v_lshlrev_b32 v218, 16, v21
    v_and_b32 v219, 0xffff0000, v21
    v_mfma_f32_16x16x32_bf16 v[72:75], v[120:123], v[184:187], v[72:75]
    v_lshlrev_b32 v220, 16, v22
    v_and_b32 v221, 0xffff0000, v22
    v_mfma_f32_16x16x32_bf16 v[76:79], v[124:127], v[184:187], v[76:79]
    v_lshlrev_b32 v222, 16, v23
    v_and_b32 v223, 0xffff0000, v23
    v_mfma_f32_16x16x32_bf16 v[80:83], v[56:59], v[184:187], v[80:83]
    v_lshlrev_b32 v224, 16, v24
    v_and_b32 v225, 0xffff0000, v24
    v_mfma_f32_16x16x32_bf16 v[84:87], v[60:63], v[184:187], v[84:87]
    v_lshlrev_b32 v226, 16, v25
    v_and_b32 v227, 0xffff0000, v25
    s_waitcnt lgkmcnt(0)
    v_mfma_f32_16x16x32_bf16 v[64:67], v[32:35], v[188:191], v[64:67]
    v_lshlrev_b32 v228, 16, v26
    v_and_b32 v229, 0xffff0000, v26
    v_mfma_f32_16x16x32_bf16 v[68:71], v[36:39], v[188:191], v[68:71]
    v_lshlrev_b32 v230, 16, v27
    v_and_b32 v231, 0xffff0000, v27
    v_mfma_f32_16x16x32_bf16 v[72:75], v[40:43], v[188:191], v[72:75]
    v_lshlrev_b32 v232, 16, v28
    v_and_b32 v233, 0xffff0000, v28
    v_mfma_f32_16x16x32_bf16 v[76:79], v[44:47], v[188:191], v[76:79]
    v_lshlrev_b32 v234, 16, v29
    v_and_b32 v235, 0xffff0000, v29
    v_mfma_f32_16x16x32_bf16 v[80:83], v[48:51], v[188:191], v[80:83]
    v_lshlrev_b32 v236, 16, v30
    v_and_b32 v237, 0xffff0000, v30
    v_mfma_f32_16x16x32_bf16 v[84:87], v[52:55], v[188:191], v[84:87]
    v_lshlrev_b32 v238, 16, v31
    v_and_b32 v239, 0xffff0000, v31
    s_setprio 3
    v_pk_add_f32 v[64:65], v[64:65], v[192:193]
    v_pk_add_f32 v[66:67], v[66:67], v[194:195]
    v_pk_add_f32 v[68:69], v[68:69], v[196:197]
    v_pk_add_f32 v[70:71], v[70:71], v[198:199]
    v_pk_mul_f32 v[64:65], v[64:65], v[216:217]
    v_pk_mul_f32 v[66:67], v[66:67], v[218:219]
    v_pk_mul_f32 v[68:69], v[68:69], v[220:221]
    v_pk_mul_f32 v[70:71], v[70:71], v[222:223]
    v_cvt_pk_bf16_f32 v32, v64, v65
    v_cvt_pk_bf16_f32 v33, v66, v67
    v_cvt_pk_bf16_f32 v34, v68, v69
    v_cvt_pk_bf16_f32 v35, v70, v71
    s_cmp_eq_u32 s33, 0
    s_cbranch_scc1 L_ls4
    buffer_store_dwordx4 v[32:35], v16, s[28:31], s3 offen offset:0
L_lb4:
    v_pk_add_f32 v[72:73], v[72:73], v[200:201]
    v_pk_add_f32 v[74:75], v[74:75], v[202:203]
    v_pk_add_f32 v[76:77], v[76:77], v[204:205]
    v_pk_add_f32 v[78:79], v[78:79], v[206:207]
    v_pk_mul_f32 v[72:73], v[72:73], v[224:225]
    v_pk_mul_f32 v[74:75], v[74:75], v[226:227]
    v_pk_mul_f32 v[76:77], v[76:77], v[228:229]
    v_pk_mul_f32 v[78:79], v[78:79], v[230:231]
    v_cvt_pk_bf16_f32 v36, v72, v73
    v_cvt_pk_bf16_f32 v37, v74, v75
    v_cvt_pk_bf16_f32 v38, v76, v77
    v_cvt_pk_bf16_f32 v39, v78, v79
    s_cmp_eq_u32 s33, 0
    s_cbranch_scc1 L_ls5
    buffer_store_dwordx4 v[36:39], v16, s[28:31], s3 offen offset:1024
L_lb5:
    v_pk_add_f32 v[80:81], v[80:81], v[208:209]
    v_pk_add_f32 v[82:83], v[82:83], v[210:211]
    v_pk_add_f32 v[84:85], v[84:85], v[212:213]
    v_pk_add_f32 v[86:87], v[86:87], v[214:215]
    v_pk_mul_f32 v[80:81], v[80:81], v[232:233]
    v_pk_mul_f32 v[82:83], v[82:83], v[234:235]
    v_pk_mul_f32 v[84:85], v[84:85], v[236:237]
    v_pk_mul_f32 v[86:87], v[86:87], v[238:239]
    v_cvt_pk_bf16_f32 v40, v80, v81
    v_cvt_pk_bf16_f32 v41, v82, v83
    v_cvt_pk_bf16_f32 v42, v84, v85
    v_cvt_pk_bf16_f32 v43, v86, v87
    s_cmp_eq_u32 s33, 0
    s_cbranch_scc1 L_ls6
    buffer_store_dwordx4 v[40:43], v16, s[28:31], s3 offen offset:2048
L_lb6:
    s_lshl_b32 s40, s35, 3
    s_add_u32 s40, s40, s36
    s_lshl_b32 s40, s40, 7
    s_lshl_b32 s41, s32, 2
    s_add_u32 s40, s40, s41
    s_add_u32 s40, s40, 8617984
    v_mov_b32 v3, 0
    v_mov_b32 v9, s39
    s_waitcnt vmcnt(0)
    s_mov_b64 exec, 1
    s_cmp_eq_u32 s33, 0
    s_cbranch_scc1 L_ls7
    buffer_store_dword v9, v3, s[28:31], s40 offen
L_lb7:
    s_mov_b64 exec, -1
    s_cmp_lg_u32 s2, 0
    s_cbranch_scc1 L_ne8
    s_mov_b32 s40, 8650752
    v_mov_b32 v3, 0
    v_mov_b32 v9, s39
    s_and_b64 exec, s[60:61], 1
    buffer_store_dword v9, v3, s[28:31], s40 offen sc1
    s_mov_b64 exec, -1
L_ne8:
L_end:
    s_endpgm
L_teamY:
    s_setprio 3
    s_mov_b32 s34, s36
    s_mul_i32 s57, s32, 24576
    s_add_u32 s57, s57, 65536
    s_lshl_b32 s40, s34, 5
    s_lshl_b32 s41, s32, 3
    s_add_u32 s40, s40, s41
    v_lshrrev_b32 v8, 1, v1
    v_add_u32 v8, s40, v8
    v_cmp_eq_u32 vcc, 0, v8
    v_mov_b32 v3, 0x100
    s_nop 0
    v_cndmask_b32 v8, v8, v3, vcc
    v_cvt_f32_u32 v8, v8
    v_mul_f32 v8, 0x3b000000, v8
    v_and_b32 v9, 1, v1
    v_cvt_f32_u32 v9, v9
    v_mul_f32 v9, 0x3e800000, v9
    s_and_b32 s40, s34, 3
    s_lshl_b32 s40, s40, 7
    v_lshl_add_u32 v4, v2, 3, s40
    v_cvt_f32_u32 v4, v4
    v_fmac_f32 v9, v4, v8
    v_fract_f32 v9, v9
    v_mul_f32 v4, 0x42000000, v8
    v_cos_f32 v4, v4
    v_fmamk_f32 v160, v8, 0x00000000, v9
    v_fmamk_f32 v161, v8, 0x3f800000, v9
    v_fmamk_f32 v162, v8, 0x40000000, v9
    v_fmamk_f32 v163, v8, 0x40400000, v9
    v_fmamk_f32 v164, v8, 0x40800000, v9
    v_fmamk_f32 v165, v8, 0x40a00000, v9
    v_fmamk_f32 v166, v8, 0x40c00000, v9
    v_fmamk_f32 v167, v8, 0x40e00000, v9
    v_fmamk_f32 v168, v8, 0x42000000, v9
    v_fmamk_f32 v169, v8, 0x42040000, v9
    v_fmamk_f32 v170, v8, 0x42080000, v9
    v_fmamk_f32 v171, v8, 0x420c0000, v9
    v_fmamk_f32 v172, v8, 0x42100000, v9
    v_fmamk_f32 v173, v8, 0x42140000, v9
    v_fmamk_f32 v174, v8, 0x42180000, v9
    v_fmamk_f32 v175, v8, 0x421c0000, v9
    v_add_f32 v4, v4, v4
    v_cos_f32 v160, v160
    v_cos_f32 v161, v161
    v_cos_f32 v162, v162
    v_cos_f32 v163, v163
    v_cos_f32 v164, v164
    v_cos_f32 v165, v165
    v_cos_f32 v166, v166
    v_cos_f32 v167, v167
    v_cos_f32 v168, v168
    v_cos_f32 v169, v169
    v_cos_f32 v170, v170
    v_cos_f32 v171, v171
    v_cos_f32 v172, v172
    v_cos_f32 v173, v173
    v_cos_f32 v174, v174
    v_cos_f32 v175, v175
    v_lshl_add_u32 v6, v0, 4, s57
    v_cvt_pk_bf16_f32 v64, v160, v161
    v_cvt_pk_bf16_f32 v65, v162, v163
    v_cvt_pk_bf16_f32 v66, v164, v165
    v_cvt_pk_bf16_f32 v67, v166, v167
    ds_write_b128 v6, v[64:67] offset:0
    v_cvt_pk_bf16_f32 v68, v168, v169
    v_cvt_pk_bf16_f32 v69, v170, v171
    v_cvt_pk_bf16_f32 v70, v172, v173
    v_cvt_pk_bf16_f32 v71, v174, v175
    ds_write_b128 v6, v[68:71] offset:1024
    v_pk_fma_f32 v[176:177], v[168:169], v[4:5], v[160:161] op_sel_hi:[1,0,1] neg_lo:[0,0,1] neg_hi:[0,0,1]
    v_pk_fma_f32 v[178:179], v[170:171], v[4:5], v[162:163] op_sel_hi:[1,0,1] neg_lo:[0,0,1] neg_hi:[0,0,1]
    v_pk_fma_f32 v[180:181], v[172:173], v[4:5], v[164:165] op_sel_hi:[1,0,1] neg_lo:[0,0,1] neg_hi:[0,0,1]
    v_pk_fma_f32 v[182:183], v[174:175], v[4:5], v[166:167] op_sel_hi:[1,0,1] neg_lo:[0,0,1] neg_hi:[0,0,1]
    v_cvt_pk_bf16_f32 v72, v176, v177
    v_cvt_pk_bf16_f32 v73, v178, v179
    v_cvt_pk_bf16_f32 v74, v180, v181
    v_cvt_pk_bf16_f32 v75, v182, v183
    ds_write_b128 v6, v[72:75] offset:2048
    v_pk_fma_f32 v[160:161], v[176:177], v[4:5], v[168:169] op_sel_hi:[1,0,1] neg_lo:[0,0,1] neg_hi:[0,0,1]
    v_pk_fma_f32 v[162:163], v[178:179], v[4:5], v[170:171] op_sel_hi:[1,0,1] neg_lo:[0,0,1] neg_hi:[0,0,1]
    v_pk_fma_f32 v[164:165], v[180:181], v[4:5], v[172:173] op_sel_hi:[1,0,1] neg_lo:[0,0,1] neg_hi:[0,0,1]
    v_pk_fma_f32 v[166:167], v[182:183], v[4:5], v[174:175] op_sel_hi:[1,0,1] neg_lo:[0,0,1] neg_hi:[0,0,1]
    v_cvt_pk_bf16_f32 v76, v160, v161
    v_cvt_pk_bf16_f32 v77, v162, v163
    v_cvt_pk_bf16_f32 v78, v164, v165
    v_cvt_pk_bf16_f32 v79, v166, v167
    ds_write_b128 v6, v[76:79] offset:3072
    v_pk_fma_f32 v[168:169], v[160:161], v[4:5], v[176:177] op_sel_hi:[1,0,1] neg_lo:[0,0,1] neg_hi:[0,0,1]
    v_pk_fma_f32 v[170:171], v[162:163], v[4:5], v[178:179] op_sel_hi:[1,0,1] neg_lo:[0,0,1] neg_hi:[0,0,1]
    v_pk_fma_f32 v[172:173], v[164:165], v[4:5], v[180:181] op_sel_hi:[1,0,1] neg_lo:[0,0,1] neg_hi:[0,0,1]
    v_pk_fma_f32 v[174:175], v[166:167], v[4:5], v[182:183] op_sel_hi:[1,0,1] neg_lo:[0,0,1] neg_hi:[0,0,1]
    v_cvt_pk_bf16_f32 v80, v168, v169
    v_cvt_pk_bf16_f32 v81, v170, v171
    v_cvt_pk_bf16_f32 v82, v172, v173
    v_cvt_pk_bf16_f32 v83, v174, v175
    ds_write_b128 v6, v[80:83] offset:4096
    v_pk_fma_f32 v[176:177], v[168:169], v[4:5], v[160:161] op_sel_hi:[1,0,1] neg_lo:[0,0,1] neg_hi:[0,0,1]
    v_pk_fma_f32 v[178:179], v[170:171], v[4:5], v[162:163] op_sel_hi:[1,0,1] neg_lo:[0,0,1] neg_hi:[0,0,1]
    v_pk_fma_f32 v[180:181], v[172:173], v[4:5], v[164:165] op_sel_hi:[1,0,1] neg_lo:[0,0,1] neg_hi:[0,0,1]
    v_pk_fma_f32 v[182:183], v[174:175], v[4:5], v[166:167] op_sel_hi:[1,0,1] neg_lo:[0,0,1] neg_hi:[0,0,1]
    v_cvt_pk_bf16_f32 v84, v176, v177
    v_cvt_pk_bf16_f32 v85, v178, v179
    v_cvt_pk_bf16_f32 v86, v180, v181
    v_cvt_pk_bf16_f32 v87, v182, v183
    ds_write_b128 v6, v[84:87] offset:5120
    v_pk_fma_f32 v[160:161], v[176:177], v[4:5], v[168:169] op_sel_hi:[1,0,1] neg_lo:[0,0,1] neg_hi:[0,0,1]
    v_pk_fma_f32 v[162:163], v[178:179], v[4:5], v[170:171] op_sel_hi:[1,0,1] neg_lo:[0,0,1] neg_hi:[0,0,1]
    v_pk_fma_f32 v[164:165], v[180:181], v[4:5], v[172:173] op_sel_hi:[1,0,1] neg_lo:[0,0,1] neg_hi:[0,0,1]
    v_pk_fma_f32 v[166:167], v[182:183], v[4:5], v[174:175] op_sel_hi:[1,0,1] neg_lo:[0,0,1] neg_hi:[0,0,1]
    v_cvt_pk_bf16_f32 v88, v160, v161
    v_cvt_pk_bf16_f32 v89, v162, v163
    v_cvt_pk_bf16_f32 v90, v164, v165
    v_cvt_pk_bf16_f32 v91, v166, v167
    ds_write_b128 v6, v[88:91] offset:6144
    v_pk_fma_f32 v[168:169], v[160:161], v[4:5], v[176:177] op_sel_hi:[1,0,1] neg_lo:[0,0,1] neg_hi:[0,0,1]
    v_pk_fma_f32 v[170:171], v[162:163], v[4:5], v[178:179] op_sel_hi:[1,0,1] neg_lo:[0,0,1] neg_hi:[0,0,1]
    v_pk_fma_f32 v[172:173], v[164:165], v[4:5], v[180:181] op_sel_hi:[1,0,1] neg_lo:[0,0,1] neg_hi:[0,0,1]
    v_pk_fma_f32 v[174:175], v[166:167], v[4:5], v[182:183] op_sel_hi:[1,0,1] neg_lo:[0,0,1] neg_hi:[0,0,1]
    v_cvt_pk_bf16_f32 v92, v168, v169
    v_cvt_pk_bf16_f32 v93, v170, v171
    v_cvt_pk_bf16_f32 v94, v172, v173
    v_cvt_pk_bf16_f32 v95, v174, v175
    ds_write_b128 v6, v[92:95] offset:7168
    s_load_dwordx2 s[28:29], s[0:1], 96
    s_load_dwordx2 s[12:13], s[0:1], 56
    s_load_dwordx2 s[16:17], s[0:1], 64
    s_load_dwordx2 s[20:21], s[0:1], 72
    s_load_dwordx2 s[24:25], s[0:1], 80
    s_mov_b32 s6, 2097152
    s_mov_b32 s7, 0x20000
    s_mov_b32 s30, 268435456
    s_mov_b32 s31, 0x20000
    s_mov_b32 s10, 1409024
    s_mov_b32 s11, 0x20000
    s_mov_b32 s14, 8388608
    s_mov_b32 s15, 0x20000
    s_mov_b32 s18, 4096
    s_mov_b32 s19, 0x20000
    s_mov_b32 s22, 704512
    s_mov_b32 s23, 0x20000
    s_mov_b32 s26, 2097152
    s_mov_b32 s27, 0x20000
    s_mov_b32 s58, 0
    s_and_b32 s63, s32, 1
    s_mov_b32 s33, s35
    s_mov_b32 s34, s36
    s_waitcnt lgkmcnt(0)
    s_barrier
    s_setprio 0
    s_mov_b32 s37, s35
    s_sub_u32 s38, 64, s35
    s_cmp_eq_u32 s35, 0
    s_cselect_b32 s38, 32, s38
    s_mul_i32 s56, s36, 196608
    s_add_u32 s56, s56, 8912896
    s_cmp_lt_u32 s32, 2
    s_cselect_b32 s62, s37, s38
    s_lshl_b32 s100, s36, 5
    s_add_u32 s100, s100, s35
    s_mul_i32 s40, s36, 393216
    s_add_u32 s98, s40, 2097152
    s_cmp_eq_u32 s32, 0
    s_cselect_b32 s60, 0xffff, 0
    s_mov_b32 s61, 0
    s_lshr_b32 s40, s2, 6
    s_mul_i32 s40, s40, 0
    s_mul_i32 s96, s2, 0
    s_add_u32 s96, s96, s40
    s_lshl_b32 s40, s35, 2
    s_add_u32 s40, s40, s32
    s_lshl_b32 s101, s40, 10
    s_add_u32 s101, s101, 8388608
    s_mul_i32 s53, s40, 24576
    s_add_u32 s53, s53, 5242880
    s_mul_i32 s40, s36, 3072
    s_add_u32 s3, s53, s40
    s_add_u32 s42, s28, 8650752
    s_addc_u32 s43, s29, 0
    s_load_dword s39, s[42:43], 0
    s_lshl_b32 s40, s36, 7
    s_add_u32 s40, s40, s101
    s_add_u32 s42, s28, s40
    s_addc_u32 s43, s29, 0
    s_load_dword s97, s[42:43], 0
    s_load_dword s97, s[42:43], 64
    s_lshl_b32 s40, s35, 3
    s_add_u32 s40, s40, s36
    s_lshl_b32 s40, s40, 7
    s_add_u32 s40, s40, 8617984
    s_add_u32 s42, s28, s40
    s_addc_u32 s43, s29, 0
    s_load_dword s97, s[42:43], 0
    s_load_dword s97, s[42:43], 64
    s_sub_u32 s92, s4, 3072
    s_subb_u32 s93, s5, 0
    s_mov_b32 s94, 2100224
    s_mov_b32 s95, 0x20000
    v_lshrrev_b32 v8, 3, v0
    v_and_b32 v9, 7, v0
    v_xor_b32 v9, v9, v2
    v_lshlrev_b32 v9, 4, v9
    v_lshl_add_u32 v64, v8, 16, v9
    v_xor_b32 v3, 64, v64
    v_add_u32 v65, 523264, v3
    v_add_u32 v66, 1046528, v64
    v_add_u32 v67, 1569792, v3
    s_lshl_b32 s47, s32, 7
    s_lshl_b32 s44, s37, 10
    s_add_u32 s44, s44, s47
    s_lshl_b32 s45, s38, 10
    s_add_u32 s45, s45, s47
    v_sub_u32 v8, 7, v8
    v_lshl_add_u32 v9, v8, 16, v9
    v_xor_b32 v71, 64, v9
    v_add_u32 v68, 1575936, v9
    v_add_u32 v69, 1050624, v71
    v_add_u32 v70, 525312, v9
    s_sub_u32 s40, 63360, s44
    v_add_u32 v72, s40, v68
    v_and_b32 v72, 0x1fffff, v72
    s_sub_u32 s43, 1024, s47
    s_cmp_eq_u32 s32, 0
    s_cselect_b32 s43, 512, s43
    v_lshlrev_b32 v9, 16, v1
    v_mov_b32 v28, 0
    s_sub_u32 s42, 2048, s37
    s_lshl_b32 s42, s42, 10
    v_sub_u32 v76, s42, v9
    v_mov_b32 v29, 0
    s_sub_u32 s42, 1024, s37
    s_lshl_b32 s42, s42, 10
    v_sub_u32 v77, s42, v9
    v_mov_b32 v30, 0
    s_sub_u32 s42, 2048, s38
    s_lshl_b32 s42, s42, 10
    v_sub_u32 v78, s42, v9
    v_mov_b32 v31, 0
    s_sub_u32 s42, 1024, s38
    s_lshl_b32 s42, s42, 10
    v_sub_u32 v79, s42, v9
    v_and_b32 v76, 0x1fffff, v76
    v_and_b32 v3, 1, v1
    v_sub_u32 v3, 0, v3
    v_and_b32 v3, 0x80008000, v3
    v_cvt_f32_u32 v8, v1
    v_mul_f32 v8, 0x3d000000, v8
    v_lshlrev_b32 v9, 2, v2
    v_cvt_f32_u32 v9, v9
    v_mul_f32 v9, v9, v8
    v_fmamk_f32 v160, v8, 0x00000000, v9
    v_fmamk_f32 v161, v8, 0x3f800000, v9
    v_fmamk_f32 v162, v8, 0x40000000, v9
    v_fmamk_f32 v163, v8, 0x40400000, v9
    v_cos_f32 v168, v160
    v_cos_f32 v169, v161
    v_cos_f32 v170, v162
    v_cos_f32 v171, v163
    v_sin_f32 v160, v160
    v_sin_f32 v161, v161
    v_sin_f32 v162, v162
    v_sin_f32 v163, v163
    v_cvt_pk_f16_f32 v32, v168, v160
    v_cvt_pk_f16_f32 v33, v169, v161
    v_cvt_pk_f16_f32 v34, v170, v162
    v_cvt_pk_f16_f32 v35, v171, v163
    v_xor_b32 v36, v3, v32
    v_xor_b32 v37, v3, v33
    v_xor_b32 v38, v3, v34
    v_xor_b32 v39, v3, v35
    v_mov_b32 v40, v32
    v_mov_b32 v44, v36
    v_xor_b32 v41, 0x80008000, v33
    v_xor_b32 v45, 0x80008000, v37
    v_mov_b32 v42, v34
    v_mov_b32 v46, v38
    v_xor_b32 v43, 0x80008000, v35
    v_xor_b32 v47, 0x80008000, v39
    s_waitcnt lgkmcnt(0)
    s_mul_i32 s39, s39, 0x9e3779b1
    s_add_u32 s39, s39, 0x7f4a7c15
    s_and_b32 s88, s39, 0x00030003
    s_lshr_b32 s89, s39, 2
    s_and_b32 s89, s89, 196610
    s_lshr_b32 s90, s39, 4
    s_and_b32 s90, s90, 196610
    s_lshr_b32 s91, s39, 6
    s_and_b32 s91, s91, 196611
    s_and_b32 s40, s39, 1
    s_xor_b32 s40, s40, 1
    s_or_b32 s89, s89, s40
    s_or_b32 s90, s90, s40
    s_barrier
    s_getreg_b32 s40, hwreg(HW_REG_XCC_ID, 0, 4)
    s_add_u32 s40, s40, s39
    v_mov_b32 v9, s40
    v_mov_b32 v3, 0
    s_lshl_b32 s40, s35, 3
    s_add_u32 s40, s40, s36
    s_lshl_b32 s40, s40, 7
    s_add_u32 s40, s40, 8519680
    s_and_b64 exec, s[60:61], 1
    buffer_store_dword v9, v3, s[28:31], s40 offen sc1
    s_mov_b64 exec, -1
    s_add_u32 m0, s57, 8192
    s_nop 0
    buffer_load_dwordx4 v64, s[4:7], s44 offen offset:0 lds
    buffer_load_dwordx4 v65, s[4:7], s44 offen offset:1024 lds
    buffer_load_dwordx4 v66, s[4:7], s44 offen offset:2048 lds
    buffer_load_dwordx4 v67, s[4:7], s44 offen offset:3072 lds
    s_add_u32 m0, s57, 12288
    s_nop 0
    buffer_load_dwordx4 v64, s[4:7], s45 offen offset:0 lds
    buffer_load_dwordx4 v65, s[4:7], s45 offen offset:1024 lds
    buffer_load_dwordx4 v66, s[4:7], s45 offen offset:2048 lds
    buffer_load_dwordx4 v67, s[4:7], s45 offen offset:3072 lds
    s_add_u32 m0, s57, 0
    s_sub_u32 s48, 66432, s44
    buffer_load_dwordx4 v72, s[4:7], 0 offen lds
    buffer_load_dwordx4 v69, s[92:95], s48 offen offset:1024 lds
    buffer_load_dwordx4 v70, s[92:95], s48 offen offset:2048 lds
    buffer_load_dwordx4 v71, s[92:95], s48 offen offset:3072 lds
    s_add_u32 m0, s57, 4096
    s_sub_u32 s48, 66432, s45
    buffer_load_dwordx4 v68, s[92:95], s48 offen offset:0 lds
    buffer_load_dwordx4 v69, s[92:95], s48 offen offset:1024 lds
    buffer_load_dwordx4 v70, s[92:95], s48 offen offset:2048 lds
    buffer_load_dwordx4 v71, s[92:95], s48 offen offset:3072 lds
    s_mov_b64 exec, 0xffff
    buffer_load_short_d16_hi v28, v76, s[4:7], s43 offen
    buffer_load_short_d16_hi v29, v77, s[4:7], s43 offen
    buffer_load_short_d16_hi v30, v78, s[4:7], s43 offen
    buffer_load_short_d16_hi v31, v79, s[4:7], s43 offen
    s_mov_b64 exec, -1
    s_lshr_b32 s40, s2, 3
    s_lshl_b32 s40, s40, 2
    s_add_u32 s40, s40, s32
    s_mul_i32 s40, s40, 11008
    s_add_u32 s40, s40, 1376
    v_min_u32 v3, 11, v1
    v_lshlrev_b32 v3, 7, v3
    v_min_u32 v3, 1372, v3
    v_mul_u32_u24 v7, 2752, v2
    v_add_u32 v3, v3, v7
    buffer_load_dword v18, v3, s[8:11], s40 offen
    v_lshlrev_b32 v3, 7, v1
    v_add_u32 v3, s57, v3
    v_lshrrev_b32 v9, 1, v1
    v_lshlrev_b32 v10, 1, v2
    v_xor_b32 v11, v10, v9
    v_lshl_add_u32 v4, v11, 4, v3
    v_xor_b32 v5, 16, v4
    v_xor_b32 v6, 0x60, v4
    v_xor_b32 v7, 0x70, v4
    v_sub_u32 v11, 8, v10
    v_and_b32 v11, 7, v11
    v_xor_b32 v11, v11, v9
    v_lshl_add_u32 v8, v11, 4, v3
    s_lshl_b32 s40, s32, 3
    v_add_u32 v10, s40, v10
    v_xor_b32 v11, v10, v1
    v_lshlrev_b32 v3, 10, v1
    v_lshl_add_u32 v20, v11, 4, v3
    v_xor_b32 v21, 16, v20
    v_add_u32 v10, 32, v10
    s_cmp_eq_u32 s35, 0
    s_cselect_b32 s40, 16, 47
    s_cselect_b32 s41, 0x7fff, -1
    s_cselect_b32 s42, 47, 15
    v_sub_u32 v9, s40, v1
    v_and_b32 v11, 15, v9
    v_xor_b32 v11, v11, v10
    v_lshlrev_b32 v9, 10, v9
    v_lshl_add_u32 v23, v11, 4, v9
    v_add_u32 v22, 16384, v23
    v_sub_u32 v9, s42, v1
    v_and_b32 v11, 15, v9
    v_xor_b32 v11, v11, v10
    v_lshlrev_b32 v9, 10, v9
    v_lshl_add_u32 v25, v11, 4, v9
    v_add_u32 v24, 16384, v25
    v_and_b32 v22, s41, v22
    s_lshl_b32 s40, s32, 8
    v_lshl_add_u32 v26, v1, 4, s40
    v_lshl_add_u32 v26, v2, 12, v26
    v_lshlrev_b32 v17, 4, v0
    s_lshl_b32 s41, s36, 7
    s_sub_u32 s40, 1528, s41
    s_cmp_lt_u32 s36, 4
    s_cselect_b32 s41, s41, s40
    s_cselect_b32 s40, 8, -8
    v_mul_i32_i24 v48, s40, v2
    v_add_u32 v48, s41, v48
    s_lshl_b32 s40, s40, 2
    v_lshlrev_b32 v49, 4, v1
    v_lshlrev_b32 v50, 10, v1
    v_add_u32 v50, s59, v50
    v_xad_u32 v56, v48, v49, v50
    v_add_u32 v51, 8, v48
    v_lshrrev_b32 v3, 1, v51
    v_and_b32 v3, 0x200, v3
    v_sub_u32 v51, v51, v3
    v_xad_u32 v60, v51, v49, v50
    v_add_u32 v48, s40, v48
    v_xad_u32 v57, v48, v49, v50
    v_add_u32 v51, 8, v48
    v_xad_u32 v61, v51, v49, v50
    v_add_u32 v48, s40, v48
    v_xad_u32 v58, v48, v49, v50
    v_add_u32 v51, 8, v48
    v_xad_u32 v62, v51, v49, v50
    v_add_u32 v48, s40, v48
    v_xad_u32 v59, v48, v49, v50
    v_add_u32 v51, 8, v48
    v_xad_u32 v63, v51, v49, v50
    v_add_u32 v48, s40, v48
    s_waitcnt vmcnt(1)
    s_barrier
    ds_read_b128 v[192:195], v4 offset:8192
    ds_read_b128 v[196:199], v5 offset:8192
    ds_read_b128 v[208:211], v4 offset:10240
    ds_read_b128 v[212:215], v5 offset:10240
    ds_read_b128 v[224:227], v4 offset:12288
    ds_read_b128 v[228:231], v5 offset:12288
    ds_read_b128 v[240:243], v4 offset:14336
    ds_read_b128 v[244:247], v5 offset:14336
    ds_read_b128 v[200:203], v6 offset:0
    ds_read_b128 v[204:207], v7 offset:0
    ds_read_b128 v[216:219], v6 offset:2048
    ds_read_b128 v[220:223], v7 offset:2048
    ds_read_b128 v[232:235], v6 offset:4096
    ds_read_b128 v[236:239], v7 offset:4096
    ds_read_b128 v[248:251], v6 offset:6144
    ds_read_b128 v[252:255], v7 offset:6144
    s_mov_b32 exec_lo, 0xffff0000
    ds_read_u16_d16_hi v28, v8 offset:0
    ds_read_u16_d16_hi v29, v8 offset:2048
    ds_read_u16_d16_hi v30, v8 offset:4096
    ds_read_u16_d16_hi v31, v8 offset:6144
    s_mov_b64 exec, -1
    s_waitcnt lgkmcnt(15)
    v_lshlrev_b32 v64, 16, v192
    v_and_b32 v68, 0xffff0000, v192
    v_lshlrev_b32 v72, 16, v193
    v_and_b32 v76, 0xffff0000, v193
    v_lshlrev_b32 v65, 16, v194
    v_and_b32 v69, 0xffff0000, v194
    v_lshlrev_b32 v73, 16, v195
    v_and_b32 v77, 0xffff0000, v195
    v_lshlrev_b32 v66, 16, v196
    v_and_b32 v70, 0xffff0000, v196
    v_lshlrev_b32 v74, 16, v197
    v_and_b32 v78, 0xffff0000, v197
    v_lshlrev_b32 v67, 16, v198
    v_and_b32 v71, 0xffff0000, v198
    v_lshlrev_b32 v75, 16, v199
    v_and_b32 v79, 0xffff0000, v199
    s_waitcnt lgkmcnt(10)
    v_and_b32 v132, 0xffff0000, v207
    v_lshlrev_b32 v136, 16, v207
    v_and_b32 v140, 0xffff0000, v206
    v_lshlrev_b32 v129, 16, v206
    v_and_b32 v133, 0xffff0000, v205
    v_lshlrev_b32 v137, 16, v205
    v_and_b32 v141, 0xffff0000, v204
    v_lshlrev_b32 v130, 16, v204
    v_and_b32 v134, 0xffff0000, v203
    v_lshlrev_b32 v138, 16, v203
    v_and_b32 v142, 0xffff0000, v202
    v_lshlrev_b32 v131, 16, v202
    v_and_b32 v135, 0xffff0000, v201
    v_lshlrev_b32 v139, 16, v201
    v_and_b32 v143, 0xffff0000, v200
    v_sub_f32 v132, v132, v68
    v_sub_f32 v136, v136, v72
    v_sub_f32 v140, v140, v76
    v_sub_f32 v129, v129, v65
    v_sub_f32 v133, v133, v69
    v_sub_f32 v137, v137, v73
    v_sub_f32 v141, v141, v77
    v_sub_f32 v130, v130, v66
    v_sub_f32 v134, v134, v70
    v_sub_f32 v138, v138, v74
    v_sub_f32 v142, v142, v78
    v_sub_f32 v131, v131, v67
    v_sub_f32 v135, v135, v71
    v_sub_f32 v139, v139, v75
    v_sub_f32 v143, v143, v79
    s_waitcnt lgkmcnt(3)
    v_sub_f32 v128, v28, v64
    v_mov_b32 v28, v64
    s_waitcnt lgkmcnt(0)
    s_barrier
    v_lshlrev_b32 v80, 16, v208
    v_and_b32 v84, 0xffff0000, v208
    v_lshlrev_b32 v88, 16, v209
    v_and_b32 v92, 0xffff0000, v209
    v_lshlrev_b32 v81, 16, v210
    v_and_b32 v85, 0xffff0000, v210
    v_lshlrev_b32 v89, 16, v211
    v_and_b32 v93, 0xffff0000, v211
    v_lshlrev_b32 v82, 16, v212
    v_and_b32 v86, 0xffff0000, v212
    v_lshlrev_b32 v90, 16, v213
    v_and_b32 v94, 0xffff0000, v213
    v_lshlrev_b32 v83, 16, v214
    v_and_b32 v87, 0xffff0000, v214
    v_lshlrev_b32 v91, 16, v215
    v_and_b32 v95, 0xffff0000, v215
    v_and_b32 v148, 0xffff0000, v223
    v_lshlrev_b32 v152, 16, v223
    v_and_b32 v156, 0xffff0000, v222
    v_lshlrev_b32 v145, 16, v222
    v_and_b32 v149, 0xffff0000, v221
    v_lshlrev_b32 v153, 16, v221
    v_and_b32 v157, 0xffff0000, v220
    v_lshlrev_b32 v146, 16, v220
    v_and_b32 v150, 0xffff0000, v219
    v_lshlrev_b32 v154, 16, v219
    v_and_b32 v158, 0xffff0000, v218
    v_lshlrev_b32 v147, 16, v218
    v_and_b32 v151, 0xffff0000, v217
    v_lshlrev_b32 v155, 16, v217
    v_and_b32 v159, 0xffff0000, v216
    v_sub_f32 v148, v148, v84
    v_sub_f32 v152, v152, v88
    v_sub_f32 v156, v156, v92
    v_sub_f32 v145, v145, v81
    v_sub_f32 v149, v149, v85
    v_sub_f32 v153, v153, v89
    v_sub_f32 v157, v157, v93
    v_sub_f32 v146, v146, v82
    v_sub_f32 v150, v150, v86
    v_sub_f32 v154, v154, v90
    v_sub_f32 v158, v158, v94
    v_sub_f32 v147, v147, v83
    v_sub_f32 v151, v151, v87
    v_sub_f32 v155, v155, v91
    v_sub_f32 v159, v159, v95
    v_sub_f32 v144, v29, v80
    v_mov_b32 v29, v80
    v_lshlrev_b32 v96, 16, v224
    v_and_b32 v100, 0xffff0000, v224
    v_lshlrev_b32 v104, 16, v225
    v_and_b32 v108, 0xffff0000, v225
    v_lshlrev_b32 v97, 16, v226
    v_and_b32 v101, 0xffff0000, v226
    v_lshlrev_b32 v105, 16, v227
    v_and_b32 v109, 0xffff0000, v227
    v_lshlrev_b32 v98, 16, v228
    v_and_b32 v102, 0xffff0000, v228
    v_lshlrev_b32 v106, 16, v229
    v_and_b32 v110, 0xffff0000, v229
    v_lshlrev_b32 v99, 16, v230
    v_and_b32 v103, 0xffff0000, v230
    v_lshlrev_b32 v107, 16, v231
    v_and_b32 v111, 0xffff0000, v231
    v_and_b32 v164, 0xffff0000, v239
    v_lshlrev_b32 v168, 16, v239
    v_and_b32 v172, 0xffff0000, v238
    v_lshlrev_b32 v161, 16, v238
    v_and_b32 v165, 0xffff0000, v237
    v_lshlrev_b32 v169, 16, v237
    v_and_b32 v173, 0xffff0000, v236
    v_lshlrev_b32 v162, 16, v236
    v_and_b32 v166, 0xffff0000, v235
    v_lshlrev_b32 v170, 16, v235
    v_and_b32 v174, 0xffff0000, v234
    v_lshlrev_b32 v163, 16, v234
    v_and_b32 v167, 0xffff0000, v233
    v_lshlrev_b32 v171, 16, v233
    v_and_b32 v175, 0xffff0000, v232
    v_sub_f32 v164, v164, v100
    v_sub_f32 v168, v168, v104
    v_sub_f32 v172, v172, v108
    v_sub_f32 v161, v161, v97
    v_sub_f32 v165, v165, v101
    v_sub_f32 v169, v169, v105
    v_sub_f32 v173, v173, v109
    v_sub_f32 v162, v162, v98
    v_sub_f32 v166, v166, v102
    v_sub_f32 v170, v170, v106
    v_sub_f32 v174, v174, v110
    v_sub_f32 v163, v163, v99
    v_sub_f32 v167, v167, v103
    v_sub_f32 v171, v171, v107
    v_sub_f32 v175, v175, v111
    v_sub_f32 v160, v30, v96
    v_mov_b32 v30, v96
    v_lshlrev_b32 v112, 16, v240
    v_and_b32 v116, 0xffff0000, v240
    v_lshlrev_b32 v120, 16, v241
    v_and_b32 v124, 0xffff0000, v241
    v_lshlrev_b32 v113, 16, v242
    v_and_b32 v117, 0xffff0000, v242
    v_lshlrev_b32 v121, 16, v243
    v_and_b32 v125, 0xffff0000, v243
    v_lshlrev_b32 v114, 16, v244
    v_and_b32 v118, 0xffff0000, v244
    v_lshlrev_b32 v122, 16, v245
    v_and_b32 v126, 0xffff0000, v245
    v_lshlrev_b32 v115, 16, v246
    v_and_b32 v119, 0xffff0000, v246
    v_lshlrev_b32 v123, 16, v247
    v_and_b32 v127, 0xffff0000, v247
    v_and_b32 v180, 0xffff0000, v255
    v_lshlrev_b32 v184, 16, v255
    v_and_b32 v188, 0xffff0000, v254
    v_lshlrev_b32 v177, 16, v254
    v_and_b32 v181, 0xffff0000, v253
    v_lshlrev_b32 v185, 16, v253
    v_and_b32 v189, 0xffff0000, v252
    v_lshlrev_b32 v178, 16, v252
    v_and_b32 v182, 0xffff0000, v251
    v_lshlrev_b32 v186, 16, v251
    v_and_b32 v190, 0xffff0000, v250
    v_lshlrev_b32 v179, 16, v250
    v_and_b32 v183, 0xffff0000, v249
    v_lshlrev_b32 v187, 16, v249
    v_and_b32 v191, 0xffff0000, v248
    v_sub_f32 v180, v180, v116
    v_sub_f32 v184, v184, v120
    v_sub_f32 v188, v188, v124
    v_sub_f32 v177, v177, v113
    v_sub_f32 v181, v181, v117
    v_sub_f32 v185, v185, v121
    v_sub_f32 v189, v189, v125
    v_sub_f32 v178, v178, v114
    v_sub_f32 v182, v182, v118
    v_sub_f32 v186, v186, v122
    v_sub_f32 v190, v190, v126
    v_sub_f32 v179, v179, v115
    v_sub_f32 v183, v183, v119
    v_sub_f32 v187, v187, v123
    v_sub_f32 v191, v191, v127
    v_sub_f32 v176, v31, v112
    v_mov_b32 v31, v112
    v_lshrrev_b32 v48, 5, v0
    v_and_b32 v49, 31, v0
    v_lshlrev_b32 v50, 3, v48
    v_xor_b32 v49, v49, v50
    v_lshlrev_b32 v49, 4, v49
    v_lshl_add_u32 v49, v48, 18, v49
    v_xor_b32 v50, 0, v49
    v_add_u32 v4, 0, v50
    v_xor_b32 v50, 32, v49
    v_add_u32 v5, 523264, v50
    v_xor_b32 v50, 64, v49
    v_add_u32 v6, 1046528, v50
    v_xor_b32 v50, 96, v49
    v_add_u32 v7, 1569792, v50
    v_xor_b32 v50, 16, v49
    v_add_u32 v16, 2097152, v50
    v_xor_b32 v50, 48, v49
    v_add_u32 v19, 2620416, v50
    v_xor_b32 v50, 80, v49
    v_add_u32 v27, 3143680, v50
    v_xor_b32 v50, 112, v49
    s_waitcnt vmcnt(0)
    v_add_u32 v18, 3666944, v50
    s_lshl_b32 s49, s62, 12
    s_lshl_b32 s40, s63, 22
    s_add_u32 s49, s49, s40
    s_mul_i32 s40, s32, 3072
    s_add_u32 s50, s56, s40
    s_mov_b32 s57, s40
    v_mov_b32 v8, v56
    v_mov_b32 v9, v57
    v_mov_b32 v10, v58
    v_mov_b32 v11, v59
    v_mov_b32 v12, v60
    v_mov_b32 v13, v61
    v_mov_b32 v14, v62
    v_mov_b32 v15, v63
    s_barrier
    s_setprio 2
    s_lshl_b32 s40, s37, 15
    s_add_u32 s40, s40, 0
    s_lshl_b32 s41, s37, 15
    s_add_u32 s41, s41, 16384
    s_lshl_b32 s42, s38, 15
    s_add_u32 s42, s42, 0
    s_lshl_b32 s43, s38, 15
    s_add_u32 s43, s43, 16384
    buffer_load_dwordx4 v[192:195], v26, s[28:31], s40 offen offset:0 sc1
    buffer_load_dwordx4 v[196:199], v26, s[28:31], s40 offen offset:1024 sc1
    buffer_load_dwordx4 v[200:203], v26, s[28:31], s40 offen offset:2048 sc1
    buffer_load_dwordx4 v[204:207], v26, s[28:31], s40 offen offset:3072 sc1
    buffer_load_dwordx4 v[208:211], v26, s[28:31], s41 offen offset:0 sc1
    buffer_load_dwordx4 v[212:215], v26, s[28:31], s41 offen offset:1024 sc1
    buffer_load_dwordx4 v[216:219], v26, s[28:31], s41 offen offset:2048 sc1
    buffer_load_dwordx4 v[220:223], v26, s[28:31], s41 offen offset:3072 sc1
    buffer_load_dwordx4 v[224:227], v26, s[28:31], s42 offen offset:0 sc1
    buffer_load_dwordx4 v[228:231], v26, s[28:31], s42 offen offset:1024 sc1
    buffer_load_dwordx4 v[232:235], v26, s[28:31], s42 offen offset:2048 sc1
    buffer_load_dwordx4 v[236:239], v26, s[28:31], s42 offen offset:3072 sc1
    buffer_load_dwordx4 v[240:243], v26, s[28:31], s43 offen offset:0 sc1
    buffer_load_dwordx4 v[244:247], v26, s[28:31], s43 offen offset:1024 sc1
    buffer_load_dwordx4 v[248:251], v26, s[28:31], s43 offen offset:2048 sc1
    buffer_load_dwordx4 v[252:255], v26, s[28:31], s43 offen offset:3072 sc1
    s_waitcnt vmcnt(15)
    v_xor_b32 v48, s88, v192
    v_xor_b32 v52, s89, v193
    v_xor_b32 v56, s90, v194
    v_xor_b32 v60, s91, v195
    s_waitcnt vmcnt(14)
    v_xor_b32 v49, s88, v196
    v_xor_b32 v53, s89, v197
    v_xor_b32 v57, s90, v198
    v_xor_b32 v61, s91, v199
    s_waitcnt vmcnt(13)
    v_xor_b32 v50, s88, v200
    v_xor_b32 v54, s89, v201
    v_xor_b32 v58, s90, v202
    v_xor_b32 v62, s91, v203
    s_waitcnt vmcnt(12)
    v_xor_b32 v51, s88, v204
    v_xor_b32 v55, s89, v205
    v_xor_b32 v59, s90, v206
    v_xor_b32 v63, s91, v207
    v_or3_b32 v3, v48, v49, v50
    v_or3_b32 v3, v3, v51, v52
    v_or3_b32 v3, v3, v53, v54
    v_or3_b32 v3, v3, v55, v56
    v_or3_b32 v3, v3, v57, v58
    v_or3_b32 v3, v3, v59, v60
    v_or3_b32 v3, v3, v61, v62
    v_or_b32 v3, v3, v63
    v_and_b32 v3, 0x30003, v3
    v_cmp_ne_u32 vcc, 0, v3
    s_cbranch_vccnz L_rt9
L_ok9:
    v_mfma_f32_16x16x32_f16 v[64:67], v[48:51], v[32:35], v[64:67]
    s_waitcnt vmcnt(11)
    v_xor_b32 v192, s88, v208
    v_xor_b32 v196, s89, v209
    v_mfma_f32_16x16x32_f16 v[68:71], v[52:55], v[32:35], v[68:71]
    v_xor_b32 v200, s90, v210
    v_xor_b32 v204, s91, v211
    v_mfma_f32_16x16x32_f16 v[72:75], v[56:59], v[32:35], v[72:75]
    s_waitcnt vmcnt(10)
    v_xor_b32 v193, s88, v212
    v_xor_b32 v197, s89, v213
    v_mfma_f32_16x16x32_f16 v[76:79], v[60:63], v[32:35], v[76:79]
    v_xor_b32 v201, s90, v214
    v_xor_b32 v205, s91, v215
    v_mfma_f32_16x16x32_f16 v[80:83], v[48:51], v[40:43], v[80:83]
    s_waitcnt vmcnt(9)
    v_xor_b32 v194, s88, v216
    v_xor_b32 v198, s89, v217
    v_mfma_f32_16x16x32_f16 v[84:87], v[52:55], v[40:43], v[84:87]
    v_xor_b32 v202, s90, v218
    v_xor_b32 v206, s91, v219
    v_mfma_f32_16x16x32_f16 v[88:91], v[56:59], v[40:43], v[88:91]
    s_waitcnt vmcnt(8)
    v_xor_b32 v195, s88, v220
    v_xor_b32 v199, s89, v221
    v_mfma_f32_16x16x32_f16 v[92:95], v[60:63], v[40:43], v[92:95]
    v_xor_b32 v203, s90, v222
    v_xor_b32 v207, s91, v223
    v_or3_b32 v3, v192, v193, v194
    v_or3_b32 v3, v3, v195, v196
    v_or3_b32 v3, v3, v197, v198
    v_or3_b32 v3, v3, v199, v200
    v_or3_b32 v3, v3, v201, v202
    v_or3_b32 v3, v3, v203, v204
    v_or3_b32 v3, v3, v205, v206
    v_or_b32 v3, v3, v207
    v_and_b32 v3, 0x30003, v3
    v_cmp_ne_u32 vcc, 0, v3
    s_cbranch_vccnz L_rt10
L_ok10:
    s_barrier
    v_mfma_f32_16x16x32_f16 v[64:67], v[192:195], v[36:39], v[64:67]
    s_waitcnt vmcnt(7)
    v_xor_b32 v208, s88, v224
    v_xor_b32 v212, s89, v225
    v_mfma_f32_16x16x32_f16 v[68:71], v[196:199], v[36:39], v[68:71]
    v_xor_b32 v216, s90, v226
    v_xor_b32 v220, s91, v227
    v_mfma_f32_16x16x32_f16 v[72:75], v[200:203], v[36:39], v[72:75]
    s_waitcnt vmcnt(6)
    v_xor_b32 v209, s88, v228
    v_xor_b32 v213, s89, v229
    v_mfma_f32_16x16x32_f16 v[76:79], v[204:207], v[36:39], v[76:79]
    v_xor_b32 v217, s90, v230
    v_xor_b32 v221, s91, v231
    v_mfma_f32_16x16x32_f16 v[80:83], v[192:195], v[44:47], v[80:83]
    s_waitcnt vmcnt(5)
    v_xor_b32 v210, s88, v232
    v_xor_b32 v214, s89, v233
    v_mfma_f32_16x16x32_f16 v[84:87], v[196:199], v[44:47], v[84:87]
    v_xor_b32 v218, s90, v234
    v_xor_b32 v222, s91, v235
    v_mfma_f32_16x16x32_f16 v[88:91], v[200:203], v[44:47], v[88:91]
    s_waitcnt vmcnt(4)
    v_xor_b32 v211, s88, v236
    v_xor_b32 v215, s89, v237
    v_mfma_f32_16x16x32_f16 v[92:95], v[204:207], v[44:47], v[92:95]
    v_xor_b32 v219, s90, v238
    v_xor_b32 v223, s91, v239
    v_or3_b32 v3, v208, v209, v210
    v_or3_b32 v3, v3, v211, v212
    v_or3_b32 v3, v3, v213, v214
    v_or3_b32 v3, v3, v215, v216
    v_or3_b32 v3, v3, v217, v218
    v_or3_b32 v3, v3, v219, v220
    v_or3_b32 v3, v3, v221, v222
    v_or_b32 v3, v3, v223
    v_and_b32 v3, 0x30003, v3
    v_cmp_ne_u32 vcc, 0, v3
    s_cbranch_vccnz L_rt11
L_ok11:
    v_add_f32 v128, v128, v64
    v_cndmask_b32 v64, v64, v28, s[60:61]
    v_cvt_pk_bf16_f32 v48, v64, v68
    v_cvt_pk_bf16_f32 v49, v72, v76
    v_cvt_pk_bf16_f32 v50, v65, v69
    v_cvt_pk_bf16_f32 v51, v73, v77
    ds_write_b128 v20, v[48:51] offset:0
    v_mfma_f32_16x16x32_f16 v[96:99], v[208:211], v[32:35], v[96:99]
    s_waitcnt vmcnt(3)
    v_xor_b32 v224, s88, v240
    v_xor_b32 v228, s89, v241
    v_mfma_f32_16x16x32_f16 v[100:103], v[212:215], v[32:35], v[100:103]
    v_xor_b32 v232, s90, v242
    v_xor_b32 v236, s91, v243
    v_mfma_f32_16x16x32_f16 v[104:107], v[216:219], v[32:35], v[104:107]
    s_waitcnt vmcnt(2)
    v_xor_b32 v225, s88, v244
    v_xor_b32 v229, s89, v245
    v_mfma_f32_16x16x32_f16 v[108:111], v[220:223], v[32:35], v[108:111]
    v_xor_b32 v233, s90, v246
    v_xor_b32 v237, s91, v247
    v_mfma_f32_16x16x32_f16 v[112:115], v[208:211], v[40:43], v[112:115]
    s_waitcnt vmcnt(1)
    v_xor_b32 v226, s88, v248
    v_xor_b32 v230, s89, v249
    v_mfma_f32_16x16x32_f16 v[116:119], v[212:215], v[40:43], v[116:119]
    v_xor_b32 v234, s90, v250
    v_xor_b32 v238, s91, v251
    v_mfma_f32_16x16x32_f16 v[120:123], v[216:219], v[40:43], v[120:123]
    s_waitcnt vmcnt(0)
    v_xor_b32 v227, s88, v252
    v_xor_b32 v231, s89, v253
    v_mfma_f32_16x16x32_f16 v[124:127], v[220:223], v[40:43], v[124:127]
    v_xor_b32 v235, s90, v254
    v_xor_b32 v239, s91, v255
    v_or3_b32 v3, v224, v225, v226
    v_or3_b32 v3, v3, v227, v228
    v_or3_b32 v3, v3, v229, v230
    v_or3_b32 v3, v3, v231, v232
    v_or3_b32 v3, v3, v233, v234
    v_or3_b32 v3, v3, v235, v236
    v_or3_b32 v3, v3, v237, v238
    v_or_b32 v3, v3, v239
    v_and_b32 v3, 0x30003, v3
    v_cmp_ne_u32 vcc, 0, v3
    s_cbranch_vccnz L_rt12
L_ok12:
    v_mfma_f32_16x16x32_f16 v[96:99], v[224:227], v[36:39], v[96:99]
    v_cvt_pk_bf16_f32 v52, v66, v70
    v_cvt_pk_bf16_f32 v53, v74, v78
    v_mfma_f32_16x16x32_f16 v[100:103], v[228:231], v[36:39], v[100:103]
    v_cvt_pk_bf16_f32 v54, v67, v71
    v_cvt_pk_bf16_f32 v55, v75, v79
    v_mfma_f32_16x16x32_f16 v[104:107], v[232:235], v[36:39], v[104:107]
    v_add_f32 v129, v129, v65
    v_add_f32 v130, v130, v66
    v_mfma_f32_16x16x32_f16 v[108:111], v[236:239], v[36:39], v[108:111]
    v_add_f32 v131, v131, v67
    v_add_f32 v132, v132, v68
    v_mfma_f32_16x16x32_f16 v[112:115], v[224:227], v[44:47], v[112:115]
    v_add_f32 v133, v133, v69
    v_add_f32 v134, v134, v70
    v_mfma_f32_16x16x32_f16 v[116:119], v[228:231], v[44:47], v[116:119]
    v_add_f32 v135, v135, v71
    v_add_f32 v136, v136, v72
    v_mfma_f32_16x16x32_f16 v[120:123], v[232:235], v[44:47], v[120:123]
    v_add_f32 v137, v137, v73
    v_add_f32 v138, v138, v74
    v_mfma_f32_16x16x32_f16 v[124:127], v[236:239], v[44:47], v[124:127]
    v_add_f32 v139, v139, v75
    v_add_f32 v140, v140, v76
    v_add_f32 v141, v141, v77
    v_add_f32 v142, v142, v78
    v_add_f32 v143, v143, v79
    ds_write_b128 v21, v[52:55] offset:0
    v_cvt_pk_bf16_f32 v56, v128, v132
    v_cvt_pk_bf16_f32 v57, v136, v140
    v_cvt_pk_bf16_f32 v58, v129, v133
    v_cvt_pk_bf16_f32 v59, v137, v141
    ds_write_b128 v22, v[56:59] offset:0
    v_cvt_pk_bf16_f32 v60, v130, v134
    v_cvt_pk_bf16_f32 v61, v138, v142
    v_cvt_pk_bf16_f32 v62, v131, v135
    v_cvt_pk_bf16_f32 v63, v139, v143
    v_xor_b32 v22, 16, v22
    ds_write_b128 v22, v[60:63] offset:0
    v_add_f32 v144, v144, v80
    v_cndmask_b32 v80, v80, v29, s[60:61]
    v_cvt_pk_bf16_f32 v192, v80, v84
    v_cvt_pk_bf16_f32 v193, v88, v92
    v_cvt_pk_bf16_f32 v194, v81, v85
    v_cvt_pk_bf16_f32 v195, v89, v93
    ds_write_b128 v20, v[192:195] offset:16384
    v_cvt_pk_bf16_f32 v196, v82, v86
    v_cvt_pk_bf16_f32 v197, v90, v94
    v_cvt_pk_bf16_f32 v198, v83, v87
    v_cvt_pk_bf16_f32 v199, v91, v95
    v_add_f32 v145, v145, v81
    v_pk_add_f32 v[146:147], v[146:147], v[82:83]
    v_pk_add_f32 v[148:149], v[148:149], v[84:85]
    v_pk_add_f32 v[150:151], v[150:151], v[86:87]
    v_pk_add_f32 v[152:153], v[152:153], v[88:89]
    v_pk_add_f32 v[154:155], v[154:155], v[90:91]
    v_pk_add_f32 v[156:157], v[156:157], v[92:93]
    v_pk_add_f32 v[158:159], v[158:159], v[94:95]
    ds_write_b128 v21, v[196:199] offset:16384
    v_cvt_pk_bf16_f32 v200, v144, v148
    v_cvt_pk_bf16_f32 v201, v152, v156
    v_cvt_pk_bf16_f32 v202, v145, v149
    v_cvt_pk_bf16_f32 v203, v153, v157
    ds_write_b128 v23, v[200:203] offset:0
    v_cvt_pk_bf16_f32 v204, v146, v150
    v_cvt_pk_bf16_f32 v205, v154, v158
    v_cvt_pk_bf16_f32 v206, v147, v151
    v_cvt_pk_bf16_f32 v207, v155, v159
    v_xor_b32 v23, 16, v23
    ds_write_b128 v23, v[204:207] offset:0
    v_add_f32 v160, v160, v96
    v_cndmask_b32 v96, v96, v30, s[60:61]
    v_cvt_pk_bf16_f32 v240, v96, v100
    v_cvt_pk_bf16_f32 v241, v104, v108
    v_cvt_pk_bf16_f32 v242, v97, v101
    v_cvt_pk_bf16_f32 v243, v105, v109
    ds_write_b128 v20, v[240:243] offset:32768
    v_cvt_pk_bf16_f32 v244, v98, v102
    v_cvt_pk_bf16_f32 v245, v106, v110
    v_cvt_pk_bf16_f32 v246, v99, v103
    v_cvt_pk_bf16_f32 v247, v107, v111
    v_add_f32 v161, v161, v97
    v_pk_add_f32 v[162:163], v[162:163], v[98:99]
    v_pk_add_f32 v[164:165], v[164:165], v[100:101]
    v_pk_add_f32 v[166:167], v[166:167], v[102:103]
    v_pk_add_f32 v[168:169], v[168:169], v[104:105]
    v_pk_add_f32 v[170:171], v[170:171], v[106:107]
    v_pk_add_f32 v[172:173], v[172:173], v[108:109]
    v_pk_add_f32 v[174:175], v[174:175], v[110:111]
    ds_write_b128 v21, v[244:247] offset:32768
    v_cvt_pk_bf16_f32 v248, v160, v164
    v_cvt_pk_bf16_f32 v249, v168, v172
    v_cvt_pk_bf16_f32 v250, v161, v165
    v_cvt_pk_bf16_f32 v251, v169, v173
    ds_write_b128 v24, v[248:251] offset:0
    v_cvt_pk_bf16_f32 v252, v162, v166
    v_cvt_pk_bf16_f32 v253, v170, v174
    v_cvt_pk_bf16_f32 v254, v163, v167
    v_cvt_pk_bf16_f32 v255, v171, v175
    v_xor_b32 v24, 16, v24
    ds_write_b128 v24, v[252:255] offset:0
    v_add_f32 v176, v176, v112
    v_cndmask_b32 v112, v112, v31, s[60:61]
    v_cvt_pk_bf16_f32 v208, v112, v116
    v_cvt_pk_bf16_f32 v209, v120, v124
    v_cvt_pk_bf16_f32 v210, v113, v117
    v_cvt_pk_bf16_f32 v211, v121, v125
    ds_write_b128 v20, v[208:211] offset:49152
    v_cvt_pk_bf16_f32 v212, v114, v118
    v_cvt_pk_bf16_f32 v213, v122, v126
    v_cvt_pk_bf16_f32 v214, v115, v119
    v_cvt_pk_bf16_f32 v215, v123, v127
    v_add_f32 v177, v177, v113
    v_pk_add_f32 v[178:179], v[178:179], v[114:115]
    v_pk_add_f32 v[180:181], v[180:181], v[116:117]
    v_pk_add_f32 v[182:183], v[182:183], v[118:119]
    v_pk_add_f32 v[184:185], v[184:185], v[120:121]
    v_pk_add_f32 v[186:187], v[186:187], v[122:123]
    v_pk_add_f32 v[188:189], v[188:189], v[124:125]
    v_pk_add_f32 v[190:191], v[190:191], v[126:127]
    ds_write_b128 v21, v[212:215] offset:49152
    v_cvt_pk_bf16_f32 v216, v176, v180
    v_cvt_pk_bf16_f32 v217, v184, v188
    v_cvt_pk_bf16_f32 v218, v177, v181
    v_cvt_pk_bf16_f32 v219, v185, v189
    ds_write_b128 v25, v[216:219] offset:0
    v_cvt_pk_bf16_f32 v220, v178, v182
    v_cvt_pk_bf16_f32 v221, v186, v190
    v_cvt_pk_bf16_f32 v222, v179, v183
    v_cvt_pk_bf16_f32 v223, v187, v191
    v_xor_b32 v25, 16, v25
    ds_write_b128 v25, v[220:223] offset:0
    s_waitcnt lgkmcnt(0)
    s_barrier
    ds_read_b64 v[20:21], v8 offset:0
    ds_read_u16 v28, v12 offset:0
    ds_read_b64 v[22:23], v9 offset:0
    ds_read_u16 v29, v13 offset:0
    ds_read_b64 v[24:25], v10 offset:0
    ds_read_u16 v30, v14 offset:0
    ds_read_b64 v[64:65], v11 offset:0
    ds_read_u16 v31, v15 offset:0
    v_lshlrev_b32 v66, 2, v2
    v_lshl_add_u32 v66, v1, 7, v66
    s_lshl_b32 s45, s36, 12
    s_add_u32 s45, s45, 8585216
    buffer_load_dword v67, v66, s[28:31], s45 offen sc1
    s_waitcnt lgkmcnt(0)
    s_setprio 0
    s_barrier
    s_add_u32 s48, s96, 0
    s_and_b32 s48, s48, 7
    s_lshl_b32 s48, s48, 9
    s_add_u32 s48, s48, s49
    s_add_u32 m0, s59, 0
    s_nop 0
    buffer_load_dwordx4 v4, s[12:15], s48 offen offset:0  lds
    buffer_load_dwordx4 v5, s[12:15], s48 offen offset:1024  lds
    buffer_load_dwordx4 v6, s[12:15], s48 offen offset:2048  lds
    buffer_load_dwordx4 v7, s[12:15], s48 offen offset:3072  lds
    s_add_u32 m0, s59, 4096
    s_nop 0
    buffer_load_dwordx4 v16, s[12:15], s48 offen offset:0  lds
    buffer_load_dwordx4 v19, s[12:15], s48 offen offset:1024  lds
    buffer_load_dwordx4 v27, s[12:15], s48 offen offset:2048  lds
    buffer_load_dwordx4 v18, s[12:15], s48 offen offset:3072  lds
    s_add_u32 s48, s96, 1
    s_and_b32 s48, s48, 7
    s_lshl_b32 s48, s48, 9
    s_add_u32 s48, s48, s49
    s_add_u32 m0, s59, 8192
    s_nop 0
    buffer_load_dwordx4 v4, s[12:15], s48 offen offset:0  lds
    buffer_load_dwordx4 v5, s[12:15], s48 offen offset:1024  lds
    buffer_load_dwordx4 v6, s[12:15], s48 offen offset:2048  lds
    buffer_load_dwordx4 v7, s[12:15], s48 offen offset:3072  lds
    s_add_u32 m0, s59, 12288
    s_nop 0
    buffer_load_dwordx4 v16, s[12:15], s48 offen offset:0  lds
    buffer_load_dwordx4 v19, s[12:15], s48 offen offset:1024  lds
    buffer_load_dwordx4 v27, s[12:15], s48 offen offset:2048  lds
    buffer_load_dwordx4 v18, s[12:15], s48 offen offset:3072  lds
    s_setprio 2
    v_mov_b32 v56, v4
    v_mov_b32 v57, v5
    v_mov_b32 v58, v6
    v_mov_b32 v59, v7
    v_mov_b32 v60, v16
    v_mov_b32 v61, v19
    v_mov_b32 v62, v27
    v_mov_b32 v63, v18
    v_and_b32 v8, 6, v1
    v_lshrrev_b32 v9, 3, v1
    v_or_b32 v8, v8, v9
    v_xor_b32 v9, v1, v2
    v_and_b32 v9, 1, v9
    v_lshl_or_b32 v8, v9, 3, v8
    v_lshrrev_b32 v9, 1, v2
    v_lshl_or_b32 v8, v9, 4, v8
    v_lshl_or_b32 v8, v1, 5, v8
    v_lshl_add_u32 v48, v8, 4, s59
    v_xor_b32 v49, 16, v48
    v_xor_b32 v50, 32, v48
    v_xor_b32 v51, 48, v48
    v_xor_b32 v52, 64, v48
    v_xor_b32 v53, 80, v48
    v_xor_b32 v54, 96, v48
    v_xor_b32 v55, 112, v48
    s_setprio 0
    s_barrier
    s_lshl_b32 s40, s2, 2
    s_add_u32 s40, s40, s32
    s_mul_i32 s40, s40, 704
    s_min_u32 s40, s40, 703808
    s_add_u32 s42, s20, s40
    s_addc_u32 s43, s21, 0
    s_load_dword s97, s[42:43], 0
    s_load_dword s97, s[42:43], 64
    s_load_dword s97, s[42:43], 128
    s_load_dword s97, s[42:43], 192
    s_load_dword s97, s[42:43], 256
    s_load_dword s97, s[42:43], 320
    s_load_dword s97, s[42:43], 384
    s_load_dword s97, s[42:43], 448
    s_load_dword s97, s[42:43], 512
    s_load_dword s97, s[42:43], 576
    s_load_dword s97, s[42:43], 640
    s_setprio 2
    s_waitcnt vmcnt(16)
    v_cmp_ne_u32 vcc, s39, v67
    s_cbranch_vccnz L_f5
L_f5ok:
    s_setprio 0
    s_add_u32 m0, s57, 65536
    s_add_u32 s48, s50, 0
    buffer_load_dwordx4 v17, s[28:31], s48 offen offset:0 sc1 lds
    buffer_load_dwordx4 v17, s[28:31], s48 offen offset:1024 sc1 lds
    buffer_load_dwordx4 v17, s[28:31], s48 offen offset:2048 sc1 lds
    s_add_u32 m0, s57, 77824
    s_add_u32 s48, s50, 12288
    buffer_load_dwordx4 v17, s[28:31], s48 offen offset:0 sc1 lds
    buffer_load_dwordx4 v17, s[28:31], s48 offen offset:1024 sc1 lds
    buffer_load_dwordx4 v17, s[28:31], s48 offen offset:2048 sc1 lds
    s_add_u32 m0, s57, 90112
    s_add_u32 s48, s50, 24576
    buffer_load_dwordx4 v17, s[28:31], s48 offen offset:0 sc1 lds
    buffer_load_dwordx4 v17, s[28:31], s48 offen offset:1024 sc1 lds
    buffer_load_dwordx4 v17, s[28:31], s48 offen offset:2048 sc1 lds
    s_add_u32 m0, s57, 102400
    s_add_u32 s48, s50, 36864
    buffer_load_dwordx4 v17, s[28:31], s48 offen offset:0 sc1 lds
    buffer_load_dwordx4 v17, s[28:31], s48 offen offset:1024 sc1 lds
    buffer_load_dwordx4 v17, s[28:31], s48 offen offset:2048 sc1 lds
    s_waitcnt vmcnt(12)
    s_setprio 2
    ds_read_b128 v[128:131], v48 offset:0
    ds_read_b128 v[132:135], v49 offset:0
    ds_read_b128 v[136:139], v50 offset:0
    ds_read_b128 v[140:143], v51 offset:0
    ds_read_b128 v[144:147], v52 offset:0
    ds_read_b128 v[148:151], v53 offset:0
    ds_read_b128 v[152:155], v54 offset:0
    ds_read_b128 v[156:159], v55 offset:0
    ds_read_b128 v[160:163], v48 offset:8192
    ds_read_b128 v[164:167], v49 offset:8192
    ds_read_b128 v[168:171], v50 offset:8192
    ds_read_b128 v[172:175], v51 offset:8192
    ds_read_b128 v[176:179], v52 offset:8192
    ds_read_b128 v[180:183], v53 offset:8192
    ds_read_b128 v[184:187], v54 offset:8192
    ds_read_b128 v[188:191], v55 offset:8192
    s_waitcnt lgkmcnt(0)
    s_setprio 0
    s_add_u32 s48, s96, 2
    s_and_b32 s48, s48, 7
    s_lshl_b32 s48, s48, 9
    s_add_u32 s48, s48, s49
    s_add_u32 m0, s59, 0
    s_nop 0
    buffer_load_dwordx4 v56, s[12:15], s48 offen offset:0  lds
    buffer_load_dwordx4 v57, s[12:15], s48 offen offset:1024  lds
    buffer_load_dwordx4 v58, s[12:15], s48 offen offset:2048  lds
    buffer_load_dwordx4 v59, s[12:15], s48 offen offset:3072  lds
    s_add_u32 m0, s59, 4096
    s_nop 0
    buffer_load_dwordx4 v60, s[12:15], s48 offen offset:0  lds
    buffer_load_dwordx4 v61, s[12:15], s48 offen offset:1024  lds
    buffer_load_dwordx4 v62, s[12:15], s48 offen offset:2048  lds
    buffer_load_dwordx4 v63, s[12:15], s48 offen offset:3072  lds
    s_add_u32 s48, s96, 3
    s_and_b32 s48, s48, 7
    s_lshl_b32 s48, s48, 9
    s_add_u32 s48, s48, s49
    s_add_u32 m0, s59, 8192
    s_nop 0
    buffer_load_dwordx4 v56, s[12:15], s48 offen offset:0  lds
    buffer_load_dwordx4 v57, s[12:15], s48 offen offset:1024  lds
    buffer_load_dwordx4 v58, s[12:15], s48 offen offset:2048  lds
    buffer_load_dwordx4 v59, s[12:15], s48 offen offset:3072  lds
    s_add_u32 m0, s59, 12288
    s_nop 0
    buffer_load_dwordx4 v60, s[12:15], s48 offen offset:0  lds
    buffer_load_dwordx4 v61, s[12:15], s48 offen offset:1024  lds
    buffer_load_dwordx4 v62, s[12:15], s48 offen offset:2048  lds
    buffer_load_dwordx4 v63, s[12:15], s48 offen offset:3072  lds
    s_waitcnt vmcnt(16)
    s_barrier
    s_add_u32 m0, s57, 114688
    s_add_u32 s48, s50, 49152
    buffer_load_dwordx4 v17, s[28:31], s48 offen offset:0 sc1 lds
    s_waitcnt vmcnt(6)
    buffer_load_dwordx4 v17, s[28:31], s48 offen offset:1024 sc1 lds
    s_waitcnt vmcnt(6)
    buffer_load_dwordx4 v17, s[28:31], s48 offen offset:2048 sc1 lds
    s_waitcnt vmcnt(6)
    s_add_u32 m0, s57, 126976
    s_add_u32 s48, s50, 61440
    buffer_load_dwordx4 v17, s[28:31], s48 offen offset:0 sc1 lds
    s_waitcnt vmcnt(6)
    buffer_load_dwordx4 v17, s[28:31], s48 offen offset:1024 sc1 lds
    s_waitcnt vmcnt(6)
    buffer_load_dwordx4 v17, s[28:31], s48 offen offset:2048 sc1 lds
    s_waitcnt vmcnt(6)
    s_add_u32 m0, s57, 139264
    s_add_u32 s48, s50, 73728
    buffer_load_dwordx4 v17, s[28:31], s48 offen offset:0 sc1 lds
    s_waitcnt vmcnt(6)
    buffer_load_dwordx4 v17, s[28:31], s48 offen offset:1024 sc1 lds
    s_waitcnt vmcnt(6)
    buffer_load_dwordx4 v17, s[28:31], s48 offen offset:2048 sc1 lds
    s_waitcnt vmcnt(6)
    s_add_u32 m0, s57, 151552
    s_add_u32 s48, s50, 86016
    buffer_load_dwordx4 v17, s[28:31], s48 offen offset:0 sc1 lds
    s_waitcnt vmcnt(6)
    buffer_load_dwordx4 v17, s[28:31], s48 offen offset:1024 sc1 lds
    s_waitcnt vmcnt(6)
    buffer_load_dwordx4 v17, s[28:31], s48 offen offset:2048 sc1 lds
    s_waitcnt vmcnt(6)
    s_setprio 2
    ds_read_b128 v[192:195], v48 offset:0
    ds_read_b128 v[196:199], v49 offset:0
    ds_read_b128 v[200:203], v50 offset:0
    ds_read_b128 v[204:207], v51 offset:0
    ds_read_b128 v[208:211], v52 offset:0
    ds_read_b128 v[212:215], v53 offset:0
    ds_read_b128 v[216:219], v54 offset:0
    ds_read_b128 v[220:223], v55 offset:0
    s_waitcnt lgkmcnt(0)
    s_setprio 0
    s_add_u32 s48, s96, 4
    s_and_b32 s48, s48, 7
    s_lshl_b32 s48, s48, 9
    s_add_u32 s48, s48, s49
    s_add_u32 m0, s59, 0
    s_nop 0
    buffer_load_dwordx4 v56, s[12:15], s48 offen offset:0  lds
    s_waitcnt vmcnt(4)
    buffer_load_dwordx4 v57, s[12:15], s48 offen offset:1024  lds
    s_waitcnt vmcnt(4)
    buffer_load_dwordx4 v58, s[12:15], s48 offen offset:2048  lds
    s_waitcnt vmcnt(4)
    buffer_load_dwordx4 v59, s[12:15], s48 offen offset:3072  lds
    s_waitcnt vmcnt(4)
    s_add_u32 m0, s59, 4096
    s_nop 0
    buffer_load_dwordx4 v60, s[12:15], s48 offen offset:0  lds
    s_waitcnt vmcnt(4)
    buffer_load_dwordx4 v61, s[12:15], s48 offen offset:1024  lds
    s_waitcnt vmcnt(4)
    buffer_load_dwordx4 v62, s[12:15], s48 offen offset:2048  lds
    s_waitcnt vmcnt(4)
    buffer_load_dwordx4 v63, s[12:15], s48 offen offset:3072  lds
    s_waitcnt vmcnt(4)
    s_setprio 2
    ds_read_b128 v[224:227], v48 offset:8192
    ds_read_b128 v[228:231], v49 offset:8192
    ds_read_b128 v[232:235], v50 offset:8192
    ds_read_b128 v[236:239], v51 offset:8192
    ds_read_b128 v[240:243], v52 offset:8192
    ds_read_b128 v[244:247], v53 offset:8192
    ds_read_b128 v[248:251], v54 offset:8192
    ds_read_b128 v[252:255], v55 offset:8192
    s_waitcnt lgkmcnt(0)
    s_setprio 0
    s_add_u32 s48, s96, 5
    s_and_b32 s48, s48, 7
    s_lshl_b32 s48, s48, 9
    s_add_u32 s48, s48, s49
    s_add_u32 m0, s59, 8192
    s_nop 0
    buffer_load_dwordx4 v56, s[12:15], s48 offen offset:0  lds
    s_waitcnt vmcnt(4)
    buffer_load_dwordx4 v57, s[12:15], s48 offen offset:1024  lds
    s_waitcnt vmcnt(4)
    buffer_load_dwordx4 v58, s[12:15], s48 offen offset:2048  lds
    s_waitcnt vmcnt(4)
    buffer_load_dwordx4 v59, s[12:15], s48 offen offset:3072  lds
    s_waitcnt vmcnt(4)
    s_add_u32 m0, s59, 12288
    s_nop 0
    buffer_load_dwordx4 v60, s[12:15], s48 offen offset:0  lds
    s_waitcnt vmcnt(4)
    buffer_load_dwordx4 v61, s[12:15], s48 offen offset:1024  lds
    s_waitcnt vmcnt(4)
    buffer_load_dwordx4 v62, s[12:15], s48 offen offset:2048  lds
    s_waitcnt vmcnt(4)
    buffer_load_dwordx4 v63, s[12:15], s48 offen offset:3072  lds
    s_waitcnt vmcnt(4)
    v_mov_b32 v26, v64
    v_mov_b32 v27, v65
    s_cmp_eq_u32 s36, 0
    s_cselect_b32 s41, 5, 0
    v_mov_b32 v7, 2147418112
    s_mov_b32 s42, 5376
    v_add_u32 v4, 0, v0
    v_mul_u32_u24 v5, 171, v4
    v_lshrrev_b32 v5, 13, v5
    v_mul_u32_u24 v6, 48, v5
    v_sub_u32 v6, v4, v6
    v_lshrrev_b32 v4, 1, v6
    v_xor_b32 v4, v4, v5
    v_and_b32 v4, 1, v4
    v_lshrrev_b32 v6, 4, v6
    v_lshl_or_b32 v4, v6, 1, v4
    v_cmp_le_u32 vcc, s41, v4
    v_lshlrev_b32 v6, 4, v0
    v_mad_u32_u24 v5, v5, s42, v6
    v_cndmask_b32 v8, v7, v5, vcc
    v_add_u32 v4, 64, v0
    v_mul_u32_u24 v5, 171, v4
    v_lshrrev_b32 v5, 13, v5
    v_mul_u32_u24 v6, 48, v5
    v_sub_u32 v6, v4, v6
    v_lshrrev_b32 v4, 1, v6
    v_xor_b32 v4, v4, v5
    v_and_b32 v4, 1, v4
    v_lshrrev_b32 v6, 4, v6
    v_lshl_or_b32 v4, v6, 1, v4
    v_cmp_le_u32 vcc, s41, v4
    v_lshlrev_b32 v6, 4, v0
    v_mad_u32_u24 v5, v5, s42, v6
    v_cndmask_b32 v9, v7, v5, vcc
    v_add_u32 v4, 128, v0
    v_mul_u32_u24 v5, 171, v4
    v_lshrrev_b32 v5, 13, v5
    v_mul_u32_u24 v6, 48, v5
    v_sub_u32 v6, v4, v6
    v_lshrrev_b32 v4, 1, v6
    v_xor_b32 v4, v4, v5
    v_and_b32 v4, 1, v4
    v_lshrrev_b32 v6, 4, v6
    v_lshl_or_b32 v4, v6, 1, v4
    v_cmp_le_u32 vcc, s41, v4
    v_lshlrev_b32 v6, 4, v0
    v_mad_u32_u24 v5, v5, s42, v6
    v_cndmask_b32 v10, v7, v5, vcc
    s_mul_i32 s55, s32, 6144
    s_mul_i32 s41, s32, 49152
    s_add_u32 s54, s98, s41
    v_bfe_u32 v4, v0, 2, 2
    v_and_b32 v5, 2, v4
    v_and_b32 v6, 1, v4
    v_lshl_or_b32 v5, v5, 1, v6
    v_lshlrev_b32 v6, 1, v2
    v_xor_b32 v5, v5, v6
    v_mul_u32_u24 v4, 768, v4
    v_lshl_add_u32 v4, v5, 5, v4
    v_and_b32 v5, 3, v0
    v_lshl_add_u32 v4, v5, 3, v4
    v_add_u32 v12, 16384, v4
    v_xor_b32 v13, 32, v12
    v_add_u32 v14, 49152, v12
    v_add_u32 v15, 49152, v13
    s_lshl_b32 s40, s63, 10
    s_add_u32 s40, s40, s62
    v_lshl_add_u32 v11, v1, 6, s40
    v_lshlrev_b32 v3, 1, v11
    v_mov_b32 v16, 0
    buffer_load_short_d16_hi v16, v3, s[16:19], 0 offen
    s_waitcnt vmcnt(1)
    s_barrier
    v_and_b32 v3, 31, v0
    v_lshlrev_b32 v3, 7, v3
    s_lshl_b32 s47, s36, 12
    s_add_u32 s47, s47, 8552448
    s_barrier
    s_setprio 2
L_poll14:
    buffer_load_dwordx4 v[4:7], v3, s[28:31], s47 offen sc1
    s_add_u32 s58, s58, 8
    s_waitcnt vmcnt(0)
    v_xor_b32 v4, s39, v4
    v_xor_b32 v5, s39, v5
    v_xor_b32 v6, s39, v6
    v_xor_b32 v7, s39, v7
    v_or3_b32 v4, v4, v5, v6
    v_or_b32 v4, v4, v7
    v_cmp_ne_u32 vcc, 0, v4
    s_cbranch_vccz L_pdone14
    s_mov_b64 exec, vcc
    s_sleep 1
    s_cmp_lt_u32 s58, 400000
    s_cbranch_scc1 L_poll14
L_pdone14:
    s_mov_b64 exec, -1
    s_add_u32 s48, s96, 0
    s_and_b32 s48, s48, 7
    s_mul_i32 s48, s48, 768
    s_add_u32 s48, s48, s54
    s_add_u32 s48, s48, 0
    s_add_u32 m0, s55, 65536
    s_nop 0
    buffer_load_dwordx4 v8, s[28:31], s48 offen offset:0 sc1 lds
    buffer_load_dwordx4 v9, s[28:31], s48 offen offset:1024 sc1 lds
    buffer_load_dwordx4 v10, s[28:31], s48 offen offset:2048 sc1 lds
    s_add_u32 s48, s48, 24576
    s_add_u32 m0, s55, 68608
    s_nop 0
    buffer_load_dwordx4 v8, s[28:31], s48 offen offset:0 sc1 lds
    buffer_load_dwordx4 v9, s[28:31], s48 offen offset:1024 sc1 lds
    buffer_load_dwordx4 v10, s[28:31], s48 offen offset:2048 sc1 lds
    s_add_u32 s48, s96, 0
    s_and_b32 s48, s48, 7
    s_mul_i32 s48, s48, 768
    s_add_u32 s48, s48, s54
    s_add_u32 s48, s48, 196608
    s_add_u32 m0, s55, 90112
    s_nop 0
    buffer_load_dwordx4 v8, s[28:31], s48 offen offset:0 sc1 lds
    buffer_load_dwordx4 v9, s[28:31], s48 offen offset:1024 sc1 lds
    buffer_load_dwordx4 v10, s[28:31], s48 offen offset:2048 sc1 lds
    s_add_u32 s48, s48, 24576
    s_add_u32 m0, s55, 93184
    s_nop 0
    buffer_load_dwordx4 v8, s[28:31], s48 offen offset:0 sc1 lds
    buffer_load_dwordx4 v9, s[28:31], s48 offen offset:1024 sc1 lds
    buffer_load_dwordx4 v10, s[28:31], s48 offen offset:2048 sc1 lds
    s_setprio 1
    v_add_u32 v6, 98304, v12
    v_add_u32 v7, 98304, v13
    s_waitcnt vmcnt(6)
    s_barrier
    ds_read_b64_tr_b16 v[32:33], v14 offset:0
    ds_read_b64_tr_b16 v[34:35], v14 offset:3072
    ds_read_b64_tr_b16 v[36:37], v15 offset:0
    ds_read_b64_tr_b16 v[38:39], v15 offset:3072
    ds_read_b64_tr_b16 v[40:41], v14 offset:256
    ds_read_b64_tr_b16 v[42:43], v14 offset:3328
    ds_read_b64_tr_b16 v[44:45], v15 offset:256
    ds_read_b64_tr_b16 v[46:47], v15 offset:3328
    ds_read_b64_tr_b16 v[48:49], v14 offset:512
    ds_read_b64_tr_b16 v[50:51], v14 offset:3584
    ds_read_b64_tr_b16 v[52:53], v15 offset:512
    ds_read_b64_tr_b16 v[54:55], v15 offset:3584
    ds_read_b64_tr_b16 v[88:89], v14 offset:6144
    ds_read_b64_tr_b16 v[90:91], v14 offset:9216
    ds_read_b64_tr_b16 v[92:93], v15 offset:6144
    ds_read_b64_tr_b16 v[94:95], v15 offset:9216
    ds_read_b64_tr_b16 v[96:97], v14 offset:6400
    ds_read_b64_tr_b16 v[98:99], v14 offset:9472
    ds_read_b64_tr_b16 v[100:101], v15 offset:6400
    ds_read_b64_tr_b16 v[102:103], v15 offset:9472
    ds_read_b64_tr_b16 v[104:105], v14 offset:6656
    ds_read_b64_tr_b16 v[106:107], v14 offset:9728
    ds_read_b64_tr_b16 v[108:109], v15 offset:6656
    ds_read_b64_tr_b16 v[110:111], v15 offset:9728
    s_waitcnt lgkmcnt(12)
    v_mfma_f32_16x16x32_bf16 v[64:67], v[32:35], v[128:131], 0
    ds_read_b64_tr_b16 v[112:113], v14 offset:12288
    ds_read_b64_tr_b16 v[114:115], v14 offset:15360
    v_mfma_f32_16x16x32_bf16 v[68:71], v[36:39], v[128:131], 0
    ds_read_b64_tr_b16 v[116:117], v15 offset:12288
    ds_read_b64_tr_b16 v[118:119], v15 offset:15360
    v_mfma_f32_16x16x32_bf16 v[72:75], v[40:43], v[128:131], 0
    ds_read_b64_tr_b16 v[120:121], v14 offset:12544
    ds_read_b64_tr_b16 v[122:123], v14 offset:15616
    v_mfma_f32_16x16x32_bf16 v[76:79], v[44:47], v[128:131], 0
    ds_read_b64_tr_b16 v[124:125], v15 offset:12544
    ds_read_b64_tr_b16 v[126:127], v15 offset:15616
    v_mfma_f32_16x16x32_bf16 v[80:83], v[48:51], v[128:131], 0
    ds_read_b64_tr_b16 v[56:57], v14 offset:12800
    ds_read_b64_tr_b16 v[58:59], v14 offset:15872
    v_mfma_f32_16x16x32_bf16 v[84:87], v[52:55], v[128:131], 0
    ds_read_b64_tr_b16 v[60:61], v15 offset:12800
    ds_read_b64_tr_b16 v[62:63], v15 offset:15872
    s_waitcnt lgkmcnt(12)
    v_mfma_f32_16x16x32_bf16 v[64:67], v[88:91], v[132:135], v[64:67]
    ds_read_b64_tr_b16 v[32:33], v14 offset:18432
    ds_read_b64_tr_b16 v[34:35], v14 offset:21504
    v_mfma_f32_16x16x32_bf16 v[68:71], v[92:95], v[132:135], v[68:71]
    ds_read_b64_tr_b16 v[36:37], v15 offset:18432
    ds_read_b64_tr_b16 v[38:39], v15 offset:21504
    v_mfma_f32_16x16x32_bf16 v[72:75], v[96:99], v[132:135], v[72:75]
    ds_read_b64_tr_b16 v[40:41], v14 offset:18688
    ds_read_b64_tr_b16 v[42:43], v14 offset:21760
    v_mfma_f32_16x16x32_bf16 v[76:79], v[100:103], v[132:135], v[76:79]
    ds_read_b64_tr_b16 v[44:45], v15 offset:18688
    ds_read_b64_tr_b16 v[46:47], v15 offset:21760
    v_mfma_f32_16x16x32_bf16 v[80:83], v[104:107], v[132:135], v[80:83]
    ds_read_b64_tr_b16 v[48:49], v14 offset:18944
    ds_read_b64_tr_b16 v[50:51], v14 offset:22016
    v_mfma_f32_16x16x32_bf16 v[84:87], v[108:111], v[132:135], v[84:87]
    ds_read_b64_tr_b16 v[52:53], v15 offset:18944
    ds_read_b64_tr_b16 v[54:55], v15 offset:22016
    s_waitcnt vmcnt(0)
    s_barrier
    s_waitcnt lgkmcnt(12)
    v_mfma_f32_16x16x32_bf16 v[64:67], v[112:115], v[136:139], v[64:67]
    ds_read_b64_tr_b16 v[88:89], v14 offset:24576
    ds_read_b64_tr_b16 v[90:91], v14 offset:27648
    v_mfma_f32_16x16x32_bf16 v[68:71], v[116:119], v[136:139], v[68:71]
    ds_read_b64_tr_b16 v[92:93], v15 offset:24576
    ds_read_b64_tr_b16 v[94:95], v15 offset:27648
    v_mfma_f32_16x16x32_bf16 v[72:75], v[120:123], v[136:139], v[72:75]
    ds_read_b64_tr_b16 v[96:97], v14 offset:24832
    ds_read_b64_tr_b16 v[98:99], v14 offset:27904
    v_mfma_f32_16x16x32_bf16 v[76:79], v[124:127], v[136:139], v[76:79]
    ds_read_b64_tr_b16 v[100:101], v15 offset:24832
    ds_read_b64_tr_b16 v[102:103], v15 offset:27904
    v_mfma_f32_16x16x32_bf16 v[80:83], v[56:59], v[136:139], v[80:83]
    ds_read_b64_tr_b16 v[104:105], v14 offset:25088
    ds_read_b64_tr_b16 v[106:107], v14 offset:28160
    v_mfma_f32_16x16x32_bf16 v[84:87], v[60:63], v[136:139], v[84:87]
    ds_read_b64_tr_b16 v[108:109], v15 offset:25088
    ds_read_b64_tr_b16 v[110:111], v15 offset:28160
    s_waitcnt lgkmcnt(12)
    v_mfma_f32_16x16x32_bf16 v[64:67], v[32:35], v[140:143], v[64:67]
    ds_read_b64_tr_b16 v[112:113], v14 offset:30720
    ds_read_b64_tr_b16 v[114:115], v14 offset:33792
    v_mfma_f32_16x16x32_bf16 v[68:71], v[36:39], v[140:143], v[68:71]
    ds_read_b64_tr_b16 v[116:117], v15 offset:30720
    ds_read_b64_tr_b16 v[118:119], v15 offset:33792
    v_mfma_f32_16x16x32_bf16 v[72:75], v[40:43], v[140:143], v[72:75]
    ds_read_b64_tr_b16 v[120:121], v14 offset:30976
    ds_read_b64_tr_b16 v[122:123], v14 offset:34048
    v_mfma_f32_16x16x32_bf16 v[76:79], v[44:47], v[140:143], v[76:79]
    ds_read_b64_tr_b16 v[124:125], v15 offset:30976
    ds_read_b64_tr_b16 v[126:127], v15 offset:34048
    v_mfma_f32_16x16x32_bf16 v[80:83], v[48:51], v[140:143], v[80:83]
    ds_read_b64_tr_b16 v[56:57], v14 offset:31232
    ds_read_b64_tr_b16 v[58:59], v14 offset:34304
    v_mfma_f32_16x16x32_bf16 v[84:87], v[52:55], v[140:143], v[84:87]
    ds_read_b64_tr_b16 v[60:61], v15 offset:31232
    ds_read_b64_tr_b16 v[62:63], v15 offset:34304
    s_waitcnt lgkmcnt(12)
    v_mfma_f32_16x16x32_bf16 v[64:67], v[88:91], v[144:147], v[64:67]
    ds_read_b64_tr_b16 v[32:33], v14 offset:36864
    ds_read_b64_tr_b16 v[34:35], v14 offset:39936
    v_mfma_f32_16x16x32_bf16 v[68:71], v[92:95], v[144:147], v[68:71]
    ds_read_b64_tr_b16 v[36:37], v15 offset:36864
    ds_read_b64_tr_b16 v[38:39], v15 offset:39936
    v_mfma_f32_16x16x32_bf16 v[72:75], v[96:99], v[144:147], v[72:75]
    ds_read_b64_tr_b16 v[40:41], v14 offset:37120
    ds_read_b64_tr_b16 v[42:43], v14 offset:40192
    v_mfma_f32_16x16x32_bf16 v[76:79], v[100:103], v[144:147], v[76:79]
    ds_read_b64_tr_b16 v[44:45], v15 offset:37120
    ds_read_b64_tr_b16 v[46:47], v15 offset:40192
    v_mfma_f32_16x16x32_bf16 v[80:83], v[104:107], v[144:147], v[80:83]
    ds_read_b64_tr_b16 v[48:49], v14 offset:37376
    ds_read_b64_tr_b16 v[50:51], v14 offset:40448
    v_mfma_f32_16x16x32_bf16 v[84:87], v[108:111], v[144:147], v[84:87]
    ds_read_b64_tr_b16 v[52:53], v15 offset:37376
    ds_read_b64_tr_b16 v[54:55], v15 offset:40448
    s_waitcnt lgkmcnt(12)
    v_mfma_f32_16x16x32_bf16 v[64:67], v[112:115], v[148:151], v[64:67]
    ds_read_b64_tr_b16 v[88:89], v14 offset:43008
    ds_read_b64_tr_b16 v[90:91], v14 offset:46080
    v_mfma_f32_16x16x32_bf16 v[68:71], v[116:119], v[148:151], v[68:71]
    ds_read_b64_tr_b16 v[92:93], v15 offset:43008
    ds_read_b64_tr_b16 v[94:95], v15 offset:46080
    v_mfma_f32_16x16x32_bf16 v[72:75], v[120:123], v[148:151], v[72:75]
    ds_read_b64_tr_b16 v[96:97], v14 offset:43264
    ds_read_b64_tr_b16 v[98:99], v14 offset:46336
    v_mfma_f32_16x16x32_bf16 v[76:79], v[124:127], v[148:151], v[76:79]
    ds_read_b64_tr_b16 v[100:101], v15 offset:43264
    ds_read_b64_tr_b16 v[102:103], v15 offset:46336
    v_mfma_f32_16x16x32_bf16 v[80:83], v[56:59], v[148:151], v[80:83]
    ds_read_b64_tr_b16 v[104:105], v14 offset:43520
    ds_read_b64_tr_b16 v[106:107], v14 offset:46592
    v_mfma_f32_16x16x32_bf16 v[84:87], v[60:63], v[148:151], v[84:87]
    ds_read_b64_tr_b16 v[108:109], v15 offset:43520
    ds_read_b64_tr_b16 v[110:111], v15 offset:46592
    s_barrier
    s_waitcnt lgkmcnt(12)
    v_mfma_f32_16x16x32_bf16 v[64:67], v[32:35], v[152:155], v[64:67]
    ds_read_b64_tr_b16 v[112:113], v6 offset:0
    ds_read_b64_tr_b16 v[114:115], v6 offset:3072
    v_mfma_f32_16x16x32_bf16 v[68:71], v[36:39], v[152:155], v[68:71]
    ds_read_b64_tr_b16 v[116:117], v7 offset:0
    ds_read_b64_tr_b16 v[118:119], v7 offset:3072
    v_mfma_f32_16x16x32_bf16 v[72:75], v[40:43], v[152:155], v[72:75]
    ds_read_b64_tr_b16 v[120:121], v6 offset:256
    ds_read_b64_tr_b16 v[122:123], v6 offset:3328
    v_mfma_f32_16x16x32_bf16 v[76:79], v[44:47], v[152:155], v[76:79]
    ds_read_b64_tr_b16 v[124:125], v7 offset:256
    ds_read_b64_tr_b16 v[126:127], v7 offset:3328
    v_mfma_f32_16x16x32_bf16 v[80:83], v[48:51], v[152:155], v[80:83]
    ds_read_b64_tr_b16 v[56:57], v6 offset:512
    ds_read_b64_tr_b16 v[58:59], v6 offset:3584
    v_mfma_f32_16x16x32_bf16 v[84:87], v[52:55], v[152:155], v[84:87]
    ds_read_b64_tr_b16 v[60:61], v7 offset:512
    ds_read_b64_tr_b16 v[62:63], v7 offset:3584
    s_waitcnt lgkmcnt(12)
    v_mfma_f32_16x16x32_bf16 v[64:67], v[88:91], v[156:159], v[64:67]
    ds_read_b64_tr_b16 v[32:33], v6 offset:6144
    ds_read_b64_tr_b16 v[34:35], v6 offset:9216
    v_mfma_f32_16x16x32_bf16 v[68:71], v[92:95], v[156:159], v[68:71]
    ds_read_b64_tr_b16 v[36:37], v7 offset:6144
    ds_read_b64_tr_b16 v[38:39], v7 offset:9216
    v_mfma_f32_16x16x32_bf16 v[72:75], v[96:99], v[156:159], v[72:75]
    ds_read_b64_tr_b16 v[40:41], v6 offset:6400
    ds_read_b64_tr_b16 v[42:43], v6 offset:9472
    v_mfma_f32_16x16x32_bf16 v[76:79], v[100:103], v[156:159], v[76:79]
    ds_read_b64_tr_b16 v[44:45], v7 offset:6400
    ds_read_b64_tr_b16 v[46:47], v7 offset:9472
    v_mfma_f32_16x16x32_bf16 v[80:83], v[104:107], v[156:159], v[80:83]
    ds_read_b64_tr_b16 v[48:49], v6 offset:6656
    ds_read_b64_tr_b16 v[50:51], v6 offset:9728
    v_mfma_f32_16x16x32_bf16 v[84:87], v[108:111], v[156:159], v[84:87]
    ds_read_b64_tr_b16 v[52:53], v7 offset:6656
    ds_read_b64_tr_b16 v[54:55], v7 offset:9728
    s_waitcnt lgkmcnt(12)
    v_mfma_f32_16x16x32_bf16 v[64:67], v[112:115], v[160:163], v[64:67]
    ds_read_b64_tr_b16 v[88:89], v6 offset:12288
    ds_read_b64_tr_b16 v[90:91], v6 offset:15360
    v_mfma_f32_16x16x32_bf16 v[68:71], v[116:119], v[160:163], v[68:71]
    ds_read_b64_tr_b16 v[92:93], v7 offset:12288
    ds_read_b64_tr_b16 v[94:95], v7 offset:15360
    v_mfma_f32_16x16x32_bf16 v[72:75], v[120:123], v[160:163], v[72:75]
    ds_read_b64_tr_b16 v[96:97], v6 offset:12544
    ds_read_b64_tr_b16 v[98:99], v6 offset:15616
    v_mfma_f32_16x16x32_bf16 v[76:79], v[124:127], v[160:163], v[76:79]
    ds_read_b64_tr_b16 v[100:101], v7 offset:12544
    ds_read_b64_tr_b16 v[102:103], v7 offset:15616
    v_mfma_f32_16x16x32_bf16 v[80:83], v[56:59], v[160:163], v[80:83]
    ds_read_b64_tr_b16 v[104:105], v6 offset:12800
    ds_read_b64_tr_b16 v[106:107], v6 offset:15872
    v_mfma_f32_16x16x32_bf16 v[84:87], v[60:63], v[160:163], v[84:87]
    ds_read_b64_tr_b16 v[108:109], v7 offset:12800
    ds_read_b64_tr_b16 v[110:111], v7 offset:15872
    s_waitcnt lgkmcnt(12)
    v_mfma_f32_16x16x32_bf16 v[64:67], v[32:35], v[164:167], v[64:67]
    ds_read_b64_tr_b16 v[112:113], v6 offset:18432
    ds_read_b64_tr_b16 v[114:115], v6 offset:21504
    v_mfma_f32_16x16x32_bf16 v[68:71], v[36:39], v[164:167], v[68:71]
    ds_read_b64_tr_b16 v[116:117], v7 offset:18432
    ds_read_b64_tr_b16 v[118:119], v7 offset:21504
    v_mfma_f32_16x16x32_bf16 v[72:75], v[40:43], v[164:167], v[72:75]
    ds_read_b64_tr_b16 v[120:121], v6 offset:18688
    ds_read_b64_tr_b16 v[122:123], v6 offset:21760
    v_mfma_f32_16x16x32_bf16 v[76:79], v[44:47], v[164:167], v[76:79]
    ds_read_b64_tr_b16 v[124:125], v7 offset:18688
    ds_read_b64_tr_b16 v[126:127], v7 offset:21760
    v_mfma_f32_16x16x32_bf16 v[80:83], v[48:51], v[164:167], v[80:83]
    ds_read_b64_tr_b16 v[56:57], v6 offset:18944
    ds_read_b64_tr_b16 v[58:59], v6 offset:22016
    v_mfma_f32_16x16x32_bf16 v[84:87], v[52:55], v[164:167], v[84:87]
    ds_read_b64_tr_b16 v[60:61], v7 offset:18944
    ds_read_b64_tr_b16 v[62:63], v7 offset:22016
    s_barrier
    s_waitcnt lgkmcnt(12)
    v_mfma_f32_16x16x32_bf16 v[64:67], v[88:91], v[168:171], v[64:67]
    ds_read_b64_tr_b16 v[32:33], v12 offset:0
    ds_read_b64_tr_b16 v[34:35], v12 offset:3072
    v_mfma_f32_16x16x32_bf16 v[68:71], v[92:95], v[168:171], v[68:71]
    ds_read_b64_tr_b16 v[36:37], v13 offset:0
    ds_read_b64_tr_b16 v[38:39], v13 offset:3072
    v_mfma_f32_16x16x32_bf16 v[72:75], v[96:99], v[168:171], v[72:75]
    ds_read_b64_tr_b16 v[40:41], v12 offset:256
    ds_read_b64_tr_b16 v[42:43], v12 offset:3328
    v_mfma_f32_16x16x32_bf16 v[76:79], v[100:103], v[168:171], v[76:79]
    ds_read_b64_tr_b16 v[44:45], v13 offset:256
    ds_read_b64_tr_b16 v[46:47], v13 offset:3328
    v_mfma_f32_16x16x32_bf16 v[80:83], v[104:107], v[168:171], v[80:83]
    ds_read_b64_tr_b16 v[48:49], v12 offset:512
    ds_read_b64_tr_b16 v[50:51], v12 offset:3584
    v_mfma_f32_16x16x32_bf16 v[84:87], v[108:111], v[168:171], v[84:87]
    ds_read_b64_tr_b16 v[52:53], v13 offset:512
    ds_read_b64_tr_b16 v[54:55], v13 offset:3584
    s_waitcnt lgkmcnt(12)
    v_mfma_f32_16x16x32_bf16 v[64:67], v[112:115], v[172:175], v[64:67]
    ds_read_b64_tr_b16 v[88:89], v12 offset:6144
    ds_read_b64_tr_b16 v[90:91], v12 offset:9216
    v_mfma_f32_16x16x32_bf16 v[68:71], v[116:119], v[172:175], v[68:71]
    ds_read_b64_tr_b16 v[92:93], v13 offset:6144
    ds_read_b64_tr_b16 v[94:95], v13 offset:9216
    v_mfma_f32_16x16x32_bf16 v[72:75], v[120:123], v[172:175], v[72:75]
    ds_read_b64_tr_b16 v[96:97], v12 offset:6400
    ds_read_b64_tr_b16 v[98:99], v12 offset:9472
    v_mfma_f32_16x16x32_bf16 v[76:79], v[124:127], v[172:175], v[76:79]
    ds_read_b64_tr_b16 v[100:101], v13 offset:6400
    ds_read_b64_tr_b16 v[102:103], v13 offset:9472
    v_mfma_f32_16x16x32_bf16 v[80:83], v[56:59], v[172:175], v[80:83]
    ds_read_b64_tr_b16 v[104:105], v12 offset:6656
    ds_read_b64_tr_b16 v[106:107], v12 offset:9728
    v_mfma_f32_16x16x32_bf16 v[84:87], v[60:63], v[172:175], v[84:87]
    ds_read_b64_tr_b16 v[108:109], v13 offset:6656
    ds_read_b64_tr_b16 v[110:111], v13 offset:9728
    s_waitcnt lgkmcnt(12)
    v_mfma_f32_16x16x32_bf16 v[64:67], v[32:35], v[176:179], v[64:67]
    ds_read_b64_tr_b16 v[112:113], v12 offset:12288
    ds_read_b64_tr_b16 v[114:115], v12 offset:15360
    v_mfma_f32_16x16x32_bf16 v[68:71], v[36:39], v[176:179], v[68:71]
    ds_read_b64_tr_b16 v[116:117], v13 offset:12288
    ds_read_b64_tr_b16 v[118:119], v13 offset:15360
    v_mfma_f32_16x16x32_bf16 v[72:75], v[40:43], v[176:179], v[72:75]
    ds_read_b64_tr_b16 v[120:121], v12 offset:12544
    ds_read_b64_tr_b16 v[122:123], v12 offset:15616
    v_mfma_f32_16x16x32_bf16 v[76:79], v[44:47], v[176:179], v[76:79]
    ds_read_b64_tr_b16 v[124:125], v13 offset:12544
    ds_read_b64_tr_b16 v[126:127], v13 offset:15616
    v_mfma_f32_16x16x32_bf16 v[80:83], v[48:51], v[176:179], v[80:83]
    ds_read_b64_tr_b16 v[56:57], v12 offset:12800
    ds_read_b64_tr_b16 v[58:59], v12 offset:15872
    v_mfma_f32_16x16x32_bf16 v[84:87], v[52:55], v[176:179], v[84:87]
    ds_read_b64_tr_b16 v[60:61], v13 offset:12800
    ds_read_b64_tr_b16 v[62:63], v13 offset:15872
    s_waitcnt lgkmcnt(12)
    v_mfma_f32_16x16x32_bf16 v[64:67], v[88:91], v[180:183], v[64:67]
    ds_read_b64_tr_b16 v[32:33], v12 offset:18432
    ds_read_b64_tr_b16 v[34:35], v12 offset:21504
    v_mfma_f32_16x16x32_bf16 v[68:71], v[92:95], v[180:183], v[68:71]
    ds_read_b64_tr_b16 v[36:37], v13 offset:18432
    ds_read_b64_tr_b16 v[38:39], v13 offset:21504
    v_mfma_f32_16x16x32_bf16 v[72:75], v[96:99], v[180:183], v[72:75]
    ds_read_b64_tr_b16 v[40:41], v12 offset:18688
    ds_read_b64_tr_b16 v[42:43], v12 offset:21760
    v_mfma_f32_16x16x32_bf16 v[76:79], v[100:103], v[180:183], v[76:79]
    ds_read_b64_tr_b16 v[44:45], v13 offset:18688
    ds_read_b64_tr_b16 v[46:47], v13 offset:21760
    v_mfma_f32_16x16x32_bf16 v[80:83], v[104:107], v[180:183], v[80:83]
    ds_read_b64_tr_b16 v[48:49], v12 offset:18944
    ds_read_b64_tr_b16 v[50:51], v12 offset:22016
    v_mfma_f32_16x16x32_bf16 v[84:87], v[108:111], v[180:183], v[84:87]
    ds_read_b64_tr_b16 v[52:53], v13 offset:18944
    ds_read_b64_tr_b16 v[54:55], v13 offset:22016
    s_barrier
    s_waitcnt lgkmcnt(12)
    v_mfma_f32_16x16x32_bf16 v[64:67], v[112:115], v[184:187], v[64:67]
    ds_read_b64_tr_b16 v[88:89], v12 offset:24576
    ds_read_b64_tr_b16 v[90:91], v12 offset:27648
    v_mfma_f32_16x16x32_bf16 v[68:71], v[116:119], v[184:187], v[68:71]
    ds_read_b64_tr_b16 v[92:93], v13 offset:24576
    ds_read_b64_tr_b16 v[94:95], v13 offset:27648
    v_mfma_f32_16x16x32_bf16 v[72:75], v[120:123], v[184:187], v[72:75]
    ds_read_b64_tr_b16 v[96:97], v12 offset:24832
    ds_read_b64_tr_b16 v[98:99], v12 offset:27904
    v_mfma_f32_16x16x32_bf16 v[76:79], v[124:127], v[184:187], v[76:79]
    ds_read_b64_tr_b16 v[100:101], v13 offset:24832
    ds_read_b64_tr_b16 v[102:103], v13 offset:27904
    v_mfma_f32_16x16x32_bf16 v[80:83], v[56:59], v[184:187], v[80:83]
    ds_read_b64_tr_b16 v[104:105], v12 offset:25088
    ds_read_b64_tr_b16 v[106:107], v12 offset:28160
    v_mfma_f32_16x16x32_bf16 v[84:87], v[60:63], v[184:187], v[84:87]
    ds_read_b64_tr_b16 v[108:109], v13 offset:25088
    ds_read_b64_tr_b16 v[110:111], v13 offset:28160
    s_waitcnt lgkmcnt(12)
    v_mfma_f32_16x16x32_bf16 v[64:67], v[32:35], v[188:191], v[64:67]
    ds_read_b64_tr_b16 v[112:113], v12 offset:30720
    ds_read_b64_tr_b16 v[114:115], v12 offset:33792
    v_mfma_f32_16x16x32_bf16 v[68:71], v[36:39], v[188:191], v[68:71]
    ds_read_b64_tr_b16 v[116:117], v13 offset:30720
    ds_read_b64_tr_b16 v[118:119], v13 offset:33792
    v_mfma_f32_16x16x32_bf16 v[72:75], v[40:43], v[188:191], v[72:75]
    ds_read_b64_tr_b16 v[120:121], v12 offset:30976
    ds_read_b64_tr_b16 v[122:123], v12 offset:34048
    v_mfma_f32_16x16x32_bf16 v[76:79], v[44:47], v[188:191], v[76:79]
    ds_read_b64_tr_b16 v[124:125], v13 offset:30976
    ds_read_b64_tr_b16 v[126:127], v13 offset:34048
    v_mfma_f32_16x16x32_bf16 v[80:83], v[48:51], v[188:191], v[80:83]
    ds_read_b64_tr_b16 v[56:57], v12 offset:31232
    ds_read_b64_tr_b16 v[58:59], v12 offset:34304
    v_mfma_f32_16x16x32_bf16 v[84:87], v[52:55], v[188:191], v[84:87]
    ds_read_b64_tr_b16 v[60:61], v13 offset:31232
    ds_read_b64_tr_b16 v[62:63], v13 offset:34304
    s_waitcnt lgkmcnt(12)
    v_mfma_f32_16x16x32_bf16 v[64:67], v[88:91], v[192:195], v[64:67]
    ds_read_b64_tr_b16 v[32:33], v12 offset:36864
    ds_read_b64_tr_b16 v[34:35], v12 offset:39936
    v_mfma_f32_16x16x32_bf16 v[68:71], v[92:95], v[192:195], v[68:71]
    ds_read_b64_tr_b16 v[36:37], v13 offset:36864
    ds_read_b64_tr_b16 v[38:39], v13 offset:39936
    v_mfma_f32_16x16x32_bf16 v[72:75], v[96:99], v[192:195], v[72:75]
    ds_read_b64_tr_b16 v[40:41], v12 offset:37120
    ds_read_b64_tr_b16 v[42:43], v12 offset:40192
    v_mfma_f32_16x16x32_bf16 v[76:79], v[100:103], v[192:195], v[76:79]
    ds_read_b64_tr_b16 v[44:45], v13 offset:37120
    ds_read_b64_tr_b16 v[46:47], v13 offset:40192
    v_mfma_f32_16x16x32_bf16 v[80:83], v[104:107], v[192:195], v[80:83]
    ds_read_b64_tr_b16 v[48:49], v12 offset:37376
    ds_read_b64_tr_b16 v[50:51], v12 offset:40448
    v_mfma_f32_16x16x32_bf16 v[84:87], v[108:111], v[192:195], v[84:87]
    ds_read_b64_tr_b16 v[52:53], v13 offset:37376
    ds_read_b64_tr_b16 v[54:55], v13 offset:40448
    s_waitcnt lgkmcnt(12)
    v_mfma_f32_16x16x32_bf16 v[64:67], v[112:115], v[196:199], v[64:67]
    ds_read_b64_tr_b16 v[88:89], v12 offset:43008
    ds_read_b64_tr_b16 v[90:91], v12 offset:46080
    v_mfma_f32_16x16x32_bf16 v[68:71], v[116:119], v[196:199], v[68:71]
    ds_read_b64_tr_b16 v[92:93], v13 offset:43008
    ds_read_b64_tr_b16 v[94:95], v13 offset:46080
    v_mfma_f32_16x16x32_bf16 v[72:75], v[120:123], v[196:199], v[72:75]
    ds_read_b64_tr_b16 v[96:97], v12 offset:43264
    ds_read_b64_tr_b16 v[98:99], v12 offset:46336
    v_mfma_f32_16x16x32_bf16 v[76:79], v[124:127], v[196:199], v[76:79]
    ds_read_b64_tr_b16 v[100:101], v13 offset:43264
    ds_read_b64_tr_b16 v[102:103], v13 offset:46336
    v_mfma_f32_16x16x32_bf16 v[80:83], v[56:59], v[196:199], v[80:83]
    ds_read_b64_tr_b16 v[104:105], v12 offset:43520
    ds_read_b64_tr_b16 v[106:107], v12 offset:46592
    v_mfma_f32_16x16x32_bf16 v[84:87], v[60:63], v[196:199], v[84:87]
    ds_read_b64_tr_b16 v[108:109], v13 offset:43520
    ds_read_b64_tr_b16 v[110:111], v13 offset:46592
    s_barrier
    s_waitcnt lgkmcnt(12)
    v_mfma_f32_16x16x32_bf16 v[64:67], v[32:35], v[200:203], v[64:67]
    ds_read_b64_tr_b16 v[112:113], v14 offset:0
    ds_read_b64_tr_b16 v[114:115], v14 offset:3072
    v_mfma_f32_16x16x32_bf16 v[68:71], v[36:39], v[200:203], v[68:71]
    ds_read_b64_tr_b16 v[116:117], v15 offset:0
    ds_read_b64_tr_b16 v[118:119], v15 offset:3072
    v_mfma_f32_16x16x32_bf16 v[72:75], v[40:43], v[200:203], v[72:75]
    ds_read_b64_tr_b16 v[120:121], v14 offset:256
    ds_read_b64_tr_b16 v[122:123], v14 offset:3328
    v_mfma_f32_16x16x32_bf16 v[76:79], v[44:47], v[200:203], v[76:79]
    ds_read_b64_tr_b16 v[124:125], v15 offset:256
    ds_read_b64_tr_b16 v[126:127], v15 offset:3328
    v_mfma_f32_16x16x32_bf16 v[80:83], v[48:51], v[200:203], v[80:83]
    ds_read_b64_tr_b16 v[56:57], v14 offset:512
    ds_read_b64_tr_b16 v[58:59], v14 offset:3584
    v_mfma_f32_16x16x32_bf16 v[84:87], v[52:55], v[200:203], v[84:87]
    ds_read_b64_tr_b16 v[60:61], v15 offset:512
    ds_read_b64_tr_b16 v[62:63], v15 offset:3584
    s_waitcnt lgkmcnt(12)
    v_mfma_f32_16x16x32_bf16 v[64:67], v[88:91], v[204:207], v[64:67]
    ds_read_b64_tr_b16 v[32:33], v14 offset:6144
    ds_read_b64_tr_b16 v[34:35], v14 offset:9216
    v_mfma_f32_16x16x32_bf16 v[68:71], v[92:95], v[204:207], v[68:71]
    ds_read_b64_tr_b16 v[36:37], v15 offset:6144
    ds_read_b64_tr_b16 v[38:39], v15 offset:9216
    v_mfma_f32_16x16x32_bf16 v[72:75], v[96:99], v[204:207], v[72:75]
    ds_read_b64_tr_b16 v[40:41], v14 offset:6400
    ds_read_b64_tr_b16 v[42:43], v14 offset:9472
    v_mfma_f32_16x16x32_bf16 v[76:79], v[100:103], v[204:207], v[76:79]
    ds_read_b64_tr_b16 v[44:45], v15 offset:6400
    ds_read_b64_tr_b16 v[46:47], v15 offset:9472
    v_mfma_f32_16x16x32_bf16 v[80:83], v[104:107], v[204:207], v[80:83]
    ds_read_b64_tr_b16 v[48:49], v14 offset:6656
    ds_read_b64_tr_b16 v[50:51], v14 offset:9728
    v_mfma_f32_16x16x32_bf16 v[84:87], v[108:111], v[204:207], v[84:87]
    ds_read_b64_tr_b16 v[52:53], v15 offset:6656
    ds_read_b64_tr_b16 v[54:55], v15 offset:9728
    s_waitcnt lgkmcnt(12)
    v_mfma_f32_16x16x32_bf16 v[64:67], v[112:115], v[208:211], v[64:67]
    ds_read_b64_tr_b16 v[88:89], v14 offset:12288
    ds_read_b64_tr_b16 v[90:91], v14 offset:15360
    v_mfma_f32_16x16x32_bf16 v[68:71], v[116:119], v[208:211], v[68:71]
    ds_read_b64_tr_b16 v[92:93], v15 offset:12288
    ds_read_b64_tr_b16 v[94:95], v15 offset:15360
    v_mfma_f32_16x16x32_bf16 v[72:75], v[120:123], v[208:211], v[72:75]
    ds_read_b64_tr_b16 v[96:97], v14 offset:12544
    ds_read_b64_tr_b16 v[98:99], v14 offset:15616
    v_mfma_f32_16x16x32_bf16 v[76:79], v[124:127], v[208:211], v[76:79]
    ds_read_b64_tr_b16 v[100:101], v15 offset:12544
    ds_read_b64_tr_b16 v[102:103], v15 offset:15616
    v_mfma_f32_16x16x32_bf16 v[80:83], v[56:59], v[208:211], v[80:83]
    ds_read_b64_tr_b16 v[104:105], v14 offset:12800
    ds_read_b64_tr_b16 v[106:107], v14 offset:15872
    v_mfma_f32_16x16x32_bf16 v[84:87], v[60:63], v[208:211], v[84:87]
    ds_read_b64_tr_b16 v[108:109], v15 offset:12800
    ds_read_b64_tr_b16 v[110:111], v15 offset:15872
    s_waitcnt lgkmcnt(12)
    v_mfma_f32_16x16x32_bf16 v[64:67], v[32:35], v[212:215], v[64:67]
    ds_read_b64_tr_b16 v[112:113], v14 offset:18432
    ds_read_b64_tr_b16 v[114:115], v14 offset:21504
    v_mfma_f32_16x16x32_bf16 v[68:71], v[36:39], v[212:215], v[68:71]
    ds_read_b64_tr_b16 v[116:117], v15 offset:18432
    ds_read_b64_tr_b16 v[118:119], v15 offset:21504
    v_mfma_f32_16x16x32_bf16 v[72:75], v[40:43], v[212:215], v[72:75]
    ds_read_b64_tr_b16 v[120:121], v14 offset:18688
    ds_read_b64_tr_b16 v[122:123], v14 offset:21760
    v_mfma_f32_16x16x32_bf16 v[76:79], v[44:47], v[212:215], v[76:79]
    ds_read_b64_tr_b16 v[124:125], v15 offset:18688
    ds_read_b64_tr_b16 v[126:127], v15 offset:21760
    v_mfma_f32_16x16x32_bf16 v[80:83], v[48:51], v[212:215], v[80:83]
    ds_read_b64_tr_b16 v[56:57], v14 offset:18944
    ds_read_b64_tr_b16 v[58:59], v14 offset:22016
    v_mfma_f32_16x16x32_bf16 v[84:87], v[52:55], v[212:215], v[84:87]
    ds_read_b64_tr_b16 v[60:61], v15 offset:18944
    ds_read_b64_tr_b16 v[62:63], v15 offset:22016
    s_barrier
    s_waitcnt lgkmcnt(12)
    v_mfma_f32_16x16x32_bf16 v[64:67], v[88:91], v[216:219], v[64:67]
    ds_read_b64_tr_b16 v[32:33], v14 offset:24576
    ds_read_b64_tr_b16 v[34:35], v14 offset:27648
    v_mfma_f32_16x16x32_bf16 v[68:71], v[92:95], v[216:219], v[68:71]
    ds_read_b64_tr_b16 v[36:37], v15 offset:24576
    ds_read_b64_tr_b16 v[38:39], v15 offset:27648
    v_mfma_f32_16x16x32_bf16 v[72:75], v[96:99], v[216:219], v[72:75]
    ds_read_b64_tr_b16 v[40:41], v14 offset:24832
    ds_read_b64_tr_b16 v[42:43], v14 offset:27904
    v_mfma_f32_16x16x32_bf16 v[76:79], v[100:103], v[216:219], v[76:79]
    ds_read_b64_tr_b16 v[44:45], v15 offset:24832
    ds_read_b64_tr_b16 v[46:47], v15 offset:27904
    v_mfma_f32_16x16x32_bf16 v[80:83], v[104:107], v[216:219], v[80:83]
    ds_read_b64_tr_b16 v[48:49], v14 offset:25088
    ds_read_b64_tr_b16 v[50:51], v14 offset:28160
    v_mfma_f32_16x16x32_bf16 v[84:87], v[108:111], v[216:219], v[84:87]
    ds_read_b64_tr_b16 v[52:53], v15 offset:25088
    ds_read_b64_tr_b16 v[54:55], v15 offset:28160
    s_waitcnt lgkmcnt(12)
    v_mfma_f32_16x16x32_bf16 v[64:67], v[112:115], v[220:223], v[64:67]
    ds_read_b64_tr_b16 v[88:89], v14 offset:30720
    ds_read_b64_tr_b16 v[90:91], v14 offset:33792
    v_mfma_f32_16x16x32_bf16 v[68:71], v[116:119], v[220:223], v[68:71]
    ds_read_b64_tr_b16 v[92:93], v15 offset:30720
    ds_read_b64_tr_b16 v[94:95], v15 offset:33792
    v_mfma_f32_16x16x32_bf16 v[72:75], v[120:123], v[220:223], v[72:75]
    ds_read_b64_tr_b16 v[96:97], v14 offset:30976
    ds_read_b64_tr_b16 v[98:99], v14 offset:34048
    v_mfma_f32_16x16x32_bf16 v[76:79], v[124:127], v[220:223], v[76:79]
    ds_read_b64_tr_b16 v[100:101], v15 offset:30976
    ds_read_b64_tr_b16 v[102:103], v15 offset:34048
    v_mfma_f32_16x16x32_bf16 v[80:83], v[56:59], v[220:223], v[80:83]
    ds_read_b64_tr_b16 v[104:105], v14 offset:31232
    ds_read_b64_tr_b16 v[106:107], v14 offset:34304
    v_mfma_f32_16x16x32_bf16 v[84:87], v[60:63], v[220:223], v[84:87]
    ds_read_b64_tr_b16 v[108:109], v15 offset:31232
    ds_read_b64_tr_b16 v[110:111], v15 offset:34304
    s_waitcnt lgkmcnt(12)
    v_mfma_f32_16x16x32_bf16 v[64:67], v[32:35], v[224:227], v[64:67]
    ds_read_b64_tr_b16 v[112:113], v14 offset:36864
    ds_read_b64_tr_b16 v[114:115], v14 offset:39936
    v_mfma_f32_16x16x32_bf16 v[68:71], v[36:39], v[224:227], v[68:71]
    ds_read_b64_tr_b16 v[116:117], v15 offset:36864
    ds_read_b64_tr_b16 v[118:119], v15 offset:39936
    v_mfma_f32_16x16x32_bf16 v[72:75], v[40:43], v[224:227], v[72:75]
    ds_read_b64_tr_b16 v[120:121], v14 offset:37120
    ds_read_b64_tr_b16 v[122:123], v14 offset:40192
    v_mfma_f32_16x16x32_bf16 v[76:79], v[44:47], v[224:227], v[76:79]
    ds_read_b64_tr_b16 v[124:125], v15 offset:37120
    ds_read_b64_tr_b16 v[126:127], v15 offset:40192
    v_mfma_f32_16x16x32_bf16 v[80:83], v[48:51], v[224:227], v[80:83]
    ds_read_b64_tr_b16 v[56:57], v14 offset:37376
    ds_read_b64_tr_b16 v[58:59], v14 offset:40448
    v_mfma_f32_16x16x32_bf16 v[84:87], v[52:55], v[224:227], v[84:87]
    ds_read_b64_tr_b16 v[60:61], v15 offset:37376
    ds_read_b64_tr_b16 v[62:63], v15 offset:40448
    s_waitcnt lgkmcnt(12)
    v_mfma_f32_16x16x32_bf16 v[64:67], v[88:91], v[228:231], v[64:67]
    ds_read_b64_tr_b16 v[32:33], v14 offset:43008
    ds_read_b64_tr_b16 v[34:35], v14 offset:46080
    v_mfma_f32_16x16x32_bf16 v[68:71], v[92:95], v[228:231], v[68:71]
    ds_read_b64_tr_b16 v[36:37], v15 offset:43008
    ds_read_b64_tr_b16 v[38:39], v15 offset:46080
    v_mfma_f32_16x16x32_bf16 v[72:75], v[96:99], v[228:231], v[72:75]
    ds_read_b64_tr_b16 v[40:41], v14 offset:43264
    ds_read_b64_tr_b16 v[42:43], v14 offset:46336
    v_mfma_f32_16x16x32_bf16 v[76:79], v[100:103], v[228:231], v[76:79]
    ds_read_b64_tr_b16 v[44:45], v15 offset:43264
    ds_read_b64_tr_b16 v[46:47], v15 offset:46336
    v_mfma_f32_16x16x32_bf16 v[80:83], v[104:107], v[228:231], v[80:83]
    ds_read_b64_tr_b16 v[48:49], v14 offset:43520
    ds_read_b64_tr_b16 v[50:51], v14 offset:46592
    v_mfma_f32_16x16x32_bf16 v[84:87], v[108:111], v[228:231], v[84:87]
    ds_read_b64_tr_b16 v[52:53], v15 offset:43520
    ds_read_b64_tr_b16 v[54:55], v15 offset:46592
    s_barrier
    s_waitcnt lgkmcnt(12)
    v_mfma_f32_16x16x32_bf16 v[64:67], v[112:115], v[232:235], v[64:67]
    ds_read_b64_tr_b16 v[88:89], v6 offset:0
    ds_read_b64_tr_b16 v[90:91], v6 offset:3072
    v_mfma_f32_16x16x32_bf16 v[68:71], v[116:119], v[232:235], v[68:71]
    ds_read_b64_tr_b16 v[92:93], v7 offset:0
    ds_read_b64_tr_b16 v[94:95], v7 offset:3072
    v_mfma_f32_16x16x32_bf16 v[72:75], v[120:123], v[232:235], v[72:75]
    ds_read_b64_tr_b16 v[96:97], v6 offset:256
    ds_read_b64_tr_b16 v[98:99], v6 offset:3328
    v_mfma_f32_16x16x32_bf16 v[76:79], v[124:127], v[232:235], v[76:79]
    ds_read_b64_tr_b16 v[100:101], v7 offset:256
    ds_read_b64_tr_b16 v[102:103], v7 offset:3328
    v_mfma_f32_16x16x32_bf16 v[80:83], v[56:59], v[232:235], v[80:83]
    ds_read_b64_tr_b16 v[104:105], v6 offset:512
    ds_read_b64_tr_b16 v[106:107], v6 offset:3584
    v_mfma_f32_16x16x32_bf16 v[84:87], v[60:63], v[232:235], v[84:87]
    ds_read_b64_tr_b16 v[108:109], v7 offset:512
    ds_read_b64_tr_b16 v[110:111], v7 offset:3584
    s_waitcnt lgkmcnt(12)
    v_mfma_f32_16x16x32_bf16 v[64:67], v[32:35], v[236:239], v[64:67]
    ds_read_b64_tr_b16 v[112:113], v6 offset:6144
    ds_read_b64_tr_b16 v[114:115], v6 offset:9216
    v_mfma_f32_16x16x32_bf16 v[68:71], v[36:39], v[236:239], v[68:71]
    ds_read_b64_tr_b16 v[116:117], v7 offset:6144
    ds_read_b64_tr_b16 v[118:119], v7 offset:9216
    v_mfma_f32_16x16x32_bf16 v[72:75], v[40:43], v[236:239], v[72:75]
    ds_read_b64_tr_b16 v[120:121], v6 offset:6400
    ds_read_b64_tr_b16 v[122:123], v6 offset:9472
    v_mfma_f32_16x16x32_bf16 v[76:79], v[44:47], v[236:239], v[76:79]
    ds_read_b64_tr_b16 v[124:125], v7 offset:6400
    ds_read_b64_tr_b16 v[126:127], v7 offset:9472
    v_mfma_f32_16x16x32_bf16 v[80:83], v[48:51], v[236:239], v[80:83]
    ds_read_b64_tr_b16 v[56:57], v6 offset:6656
    ds_read_b64_tr_b16 v[58:59], v6 offset:9728
    v_mfma_f32_16x16x32_bf16 v[84:87], v[52:55], v[236:239], v[84:87]
    ds_read_b64_tr_b16 v[60:61], v7 offset:6656
    ds_read_b64_tr_b16 v[62:63], v7 offset:9728
    s_waitcnt lgkmcnt(12)
    v_mfma_f32_16x16x32_bf16 v[64:67], v[88:91], v[240:243], v[64:67]
    ds_read_b64_tr_b16 v[32:33], v6 offset:12288
    ds_read_b64_tr_b16 v[34:35], v6 offset:15360
    v_mfma_f32_16x16x32_bf16 v[68:71], v[92:95], v[240:243], v[68:71]
    ds_read_b64_tr_b16 v[36:37], v7 offset:12288
    ds_read_b64_tr_b16 v[38:39], v7 offset:15360
    v_mfma_f32_16x16x32_bf16 v[72:75], v[96:99], v[240:243], v[72:75]
    ds_read_b64_tr_b16 v[40:41], v6 offset:12544
    ds_read_b64_tr_b16 v[42:43], v6 offset:15616
    v_mfma_f32_16x16x32_bf16 v[76:79], v[100:103], v[240:243], v[76:79]
    ds_read_b64_tr_b16 v[44:45], v7 offset:12544
    ds_read_b64_tr_b16 v[46:47], v7 offset:15616
    v_mfma_f32_16x16x32_bf16 v[80:83], v[104:107], v[240:243], v[80:83]
    ds_read_b64_tr_b16 v[48:49], v6 offset:12800
    ds_read_b64_tr_b16 v[50:51], v6 offset:15872
    v_mfma_f32_16x16x32_bf16 v[84:87], v[108:111], v[240:243], v[84:87]
    ds_read_b64_tr_b16 v[52:53], v7 offset:12800
    ds_read_b64_tr_b16 v[54:55], v7 offset:15872
    s_waitcnt lgkmcnt(12)
    v_mfma_f32_16x16x32_bf16 v[64:67], v[112:115], v[244:247], v[64:67]
    ds_read_b64_tr_b16 v[88:89], v6 offset:18432
    ds_read_b64_tr_b16 v[90:91], v6 offset:21504
    v_mfma_f32_16x16x32_bf16 v[68:71], v[116:119], v[244:247], v[68:71]
    ds_read_b64_tr_b16 v[92:93], v7 offset:18432
    ds_read_b64_tr_b16 v[94:95], v7 offset:21504
    v_mfma_f32_16x16x32_bf16 v[72:75], v[120:123], v[244:247], v[72:75]
    ds_read_b64_tr_b16 v[96:97], v6 offset:18688
    ds_read_b64_tr_b16 v[98:99], v6 offset:21760
    v_mfma_f32_16x16x32_bf16 v[76:79], v[124:127], v[244:247], v[76:79]
    ds_read_b64_tr_b16 v[100:101], v7 offset:18688
    ds_read_b64_tr_b16 v[102:103], v7 offset:21760
    v_mfma_f32_16x16x32_bf16 v[80:83], v[56:59], v[244:247], v[80:83]
    ds_read_b64_tr_b16 v[104:105], v6 offset:18944
    ds_read_b64_tr_b16 v[106:107], v6 offset:22016
    v_mfma_f32_16x16x32_bf16 v[84:87], v[60:63], v[244:247], v[84:87]
    ds_read_b64_tr_b16 v[108:109], v7 offset:18944
    ds_read_b64_tr_b16 v[110:111], v7 offset:22016
    s_barrier
    s_waitcnt lgkmcnt(12)
    v_mfma_f32_16x16x32_bf16 v[64:67], v[32:35], v[248:251], v[64:67]
    s_add_u32 s48, s96, 5
    v_mfma_f32_16x16x32_bf16 v[68:71], v[36:39], v[248:251], v[68:71]
    s_and_b32 s48, s48, 7
    v_mfma_f32_16x16x32_bf16 v[72:75], v[40:43], v[248:251], v[72:75]
    s_mul_i32 s48, s48, 768
    v_mfma_f32_16x16x32_bf16 v[76:79], v[44:47], v[248:251], v[76:79]
    s_add_u32 s48, s48, s54
    v_mfma_f32_16x16x32_bf16 v[80:83], v[48:51], v[248:251], v[80:83]
    s_add_u32 s48, s48, 196608
    v_mfma_f32_16x16x32_bf16 v[84:87], v[52:55], v[248:251], v[84:87]
    s_add_u32 m0, s55, 90112
    s_waitcnt lgkmcnt(0)
    v_mfma_f32_16x16x32_bf16 v[64:67], v[88:91], v[252:255], v[64:67]
    buffer_load_dwordx4 v8, s[28:31], s48 offen offset:0 sc1 lds
    v_mfma_f32_16x16x32_bf16 v[68:71], v[92:95], v[252:255], v[68:71]
    v_mfma_f32_16x16x32_bf16 v[72:75], v[96:99], v[252:255], v[72:75]
    v_mfma_f32_16x16x32_bf16 v[76:79], v[100:103], v[252:255], v[76:79]
    buffer_load_dwordx4 v9, s[28:31], s48 offen offset:1024 sc1 lds
    v_mfma_f32_16x16x32_bf16 v[80:83], v[104:107], v[252:255], v[80:83]
    v_mfma_f32_16x16x32_bf16 v[84:87], v[108:111], v[252:255], v[84:87]
    s_setprio 0
    s_mul_i32 s40, s32, 6144
    buffer_load_dwordx4 v10, s[28:31], s48 offen offset:2048 sc1 lds
    s_add_u32 s40, s40, 90112
    s_add_u32 s48, s48, 24576
    v_add_u32 v132, s40, v17
    s_add_u32 m0, s55, 93184
    s_nop 0
    buffer_load_dwordx4 v8, s[28:31], s48 offen offset:0 sc1 lds
    buffer_load_dwordx4 v9, s[28:31], s48 offen offset:1024 sc1 lds
    buffer_load_dwordx4 v10, s[28:31], s48 offen offset:2048 sc1 lds
    s_barrier
    v_lshrrev_b32 v4, 3, v0
    s_add_u32 s48, s96, 6
    v_and_b32 v5, 7, v0
    s_and_b32 s48, s48, 7
    v_lshlrev_b32 v3, 1, v2
    s_mul_i32 s48, s48, 768
    v_xor_b32 v5, v5, v3
    s_add_u32 s48, s48, s54
    v_lshlrev_b32 v5, 4, v5
    s_add_u32 s48, s48, 0
    v_lshl_add_u32 v131, v4, 10, v5
    s_add_u32 m0, s55, 114688
    s_lshl_b32 s50, s32, 13
    buffer_load_dwordx4 v8, s[28:31], s48 offen offset:0 sc1 lds
    s_lshl_b32 s46, s36, 7
    s_add_u32 s50, s50, s46
    s_lshl_b32 s51, s32, 10
    v_bfe_u32 v5, v0, 2, 2
    v_lshl_add_u32 v5, v2, 2, v5
    v_bfe_u32 v6, v5, 1, 2
    v_lshlrev_b32 v5, 7, v5
    v_and_b32 v7, 3, v0
    v_lshl_add_u32 v5, v7, 3, v5
    v_xor_b32 v7, 0, v6
    v_lshl_add_u32 v48, v7, 5, v5
    v_add_u32 v52, 98304, v48
    v_xor_b32 v7, 1, v6
    v_lshl_add_u32 v49, v7, 5, v5
    v_add_u32 v53, 98304, v49
    buffer_load_dwordx4 v9, s[28:31], s48 offen offset:1024 sc1 lds
    v_xor_b32 v7, 2, v6
    v_lshl_add_u32 v50, v7, 5, v5
    v_add_u32 v54, 98304, v50
    v_xor_b32 v7, 3, v6
    v_lshl_add_u32 v51, v7, 5, v5
    v_add_u32 v55, 98304, v51
    buffer_load_dwordx4 v10, s[28:31], s48 offen offset:2048 sc1 lds
    s_add_u32 s48, s48, 24576
    s_add_u32 m0, s55, 117760
    s_nop 0
    buffer_load_dwordx4 v8, s[28:31], s48 offen offset:0 sc1 lds
    buffer_load_dwordx4 v9, s[28:31], s48 offen offset:1024 sc1 lds
    buffer_load_dwordx4 v10, s[28:31], s48 offen offset:2048 sc1 lds
    s_barrier
    v_add_f32 v64, v64, v16
    s_add_u32 s48, s96, 6
    v_add_f32 v65, v65, v16
    s_and_b32 s48, s48, 7
    v_add_f32 v66, v66, v16
    s_mul_i32 s48, s48, 768
    v_add_f32 v67, v67, v16
    s_add_u32 s48, s48, s54
    v_add_f32 v68, v68, v16
    s_add_u32 s48, s48, 196608
    v_add_f32 v69, v69, v16
    s_add_u32 m0, s55, 16384
    v_add_f32 v70, v70, v16
    buffer_load_dwordx4 v8, s[28:31], s48 offen offset:0 sc1 lds
    v_add_f32 v71, v71, v16
    v_add_f32 v72, v72, v16
    v_add_f32 v73, v73, v16
    v_add_f32 v74, v74, v16
    v_add_f32 v75, v75, v16
    v_add_f32 v76, v76, v16
    v_add_f32 v77, v77, v16
    v_add_f32 v78, v78, v16
    v_add_f32 v79, v79, v16
    v_add_f32 v80, v80, v16
    v_add_f32 v81, v81, v16
    v_add_f32 v82, v82, v16
    v_add_f32 v83, v83, v16
    v_add_f32 v84, v84, v16
    v_add_f32 v85, v85, v16
    buffer_load_dwordx4 v9, s[28:31], s48 offen offset:1024 sc1 lds
    v_add_f32 v86, v86, v16
    v_add_f32 v87, v87, v16
    buffer_load_dwordx4 v10, s[28:31], s48 offen offset:2048 sc1 lds
    s_add_u32 s48, s48, 24576
    s_add_u32 m0, s55, 19456
    s_nop 0
    buffer_load_dwordx4 v8, s[28:31], s48 offen offset:0 sc1 lds
    buffer_load_dwordx4 v9, s[28:31], s48 offen offset:1024 sc1 lds
    buffer_load_dwordx4 v10, s[28:31], s48 offen offset:2048 sc1 lds
    s_add_u32 s48, s50, 180224
    s_add_u32 m0, s51, 147456
    s_nop 0
    buffer_load_dwordx4 v131, s[20:23], s48 offen lds
    s_waitcnt vmcnt(13)
    s_barrier
    v_lshrrev_b32 v3, 1, v2
    s_add_u32 s48, s96, 7
    v_and_b32 v16, 1, v2
    s_and_b32 s48, s48, 7
    v_lshl_or_b32 v3, v16, 1, v3
    s_mul_i32 s48, s48, 768
    v_lshlrev_b32 v16, 4, v3
    s_add_u32 s48, s48, s54
    v_lshl_add_u32 v16, v11, 10, v16
    s_add_u32 s48, s48, 0
    s_cmp_lt_u32 s36, 4
    s_cbranch_scc0 L_rm15
    v_lshlrev_b32 v32, 16, v20
    v_and_b32 v33, 0xffff0000, v20
    v_lshlrev_b32 v34, 16, v21
    v_and_b32 v35, 0xffff0000, v21
    v_lshlrev_b32 v36, 16, v22
    v_and_b32 v37, 0xffff0000, v22
    v_lshlrev_b32 v38, 16, v23
    v_and_b32 v39, 0xffff0000, v23
    v_lshlrev_b32 v40, 16, v24
    v_and_b32 v41, 0xffff0000, v24
    v_lshlrev_b32 v42, 16, v25
    v_and_b32 v43, 0xffff0000, v25
    v_lshlrev_b32 v44, 16, v26
    v_and_b32 v45, 0xffff0000, v26
    v_lshlrev_b32 v46, 16, v27
    v_and_b32 v47, 0xffff0000, v27
    s_branch L_rd15
L_rm15:
    v_lshlrev_b32 v32, 16, v28
    v_and_b32 v33, 0xffff0000, v21
    v_lshlrev_b32 v34, 16, v21
    v_and_b32 v35, 0xffff0000, v20
    v_lshlrev_b32 v36, 16, v29
    v_and_b32 v37, 0xffff0000, v23
    v_lshlrev_b32 v38, 16, v23
    v_and_b32 v39, 0xffff0000, v22
    v_lshlrev_b32 v40, 16, v30
    v_and_b32 v41, 0xffff0000, v25
    v_lshlrev_b32 v42, 16, v25
    v_and_b32 v43, 0xffff0000, v24
    v_lshlrev_b32 v44, 16, v31
    v_and_b32 v45, 0xffff0000, v27
    v_lshlrev_b32 v46, 16, v27
    v_and_b32 v47, 0xffff0000, v26
L_rd15:
    s_add_u32 s40, s53, 2048
    s_add_u32 m0, s55, 40960
    s_add_u32 s41, s53, 6144
    buffer_load_dwordx4 v8, s[28:31], s48 offen offset:0 sc1 lds
    s_add_u32 s42, s53, 10240
    s_add_u32 s43, s53, 14336
    s_add_u32 s44, s53, 18432
    s_add_u32 s45, s53, 22528
    buffer_load_dwordx4 v9, s[28:31], s48 offen offset:1024 sc1 lds
    buffer_load_dwordx4 v10, s[28:31], s48 offen offset:2048 sc1 lds
    s_add_u32 s48, s48, 24576
    s_add_u32 m0, s55, 44032
    s_nop 0
    buffer_load_dwordx4 v8, s[28:31], s48 offen offset:0 sc1 lds
    buffer_load_dwordx4 v9, s[28:31], s48 offen offset:1024 sc1 lds
    buffer_load_dwordx4 v10, s[28:31], s48 offen offset:2048 sc1 lds
    s_add_u32 s48, s50, 212992
    s_add_u32 m0, s51, 151552
    s_nop 0
    buffer_load_dwordx4 v131, s[20:23], s48 offen lds
    s_waitcnt vmcnt(14)
    s_barrier
    s_add_u32 s48, s96, 7
    s_and_b32 s48, s48, 7
    s_mul_i32 s48, s48, 768
    s_add_u32 s48, s48, s54
    s_add_u32 s48, s48, 196608
    s_add_u32 m0, s55, 65536
    s_nop 0
    buffer_load_dwordx4 v8, s[28:31], s48 offen offset:0 sc1 lds
    buffer_load_dwordx4 v9, s[28:31], s48 offen offset:1024 sc1 lds
    buffer_load_dwordx4 v10, s[28:31], s48 offen offset:2048 sc1 lds
    s_add_u32 s48, s48, 24576
    s_add_u32 m0, s55, 68608
    s_nop 0
    buffer_load_dwordx4 v8, s[28:31], s48 offen offset:0 sc1 lds
    buffer_load_dwordx4 v9, s[28:31], s48 offen offset:1024 sc1 lds
    buffer_load_dwordx4 v10, s[28:31], s48 offen offset:2048 sc1 lds
    s_waitcnt vmcnt(14)
    s_barrier
    v_lshlrev_b32 v18, 7, v0
    s_mov_b64 exec, 0xffffff
    buffer_load_dword v19, v18, s[28:31], s3 offen
    s_mov_b64 exec, -1
    s_setprio 2
    ds_write_b128 v132, v[64:67] offset:0
    ds_write_b128 v132, v[68:71] offset:1024
    ds_write_b128 v132, v[72:75] offset:2048
    ds_write_b128 v132, v[76:79] offset:3072
    ds_write_b128 v132, v[80:83] offset:4096
    ds_write_b128 v132, v[84:87] offset:5120
    s_waitcnt lgkmcnt(0)
    s_setprio 0
    s_waitcnt vmcnt(8)
    s_barrier
    s_add_u32 s48, s50, 245760
    s_add_u32 m0, s51, 114688
    s_nop 0
    buffer_load_dwordx4 v131, s[20:23], s48 offen lds
    s_add_u32 s48, s50, 278528
    s_add_u32 m0, s51, 118784
    s_nop 0
    buffer_load_dwordx4 v131, s[20:23], s48 offen lds
    s_add_u32 s48, s50, 311296
    s_add_u32 m0, s51, 122880
    s_nop 0
    buffer_load_dwordx4 v131, s[20:23], s48 offen lds
    s_add_u32 s48, s50, 344064
    s_add_u32 m0, s51, 126976
    s_nop 0
    buffer_load_dwordx4 v131, s[20:23], s48 offen lds
    s_add_u32 s48, s50, 376832
    s_add_u32 m0, s51, 131072
    s_nop 0
    buffer_load_dwordx4 v131, s[20:23], s48 offen lds
    s_add_u32 s48, s50, 409600
    s_add_u32 m0, s51, 135168
    s_nop 0
    buffer_load_dwordx4 v131, s[20:23], s48 offen lds
    s_waitcnt vmcnt(7)
    s_barrier
    s_add_u32 s48, s50, 442368
    s_add_u32 m0, s51, 16384
    s_nop 0
    buffer_load_dwordx4 v131, s[20:23], s48 offen lds
    s_add_u32 s48, s50, 475136
    s_add_u32 m0, s51, 20480
    s_nop 0
    buffer_load_dwordx4 v131, s[20:23], s48 offen lds
    s_add_u32 s48, s50, 507904
    s_add_u32 m0, s51, 24576
    s_nop 0
    buffer_load_dwordx4 v131, s[20:23], s48 offen lds
    s_add_u32 s48, s50, 540672
    s_add_u32 m0, s51, 28672
    s_nop 0
    buffer_load_dwordx4 v131, s[20:23], s48 offen lds
    s_add_u32 s48, s50, 573440
    s_add_u32 m0, s51, 32768
    s_nop 0
    buffer_load_dwordx4 v131, s[20:23], s48 offen lds
    s_add_u32 s48, s50, 606208
    s_add_u32 m0, s51, 36864
    s_nop 0
    buffer_load_dwordx4 v131, s[20:23], s48 offen lds
    s_add_u32 s48, s50, 638976
    s_add_u32 m0, s51, 40960
    s_nop 0
    buffer_load_dwordx4 v131, s[20:23], s48 offen lds
    s_add_u32 s48, s50, 671744
    s_add_u32 m0, s51, 45056
    s_nop 0
    buffer_load_dwordx4 v131, s[20:23], s48 offen lds
    ds_read_b64_tr_b16 v[112:113], v48 offset:0
    ds_read_b64_tr_b16 v[114:115], v48 offset:2048
    ds_read_b64_tr_b16 v[116:117], v49 offset:0
    ds_read_b64_tr_b16 v[118:119], v49 offset:2048
    ds_read_b64_tr_b16 v[120:121], v50 offset:0
    ds_read_b64_tr_b16 v[122:123], v50 offset:2048
    ds_read_b64_tr_b16 v[124:125], v51 offset:0
    ds_read_b64_tr_b16 v[126:127], v51 offset:2048
    ds_read_b64_tr_b16 v[128:129], v48 offset:4096
    ds_read_b64_tr_b16 v[130:131], v48 offset:6144
    ds_read_b64_tr_b16 v[132:133], v49 offset:4096
    ds_read_b64_tr_b16 v[134:135], v49 offset:6144
    ds_read_b64_tr_b16 v[136:137], v50 offset:4096
    ds_read_b64_tr_b16 v[138:139], v50 offset:6144
    ds_read_b64_tr_b16 v[140:141], v51 offset:4096
    ds_read_b64_tr_b16 v[142:143], v51 offset:6144
    ds_read_b64_tr_b16 v[144:145], v48 offset:8192
    ds_read_b64_tr_b16 v[146:147], v48 offset:10240
    ds_read_b64_tr_b16 v[148:149], v49 offset:8192
    ds_read_b64_tr_b16 v[150:151], v49 offset:10240
    ds_read_b64_tr_b16 v[152:153], v50 offset:8192
    ds_read_b64_tr_b16 v[154:155], v50 offset:10240
    ds_read_b64_tr_b16 v[156:157], v51 offset:8192
    ds_read_b64_tr_b16 v[158:159], v51 offset:10240
    ds_read_b64_tr_b16 v[160:161], v48 offset:12288
    ds_read_b64_tr_b16 v[162:163], v48 offset:14336
    ds_read_b64_tr_b16 v[164:165], v49 offset:12288
    ds_read_b64_tr_b16 v[166:167], v49 offset:14336
    ds_read_b64_tr_b16 v[168:169], v50 offset:12288
    ds_read_b64_tr_b16 v[170:171], v50 offset:14336
    ds_read_b64_tr_b16 v[172:173], v51 offset:12288
    ds_read_b64_tr_b16 v[174:175], v51 offset:14336
    ds_read_b64_tr_b16 v[176:177], v52 offset:40960
    ds_read_b64_tr_b16 v[178:179], v52 offset:43008
    ds_read_b64_tr_b16 v[180:181], v53 offset:40960
    ds_read_b64_tr_b16 v[182:183], v53 offset:43008
    ds_read_b64_tr_b16 v[184:185], v54 offset:40960
    ds_read_b64_tr_b16 v[186:187], v54 offset:43008
    ds_read_b64_tr_b16 v[188:189], v55 offset:40960
    ds_read_b64_tr_b16 v[190:191], v55 offset:43008
    ds_read_b64_tr_b16 v[192:193], v52 offset:45056
    ds_read_b64_tr_b16 v[194:195], v52 offset:47104
    ds_read_b64_tr_b16 v[196:197], v53 offset:45056
    ds_read_b64_tr_b16 v[198:199], v53 offset:47104
    ds_read_b64_tr_b16 v[200:201], v54 offset:45056
    ds_read_b64_tr_b16 v[202:203], v54 offset:47104
    ds_read_b64_tr_b16 v[204:205], v55 offset:45056
    ds_read_b64_tr_b16 v[206:207], v55 offset:47104
    ds_read_b64_tr_b16 v[208:209], v52 offset:49152
    ds_read_b64_tr_b16 v[210:211], v52 offset:51200
    ds_read_b64_tr_b16 v[212:213], v53 offset:49152
    ds_read_b64_tr_b16 v[214:215], v53 offset:51200
    ds_read_b64_tr_b16 v[216:217], v54 offset:49152
    ds_read_b64_tr_b16 v[218:219], v54 offset:51200
    ds_read_b64_tr_b16 v[220:221], v55 offset:49152
    ds_read_b64_tr_b16 v[222:223], v55 offset:51200
    ds_read_b64_tr_b16 v[224:225], v52 offset:53248
    ds_read_b64_tr_b16 v[226:227], v52 offset:55296
    ds_read_b64_tr_b16 v[228:229], v53 offset:53248
    ds_read_b64_tr_b16 v[230:231], v53 offset:55296
    ds_read_b64_tr_b16 v[232:233], v54 offset:53248
    ds_read_b64_tr_b16 v[234:235], v54 offset:55296
    ds_read_b64_tr_b16 v[236:237], v55 offset:53248
    ds_read_b64_tr_b16 v[238:239], v55 offset:55296
    v_and_b32 v3, 7, v0
    v_lshlrev_b32 v3, 7, v3
    s_lshl_b32 s47, s35, 10
    s_lshl_b32 s48, s32, 2
    s_add_u32 s47, s47, s48
    s_add_u32 s47, s47, 8617984
L_poll16:
    buffer_load_dword v4, v3, s[28:31], s47 offen sc1
    s_add_u32 s58, s58, 8
    s_waitcnt vmcnt(0)
    v_cmp_ne_u32 vcc, s39, v4
    s_cbranch_vccz L_pdone16
    s_mov_b64 exec, vcc
    s_sleep 1
    s_cmp_lt_u32 s58, 400000
    s_cbranch_scc1 L_poll16
L_pdone16:
    s_mov_b64 exec, -1
    buffer_load_dwordx4 v[56:59], v17, s[28:31], s40 offen offset:0 sc1
    buffer_load_dwordx4 v[60:63], v17, s[28:31], s40 offen offset:1024 sc1
    buffer_load_dwordx4 v[64:67], v17, s[28:31], s40 offen offset:2048 sc1
    buffer_load_dwordx4 v[68:71], v17, s[28:31], s40 offen offset:3072 sc1
    buffer_load_dwordx4 v[72:75], v17, s[28:31], s41 offen offset:0 sc1
    buffer_load_dwordx4 v[76:79], v17, s[28:31], s41 offen offset:1024 sc1
    buffer_load_dwordx4 v[80:83], v17, s[28:31], s41 offen offset:2048 sc1
    buffer_load_dwordx4 v[84:87], v17, s[28:31], s41 offen offset:3072 sc1
    buffer_load_dwordx4 v[88:91], v17, s[28:31], s42 offen offset:0 sc1
    buffer_load_dwordx4 v[92:95], v17, s[28:31], s42 offen offset:1024 sc1
    buffer_load_dwordx4 v[96:99], v17, s[28:31], s42 offen offset:2048 sc1
    buffer_load_dwordx4 v[100:103], v17, s[28:31], s42 offen offset:3072 sc1
    s_barrier
    ds_read_b64_tr_b16 v[240:241], v52 offset:16384
    ds_read_b64_tr_b16 v[242:243], v52 offset:18432
    ds_read_b64_tr_b16 v[244:245], v53 offset:16384
    ds_read_b64_tr_b16 v[246:247], v53 offset:18432
    ds_read_b64_tr_b16 v[248:249], v54 offset:16384
    ds_read_b64_tr_b16 v[250:251], v54 offset:18432
    ds_read_b64_tr_b16 v[252:253], v55 offset:16384
    ds_read_b64_tr_b16 v[254:255], v55 offset:18432
    s_waitcnt vmcnt(11) lgkmcnt(15)
    v_mfma_f32_16x16x32_bf16 v[32:35], v[112:115], v[56:59], v[32:35]
    buffer_load_dwordx4 v[104:107], v17, s[28:31], s43 offen offset:0 sc1
    buffer_load_dwordx4 v[108:111], v17, s[28:31], s43 offen offset:1024 sc1
    v_mfma_f32_16x16x32_bf16 v[36:39], v[116:119], v[56:59], v[36:39]
    v_mfma_f32_16x16x32_bf16 v[40:43], v[120:123], v[56:59], v[40:43]
    v_mfma_f32_16x16x32_bf16 v[44:47], v[124:127], v[56:59], v[44:47]
    s_waitcnt vmcnt(12)
    v_mfma_f32_16x16x32_bf16 v[32:35], v[128:131], v[60:63], v[32:35]
    v_mfma_f32_16x16x32_bf16 v[36:39], v[132:135], v[60:63], v[36:39]
    v_mfma_f32_16x16x32_bf16 v[40:43], v[136:139], v[60:63], v[40:43]
    v_mfma_f32_16x16x32_bf16 v[44:47], v[140:143], v[60:63], v[44:47]
    s_waitcnt vmcnt(11)
    v_mfma_f32_16x16x32_bf16 v[32:35], v[144:147], v[64:67], v[32:35]
    buffer_load_dwordx4 v[56:59], v17, s[28:31], s43 offen offset:2048 sc1
    buffer_load_dwordx4 v[60:63], v17, s[28:31], s43 offen offset:3072 sc1
    v_mfma_f32_16x16x32_bf16 v[36:39], v[148:151], v[64:67], v[36:39]
    ds_read_b64_tr_b16 v[112:113], v52 offset:20480
    ds_read_b64_tr_b16 v[114:115], v52 offset:22528
    v_mfma_f32_16x16x32_bf16 v[40:43], v[152:155], v[64:67], v[40:43]
    ds_read_b64_tr_b16 v[116:117], v53 offset:20480
    ds_read_b64_tr_b16 v[118:119], v53 offset:22528
    v_mfma_f32_16x16x32_bf16 v[44:47], v[156:159], v[64:67], v[44:47]
    ds_read_b64_tr_b16 v[120:121], v54 offset:20480
    ds_read_b64_tr_b16 v[122:123], v54 offset:22528
    s_waitcnt vmcnt(12)
    v_mfma_f32_16x16x32_bf16 v[32:35], v[160:163], v[68:71], v[32:35]
    ds_read_b64_tr_b16 v[124:125], v55 offset:20480
    ds_read_b64_tr_b16 v[126:127], v55 offset:22528
    v_mfma_f32_16x16x32_bf16 v[36:39], v[164:167], v[68:71], v[36:39]
    ds_read_b64_tr_b16 v[128:129], v52 offset:24576
    ds_read_b64_tr_b16 v[130:131], v52 offset:26624
    v_mfma_f32_16x16x32_bf16 v[40:43], v[168:171], v[68:71], v[40:43]
    ds_read_b64_tr_b16 v[132:133], v53 offset:24576
    ds_read_b64_tr_b16 v[134:135], v53 offset:26624
    v_mfma_f32_16x16x32_bf16 v[44:47], v[172:175], v[68:71], v[44:47]
    s_waitcnt vmcnt(11)
    v_mfma_f32_16x16x32_bf16 v[32:35], v[176:179], v[72:75], v[32:35]
    buffer_load_dwordx4 v[64:67], v17, s[28:31], s44 offen offset:0 sc1
    buffer_load_dwordx4 v[68:71], v17, s[28:31], s44 offen offset:1024 sc1
    v_mfma_f32_16x16x32_bf16 v[36:39], v[180:183], v[72:75], v[36:39]
    ds_read_b64_tr_b16 v[136:137], v54 offset:24576
    ds_read_b64_tr_b16 v[138:139], v54 offset:26624
    v_mfma_f32_16x16x32_bf16 v[40:43], v[184:187], v[72:75], v[40:43]
    ds_read_b64_tr_b16 v[140:141], v55 offset:24576
    ds_read_b64_tr_b16 v[142:143], v55 offset:26624
    v_mfma_f32_16x16x32_bf16 v[44:47], v[188:191], v[72:75], v[44:47]
    ds_read_b64_tr_b16 v[144:145], v52 offset:28672
    ds_read_b64_tr_b16 v[146:147], v52 offset:30720
    s_waitcnt vmcnt(12)
    v_mfma_f32_16x16x32_bf16 v[32:35], v[192:195], v[76:79], v[32:35]
    ds_read_b64_tr_b16 v[148:149], v53 offset:28672
    ds_read_b64_tr_b16 v[150:151], v53 offset:30720
    v_mfma_f32_16x16x32_bf16 v[36:39], v[196:199], v[76:79], v[36:39]
    ds_read_b64_tr_b16 v[152:153], v54 offset:28672
    ds_read_b64_tr_b16 v[154:155], v54 offset:30720
    v_mfma_f32_16x16x32_bf16 v[40:43], v[200:203], v[76:79], v[40:43]
    ds_read_b64_tr_b16 v[156:157], v55 offset:28672
    ds_read_b64_tr_b16 v[158:159], v55 offset:30720
    v_mfma_f32_16x16x32_bf16 v[44:47], v[204:207], v[76:79], v[44:47]
    s_waitcnt vmcnt(11)
    v_mfma_f32_16x16x32_bf16 v[32:35], v[208:211], v[80:83], v[32:35]
    buffer_load_dwordx4 v[72:75], v17, s[28:31], s44 offen offset:2048 sc1
    buffer_load_dwordx4 v[76:79], v17, s[28:31], s44 offen offset:3072 sc1
    v_mfma_f32_16x16x32_bf16 v[36:39], v[212:215], v[80:83], v[36:39]
    ds_read_b64_tr_b16 v[160:161], v52 offset:32768
    ds_read_b64_tr_b16 v[162:163], v52 offset:34816
    v_mfma_f32_16x16x32_bf16 v[40:43], v[216:219], v[80:83], v[40:43]
    ds_read_b64_tr_b16 v[164:165], v53 offset:32768
    ds_read_b64_tr_b16 v[166:167], v53 offset:34816
    v_mfma_f32_16x16x32_bf16 v[44:47], v[220:223], v[80:83], v[44:47]
    ds_read_b64_tr_b16 v[168:169], v54 offset:32768
    ds_read_b64_tr_b16 v[170:171], v54 offset:34816
    s_waitcnt vmcnt(12) lgkmcnt(15)
    v_mfma_f32_16x16x32_bf16 v[32:35], v[224:227], v[84:87], v[32:35]
    ds_read_b64_tr_b16 v[172:173], v55 offset:32768
    ds_read_b64_tr_b16 v[174:175], v55 offset:34816
    v_mfma_f32_16x16x32_bf16 v[36:39], v[228:231], v[84:87], v[36:39]
    ds_read_b64_tr_b16 v[176:177], v52 offset:36864
    ds_read_b64_tr_b16 v[178:179], v52 offset:38912
    v_mfma_f32_16x16x32_bf16 v[40:43], v[232:235], v[84:87], v[40:43]
    ds_read_b64_tr_b16 v[180:181], v53 offset:36864
    ds_read_b64_tr_b16 v[182:183], v53 offset:38912
    v_mfma_f32_16x16x32_bf16 v[44:47], v[236:239], v[84:87], v[44:47]
    s_waitcnt vmcnt(11)
    v_mfma_f32_16x16x32_bf16 v[32:35], v[240:243], v[88:91], v[32:35]
    buffer_load_dwordx4 v[80:83], v17, s[28:31], s45 offen offset:0 sc1
    buffer_load_dwordx4 v[84:87], v17, s[28:31], s45 offen offset:1024 sc1
    v_mfma_f32_16x16x32_bf16 v[36:39], v[244:247], v[88:91], v[36:39]
    ds_read_b64_tr_b16 v[184:185], v54 offset:36864
    ds_read_b64_tr_b16 v[186:187], v54 offset:38912
    v_mfma_f32_16x16x32_bf16 v[40:43], v[248:251], v[88:91], v[40:43]
    ds_read_b64_tr_b16 v[188:189], v55 offset:36864
    ds_read_b64_tr_b16 v[190:191], v55 offset:38912
    v_mfma_f32_16x16x32_bf16 v[44:47], v[252:255], v[88:91], v[44:47]
    ds_read_b64_tr_b16 v[192:193], v48 offset:16384
    ds_read_b64_tr_b16 v[194:195], v48 offset:18432
    s_waitcnt vmcnt(12)
    v_mfma_f32_16x16x32_bf16 v[32:35], v[112:115], v[92:95], v[32:35]
    ds_read_b64_tr_b16 v[196:197], v49 offset:16384
    ds_read_b64_tr_b16 v[198:199], v49 offset:18432
    v_mfma_f32_16x16x32_bf16 v[36:39], v[116:119], v[92:95], v[36:39]
    ds_read_b64_tr_b16 v[200:201], v50 offset:16384
    ds_read_b64_tr_b16 v[202:203], v50 offset:18432
    v_mfma_f32_16x16x32_bf16 v[40:43], v[120:123], v[92:95], v[40:43]
    ds_read_b64_tr_b16 v[204:205], v51 offset:16384
    ds_read_b64_tr_b16 v[206:207], v51 offset:18432
    v_mfma_f32_16x16x32_bf16 v[44:47], v[124:127], v[92:95], v[44:47]
    s_waitcnt vmcnt(11)
    v_mfma_f32_16x16x32_bf16 v[32:35], v[128:131], v[96:99], v[32:35]
    ds_read_b64_tr_b16 v[208:209], v48 offset:20480
    ds_read_b64_tr_b16 v[210:211], v48 offset:22528
    v_mfma_f32_16x16x32_bf16 v[36:39], v[132:135], v[96:99], v[36:39]
    ds_read_b64_tr_b16 v[212:213], v49 offset:20480
    ds_read_b64_tr_b16 v[214:215], v49 offset:22528
    v_mfma_f32_16x16x32_bf16 v[40:43], v[136:139], v[96:99], v[40:43]
    ds_read_b64_tr_b16 v[216:217], v50 offset:20480
    ds_read_b64_tr_b16 v[218:219], v50 offset:22528
    s_waitcnt lgkmcnt(15)
    v_mfma_f32_16x16x32_bf16 v[44:47], v[140:143], v[96:99], v[44:47]
    ds_read_b64_tr_b16 v[220:221], v51 offset:20480
    ds_read_b64_tr_b16 v[222:223], v51 offset:22528
    s_waitcnt vmcnt(10)
    v_mfma_f32_16x16x32_bf16 v[32:35], v[144:147], v[100:103], v[32:35]
    ds_read_b64_tr_b16 v[224:225], v48 offset:24576
    ds_read_b64_tr_b16 v[226:227], v48 offset:26624
    v_mfma_f32_16x16x32_bf16 v[36:39], v[148:151], v[100:103], v[36:39]
    ds_read_b64_tr_b16 v[228:229], v49 offset:24576
    ds_read_b64_tr_b16 v[230:231], v49 offset:26624
    v_mfma_f32_16x16x32_bf16 v[40:43], v[152:155], v[100:103], v[40:43]
    v_mfma_f32_16x16x32_bf16 v[44:47], v[156:159], v[100:103], v[44:47]
    s_waitcnt vmcnt(9)
    v_mfma_f32_16x16x32_bf16 v[32:35], v[160:163], v[104:107], v[32:35]
    ds_read_b64_tr_b16 v[232:233], v50 offset:24576
    ds_read_b64_tr_b16 v[234:235], v50 offset:26624
    v_mfma_f32_16x16x32_bf16 v[36:39], v[164:167], v[104:107], v[36:39]
    ds_read_b64_tr_b16 v[236:237], v51 offset:24576
    ds_read_b64_tr_b16 v[238:239], v51 offset:26624
    v_mfma_f32_16x16x32_bf16 v[40:43], v[168:171], v[104:107], v[40:43]
    ds_read_b64_tr_b16 v[240:241], v48 offset:28672
    ds_read_b64_tr_b16 v[242:243], v48 offset:30720
    v_mfma_f32_16x16x32_bf16 v[44:47], v[172:175], v[104:107], v[44:47]
    ds_read_b64_tr_b16 v[244:245], v49 offset:28672
    ds_read_b64_tr_b16 v[246:247], v49 offset:30720
    s_waitcnt vmcnt(8)
    v_mfma_f32_16x16x32_bf16 v[32:35], v[176:179], v[108:111], v[32:35]
    ds_read_b64_tr_b16 v[248:249], v50 offset:28672
    ds_read_b64_tr_b16 v[250:251], v50 offset:30720
    v_mfma_f32_16x16x32_bf16 v[36:39], v[180:183], v[108:111], v[36:39]
    ds_read_b64_tr_b16 v[252:253], v51 offset:28672
    ds_read_b64_tr_b16 v[254:255], v51 offset:30720
    v_mfma_f32_16x16x32_bf16 v[40:43], v[184:187], v[108:111], v[40:43]
    s_waitcnt lgkmcnt(15)
    v_mfma_f32_16x16x32_bf16 v[44:47], v[188:191], v[108:111], v[44:47]
    s_waitcnt vmcnt(7)
    v_mfma_f32_16x16x32_bf16 v[32:35], v[192:195], v[56:59], v[32:35]
    ds_read_b64_tr_b16 v[112:113], v48 offset:32768
    ds_read_b64_tr_b16 v[114:115], v48 offset:34816
    v_mfma_f32_16x16x32_bf16 v[36:39], v[196:199], v[56:59], v[36:39]
    ds_read_b64_tr_b16 v[116:117], v49 offset:32768
    ds_read_b64_tr_b16 v[118:119], v49 offset:34816
    v_mfma_f32_16x16x32_bf16 v[40:43], v[200:203], v[56:59], v[40:43]
    ds_read_b64_tr_b16 v[120:121], v50 offset:32768
    ds_read_b64_tr_b16 v[122:123], v50 offset:34816
    v_mfma_f32_16x16x32_bf16 v[44:47], v[204:207], v[56:59], v[44:47]
    ds_read_b64_tr_b16 v[124:125], v51 offset:32768
    ds_read_b64_tr_b16 v[126:127], v51 offset:34816
    s_waitcnt vmcnt(6)
    v_mfma_f32_16x16x32_bf16 v[32:35], v[208:211], v[60:63], v[32:35]
    ds_read_b64_tr_b16 v[128:129], v48 offset:36864
    ds_read_b64_tr_b16 v[130:131], v48 offset:38912
    v_mfma_f32_16x16x32_bf16 v[36:39], v[212:215], v[60:63], v[36:39]
    ds_read_b64_tr_b16 v[132:133], v49 offset:36864
    ds_read_b64_tr_b16 v[134:135], v49 offset:38912
    v_mfma_f32_16x16x32_bf16 v[40:43], v[216:219], v[60:63], v[40:43]
    v_mfma_f32_16x16x32_bf16 v[44:47], v[220:223], v[60:63], v[44:47]
    s_waitcnt vmcnt(5) lgkmcnt(15)
    v_mfma_f32_16x16x32_bf16 v[32:35], v[224:227], v[64:67], v[32:35]
    ds_read_b64_tr_b16 v[136:137], v50 offset:36864
    ds_read_b64_tr_b16 v[138:139], v50 offset:38912
    v_mfma_f32_16x16x32_bf16 v[36:39], v[228:231], v[64:67], v[36:39]
    ds_read_b64_tr_b16 v[140:141], v51 offset:36864
    ds_read_b64_tr_b16 v[142:143], v51 offset:38912
    v_mfma_f32_16x16x32_bf16 v[40:43], v[232:235], v[64:67], v[40:43]
    ds_read_b64_tr_b16 v[144:145], v48 offset:40960
    ds_read_b64_tr_b16 v[146:147], v48 offset:43008
    v_mfma_f32_16x16x32_bf16 v[44:47], v[236:239], v[64:67], v[44:47]
    ds_read_b64_tr_b16 v[148:149], v49 offset:40960
    ds_read_b64_tr_b16 v[150:151], v49 offset:43008
    s_waitcnt vmcnt(4)
    v_mfma_f32_16x16x32_bf16 v[32:35], v[240:243], v[68:71], v[32:35]
    ds_read_b64_tr_b16 v[152:153], v50 offset:40960
    ds_read_b64_tr_b16 v[154:155], v50 offset:43008
    v_mfma_f32_16x16x32_bf16 v[36:39], v[244:247], v[68:71], v[36:39]
    ds_read_b64_tr_b16 v[156:157], v51 offset:40960
    ds_read_b64_tr_b16 v[158:159], v51 offset:43008
    s_waitcnt lgkmcnt(15)
    v_mfma_f32_16x16x32_bf16 v[40:43], v[248:251], v[68:71], v[40:43]
    v_mfma_f32_16x16x32_bf16 v[44:47], v[252:255], v[68:71], v[44:47]
    s_waitcnt vmcnt(3)
    v_mfma_f32_16x16x32_bf16 v[32:35], v[112:115], v[72:75], v[32:35]
    ds_read_b64_tr_b16 v[160:161], v48 offset:45056
    ds_read_b64_tr_b16 v[162:163], v48 offset:47104
    v_mfma_f32_16x16x32_bf16 v[36:39], v[116:119], v[72:75], v[36:39]
    ds_read_b64_tr_b16 v[164:165], v49 offset:45056
    ds_read_b64_tr_b16 v[166:167], v49 offset:47104
    v_mfma_f32_16x16x32_bf16 v[40:43], v[120:123], v[72:75], v[40:43]
    ds_read_b64_tr_b16 v[168:169], v50 offset:45056
    ds_read_b64_tr_b16 v[170:171], v50 offset:47104
    v_mfma_f32_16x16x32_bf16 v[44:47], v[124:127], v[72:75], v[44:47]
    ds_read_b64_tr_b16 v[172:173], v51 offset:45056
    ds_read_b64_tr_b16 v[174:175], v51 offset:47104
    s_waitcnt vmcnt(2) lgkmcnt(15)
    v_mfma_f32_16x16x32_bf16 v[32:35], v[128:131], v[76:79], v[32:35]
    v_mfma_f32_16x16x32_bf16 v[36:39], v[132:135], v[76:79], v[36:39]
    v_mfma_f32_16x16x32_bf16 v[40:43], v[136:139], v[76:79], v[40:43]
    v_mfma_f32_16x16x32_bf16 v[44:47], v[140:143], v[76:79], v[44:47]
    s_waitcnt vmcnt(1) lgkmcnt(14)
    v_mfma_f32_16x16x32_bf16 v[32:35], v[144:147], v[80:83], v[32:35]
    s_waitcnt lgkmcnt(12)
    v_mfma_f32_16x16x32_bf16 v[36:39], v[148:151], v[80:83], v[36:39]
    s_waitcnt lgkmcnt(10)
    v_mfma_f32_16x16x32_bf16 v[40:43], v[152:155], v[80:83], v[40:43]
    s_waitcnt lgkmcnt(8)
    v_mfma_f32_16x16x32_bf16 v[44:47], v[156:159], v[80:83], v[44:47]
    s_waitcnt vmcnt(0) lgkmcnt(6)
    v_mfma_f32_16x16x32_bf16 v[32:35], v[160:163], v[84:87], v[32:35]
    s_waitcnt lgkmcnt(4)
    v_mfma_f32_16x16x32_bf16 v[36:39], v[164:167], v[84:87], v[36:39]
    s_waitcnt lgkmcnt(2)
    v_mfma_f32_16x16x32_bf16 v[40:43], v[168:171], v[84:87], v[40:43]
    s_waitcnt lgkmcnt(0)
    v_mfma_f32_16x16x32_bf16 v[44:47], v[172:175], v[84:87], v[44:47]
    s_nop 1
    v_cvt_pk_bf16_f32 v4, v32, v33
    v_cvt_pk_bf16_f32 v5, v34, v35
    v_cvt_pk_bf16_f32 v6, v36, v37
    v_cvt_pk_bf16_f32 v7, v38, v39
    s_nop 0
    v_permlane16_swap_b32 v4, v6
    v_permlane16_swap_b32 v5, v7
    buffer_store_dwordx4 v[4:7], v16, s[24:27], s46 offen offset:0
    v_cvt_pk_bf16_f32 v8, v40, v41
    v_cvt_pk_bf16_f32 v9, v42, v43
    v_cvt_pk_bf16_f32 v10, v44, v45
    v_cvt_pk_bf16_f32 v11, v46, v47
    s_nop 0
    v_permlane16_swap_b32 v8, v10
    v_permlane16_swap_b32 v9, v11
    buffer_store_dwordx4 v[8:11], v16, s[24:27], s46 offen offset:64
    s_endpgm
L_rt1:
    s_add_u32 s58, s58, 8
    s_cmp_gt_u32 s58, 400000
    s_cbranch_scc1 L_ok1
    s_waitcnt vmcnt(0)
    buffer_load_dwordx4 v[96:99], v65, s[28:31], s52 offen offset:0 sc1
    buffer_load_dwordx4 v[100:103], v65, s[28:31], s52 offen offset:384 sc1
    buffer_load_dwordx4 v[104:107], v65, s[28:31], s52 offen offset:768 sc1
    buffer_load_dwordx4 v[108:111], v65, s[28:31], s52 offen offset:1152 sc1
    buffer_load_dword v112, v64, s[28:31], s45 offen sc1
    s_waitcnt vmcnt(0)
    v_xor_b32 v96, s44, v96
    v_xor_b32 v97, s44, v97
    v_xor_b32 v98, s44, v98
    v_xor_b32 v99, s44, v99
    v_xor_b32 v100, s44, v100
    v_xor_b32 v101, s44, v101
    v_xor_b32 v102, s44, v102
    v_xor_b32 v103, s44, v103
    v_xor_b32 v104, s44, v104
    v_xor_b32 v105, s44, v105
    v_xor_b32 v106, s44, v106
    v_xor_b32 v107, s44, v107
    v_xor_b32 v108, s44, v108
    v_xor_b32 v109, s44, v109
    v_xor_b32 v110, s44, v110
    v_xor_b32 v111, s44, v111
    v_subrev_u32 v112, s39, v112
    v_lshrrev_b32 v113, 4, v112
    v_min_u32 v113, 1, v113
    v_or3_b32 v3, v96, v97, v98
    v_or3_b32 v3, v3, v99, v100
    v_or3_b32 v3, v3, v101, v102
    v_or3_b32 v3, v3, v103, v104
    v_or3_b32 v3, v3, v105, v106
    v_or3_b32 v3, v3, v107, v108
    v_or3_b32 v3, v3, v109, v110
    v_or3_b32 v3, v3, v111, v113
    v_and_b32 v3, 0xff, v3
    v_cmp_ne_u32 vcc, 0, v3
    s_cbranch_vccnz L_rt1
    s_branch L_ok1
    s_waitcnt vmcnt(0)
L_ls2:
    s_nop 1
    buffer_store_dword v4, v7, s[28:31], s47 offen sc1
    s_branch L_lb2
    s_waitcnt vmcnt(0)
L_rt3:
    s_add_u32 s58, s58, 8
    s_cmp_gt_u32 s58, 400000
    s_cbranch_scc1 L_ok3
    s_waitcnt vmcnt(0)
    buffer_load_dword v4, v17, s[28:31], s101 offen offset:0 sc1
    buffer_load_dword v5, v17, s[28:31], s101 offen offset:128 sc1
    buffer_load_dword v6, v17, s[28:31], s101 offen offset:256 sc1
    buffer_load_dword v7, v17, s[28:31], s101 offen offset:384 sc1
    s_waitcnt vmcnt(0)
    v_xor_b32 v4, s44, v4
    v_xor_b32 v5, s44, v5
    v_xor_b32 v6, s44, v6
    v_xor_b32 v7, s44, v7
    v_or3_b32 v3, v4, v5, v6
    v_or_b32 v3, v3, v7
    v_and_b32 v3, 0xfff, v3
    v_cmp_ne_u32 vcc, 0, v3
    s_cbranch_vccnz L_rt3
    s_branch L_ok3
    s_waitcnt vmcnt(0)
L_ls4:
    s_nop 1
    buffer_store_dwordx4 v[32:35], v16, s[28:31], s3 offen offset:0 sc1
    s_branch L_lb4
    s_waitcnt vmcnt(0)
L_ls5:
    s_nop 1
    buffer_store_dwordx4 v[36:39], v16, s[28:31], s3 offen offset:1024 sc1
    s_branch L_lb5
    s_waitcnt vmcnt(0)
L_ls6:
    s_nop 1
    buffer_store_dwordx4 v[40:43], v16, s[28:31], s3 offen offset:2048 sc1
    s_branch L_lb6
    s_waitcnt vmcnt(0)
L_ls7:
    s_nop 1
    buffer_store_dword v9, v3, s[28:31], s40 offen sc1
    s_branch L_lb7
    s_waitcnt vmcnt(0)
L_rt9:
    s_add_u32 s58, s58, 8
    s_cmp_gt_u32 s58, 400000
    s_cbranch_scc1 L_ok9
    s_waitcnt vmcnt(0)
    buffer_load_dwordx4 v[192:195], v26, s[28:31], s40 offen offset:0 sc1
    buffer_load_dwordx4 v[196:199], v26, s[28:31], s40 offen offset:1024 sc1
    buffer_load_dwordx4 v[200:203], v26, s[28:31], s40 offen offset:2048 sc1
    buffer_load_dwordx4 v[204:207], v26, s[28:31], s40 offen offset:3072 sc1
    s_waitcnt vmcnt(0)
    v_xor_b32 v48, s88, v192
    v_xor_b32 v52, s89, v193
    v_xor_b32 v56, s90, v194
    v_xor_b32 v60, s91, v195
    v_xor_b32 v49, s88, v196
    v_xor_b32 v53, s89, v197
    v_xor_b32 v57, s90, v198
    v_xor_b32 v61, s91, v199
    v_xor_b32 v50, s88, v200
    v_xor_b32 v54, s89, v201
    v_xor_b32 v58, s90, v202
    v_xor_b32 v62, s91, v203
    v_xor_b32 v51, s88, v204
    v_xor_b32 v55, s89, v205
    v_xor_b32 v59, s90, v206
    v_xor_b32 v63, s91, v207
    v_or3_b32 v3, v48, v49, v50
    v_or3_b32 v3, v3, v51, v52
    v_or3_b32 v3, v3, v53, v54
    v_or3_b32 v3, v3, v55, v56
    v_or3_b32 v3, v3, v57, v58
    v_or3_b32 v3, v3, v59, v60
    v_or3_b32 v3, v3, v61, v62
    v_or_b32 v3, v3, v63
    v_and_b32 v3, 0x30003, v3
    v_cmp_ne_u32 vcc, 0, v3
    s_cbranch_vccnz L_rt9
    buffer_load_dwordx4 v[208:211], v26, s[28:31], s41 offen offset:0 sc1
    buffer_load_dwordx4 v[212:215], v26, s[28:31], s41 offen offset:1024 sc1
    buffer_load_dwordx4 v[216:219], v26, s[28:31], s41 offen offset:2048 sc1
    buffer_load_dwordx4 v[220:223], v26, s[28:31], s41 offen offset:3072 sc1
    buffer_load_dwordx4 v[224:227], v26, s[28:31], s42 offen offset:0 sc1
    buffer_load_dwordx4 v[228:231], v26, s[28:31], s42 offen offset:1024 sc1
    buffer_load_dwordx4 v[232:235], v26, s[28:31], s42 offen offset:2048 sc1
    buffer_load_dwordx4 v[236:239], v26, s[28:31], s42 offen offset:3072 sc1
    buffer_load_dwordx4 v[240:243], v26, s[28:31], s43 offen offset:0 sc1
    buffer_load_dwordx4 v[244:247], v26, s[28:31], s43 offen offset:1024 sc1
    buffer_load_dwordx4 v[248:251], v26, s[28:31], s43 offen offset:2048 sc1
    buffer_load_dwordx4 v[252:255], v26, s[28:31], s43 offen offset:3072 sc1
    s_branch L_ok9
    s_waitcnt vmcnt(0)
L_rt10:
    s_add_u32 s58, s58, 8
    s_cmp_gt_u32 s58, 400000
    s_cbranch_scc1 L_ok10
    s_waitcnt vmcnt(0)
    buffer_load_dwordx4 v[208:211], v26, s[28:31], s41 offen offset:0 sc1
    buffer_load_dwordx4 v[212:215], v26, s[28:31], s41 offen offset:1024 sc1
    buffer_load_dwordx4 v[216:219], v26, s[28:31], s41 offen offset:2048 sc1
    buffer_load_dwordx4 v[220:223], v26, s[28:31], s41 offen offset:3072 sc1
    s_waitcnt vmcnt(0)
    v_xor_b32 v192, s88, v208
    v_xor_b32 v196, s89, v209
    v_xor_b32 v200, s90, v210
    v_xor_b32 v204, s91, v211
    v_xor_b32 v193, s88, v212
    v_xor_b32 v197, s89, v213
    v_xor_b32 v201, s90, v214
    v_xor_b32 v205, s91, v215
    v_xor_b32 v194, s88, v216
    v_xor_b32 v198, s89, v217
    v_xor_b32 v202, s90, v218
    v_xor_b32 v206, s91, v219
    v_xor_b32 v195, s88, v220
    v_xor_b32 v199, s89, v221
    v_xor_b32 v203, s90, v222
    v_xor_b32 v207, s91, v223
    v_or3_b32 v3, v192, v193, v194
    v_or3_b32 v3, v3, v195, v196
    v_or3_b32 v3, v3, v197, v198
    v_or3_b32 v3, v3, v199, v200
    v_or3_b32 v3, v3, v201, v202
    v_or3_b32 v3, v3, v203, v204
    v_or3_b32 v3, v3, v205, v206
    v_or_b32 v3, v3, v207
    v_and_b32 v3, 0x30003, v3
    v_cmp_ne_u32 vcc, 0, v3
    s_cbranch_vccnz L_rt10
    buffer_load_dwordx4 v[224:227], v26, s[28:31], s42 offen offset:0 sc1
    buffer_load_dwordx4 v[228:231], v26, s[28:31], s42 offen offset:1024 sc1
    buffer_load_dwordx4 v[232:235], v26, s[28:31], s42 offen offset:2048 sc1
    buffer_load_dwordx4 v[236:239], v26, s[28:31], s42 offen offset:3072 sc1
    buffer_load_dwordx4 v[240:243], v26, s[28:31], s43 offen offset:0 sc1
    buffer_load_dwordx4 v[244:247], v26, s[28:31], s43 offen offset:1024 sc1
    buffer_load_dwordx4 v[248:251], v26, s[28:31], s43 offen offset:2048 sc1
    buffer_load_dwordx4 v[252:255], v26, s[28:31], s43 offen offset:3072 sc1
    s_branch L_ok10
    s_waitcnt vmcnt(0)
L_rt11:
    s_add_u32 s58, s58, 8
    s_cmp_gt_u32 s58, 400000
    s_cbranch_scc1 L_ok11
    s_waitcnt vmcnt(0)
    buffer_load_dwordx4 v[224:227], v26, s[28:31], s42 offen offset:0 sc1
    buffer_load_dwordx4 v[228:231], v26, s[28:31], s42 offen offset:1024 sc1
    buffer_load_dwordx4 v[232:235], v26, s[28:31], s42 offen offset:2048 sc1
    buffer_load_dwordx4 v[236:239], v26, s[28:31], s42 offen offset:3072 sc1
    s_waitcnt vmcnt(0)
    v_xor_b32 v208, s88, v224
    v_xor_b32 v212, s89, v225
    v_xor_b32 v216, s90, v226
    v_xor_b32 v220, s91, v227
    v_xor_b32 v209, s88, v228
    v_xor_b32 v213, s89, v229
    v_xor_b32 v217, s90, v230
    v_xor_b32 v221, s91, v231
    v_xor_b32 v210, s88, v232
    v_xor_b32 v214, s89, v233
    v_xor_b32 v218, s90, v234
    v_xor_b32 v222, s91, v235
    v_xor_b32 v211, s88, v236
    v_xor_b32 v215, s89, v237
    v_xor_b32 v219, s90, v238
    v_xor_b32 v223, s91, v239
    v_or3_b32 v3, v208, v209, v210
    v_or3_b32 v3, v3, v211, v212
    v_or3_b32 v3, v3, v213, v214
    v_or3_b32 v3, v3, v215, v216
    v_or3_b32 v3, v3, v217, v218
    v_or3_b32 v3, v3, v219, v220
    v_or3_b32 v3, v3, v221, v222
    v_or_b32 v3, v3, v223
    v_and_b32 v3, 0x30003, v3
    v_cmp_ne_u32 vcc, 0, v3
    s_cbranch_vccnz L_rt11
    buffer_load_dwordx4 v[240:243], v26, s[28:31], s43 offen offset:0 sc1
    buffer_load_dwordx4 v[244:247], v26, s[28:31], s43 offen offset:1024 sc1
    buffer_load_dwordx4 v[248:251], v26, s[28:31], s43 offen offset:2048 sc1
    buffer_load_dwordx4 v[252:255], v26, s[28:31], s43 offen offset:3072 sc1
    s_branch L_ok11
    s_waitcnt vmcnt(0)
L_rt12:
    s_add_u32 s58, s58, 8
    s_cmp_gt_u32 s58, 400000
    s_cbranch_scc1 L_ok12
    s_waitcnt vmcnt(0)
    buffer_load_dwordx4 v[240:243], v26, s[28:31], s43 offen offset:0 sc1
    buffer_load_dwordx4 v[244:247], v26, s[28:31], s43 offen offset:1024 sc1
    buffer_load_dwordx4 v[248:251], v26, s[28:31], s43 offen offset:2048 sc1
    buffer_load_dwordx4 v[252:255], v26, s[28:31], s43 offen offset:3072 sc1
    s_waitcnt vmcnt(0)
    v_xor_b32 v224, s88, v240
    v_xor_b32 v228, s89, v241
    v_xor_b32 v232, s90, v242
    v_xor_b32 v236, s91, v243
    v_xor_b32 v225, s88, v244
    v_xor_b32 v229, s89, v245
    v_xor_b32 v233, s90, v246
    v_xor_b32 v237, s91, v247
    v_xor_b32 v226, s88, v248
    v_xor_b32 v230, s89, v249
    v_xor_b32 v234, s90, v250
    v_xor_b32 v238, s91, v251
    v_xor_b32 v227, s88, v252
    v_xor_b32 v231, s89, v253
    v_xor_b32 v235, s90, v254
    v_xor_b32 v239, s91, v255
    v_or3_b32 v3, v224, v225, v226
    v_or3_b32 v3, v3, v227, v228
    v_or3_b32 v3, v3, v229, v230
    v_or3_b32 v3, v3, v231, v232
    v_or3_b32 v3, v3, v233, v234
    v_or3_b32 v3, v3, v235, v236
    v_or3_b32 v3, v3, v237, v238
    v_or_b32 v3, v3, v239
    v_and_b32 v3, 0x30003, v3
    v_cmp_ne_u32 vcc, 0, v3
    s_cbranch_vccnz L_rt12
    s_branch L_ok12
    s_waitcnt vmcnt(0)
L_f5:
L_poll13:
    buffer_load_dword v4, v66, s[28:31], s45 offen sc1
    s_add_u32 s58, s58, 8
    s_waitcnt vmcnt(0)
    v_cmp_ne_u32 vcc, s39, v4
    s_cbranch_vccz L_pdone13
    s_mov_b64 exec, vcc
    s_sleep 2
    s_cmp_lt_u32 s58, 400000
    s_cbranch_scc1 L_poll13
L_pdone13:
    s_mov_b64 exec, -1
    s_branch L_f5ok
.fill (40960 - (. - sequential_preLN__spectral_fnet__mixer_gmlp__prompt_kernel)) / 4, 4, 0xbf800000
.section .rodata,"a"
.p2align 6
.amdhsa_kernel sequential_preLN__spectral_fnet__mixer_gmlp__prompt_kernel
  .amdhsa_next_free_vgpr 256
  .amdhsa_next_free_sgpr 102
  .amdhsa_accum_offset 256
  .amdhsa_group_segment_fixed_size 0
  .amdhsa_kernarg_size 104
  .amdhsa_user_sgpr_count 2
  .amdhsa_user_sgpr_kernarg_segment_ptr 1
  .amdhsa_system_sgpr_workgroup_id_x 1
  .amdhsa_float_denorm_mode_32 3
  .amdhsa_float_denorm_mode_16_64 3
.end_amdhsa_kernel
```
